```python
import torch

def _softmax(x, axis=-1):
    return torch.softmax(x, dim=axis)
def _gelu(x):
    return torch.nn.functional.gelu(x, approximate="tanh")
def _silu(x):
    return torch.nn.functional.silu(x)
def _sigmoid(x):
    return torch.sigmoid(x)
def _layernorm(x, axis=-1, eps=1e-5):
    m = x.mean(dim=axis, keepdim=True)
    v = x.var(dim=axis, keepdim=True, unbiased=False)
    return (x - m) / torch.sqrt(v + eps)
def _scatter_add(tgt, idx, src, axis=0):
    return tgt.clone().index_add_(axis, idx, src)
def _segment_sum(src, seg, n):
    out = torch.zeros((n,) + src.shape[1:], dtype=src.dtype)
    return out.index_add_(0, seg, src)
def _pad(x, pw):
    flat = tuple(v for pair in reversed(pw) for v in pair)
    return torch.nn.functional.pad(x, flat)

kernel_name = 'interleave_layers__ssm_conv_s4d__dense_activation_relu__prompt'

def setup_inputs():

    _w = (lambda a: (lambda t: t.to(torch.bfloat16) if t.is_floating_point() else t)(torch.as_tensor(a)))
    def _A_setup():
        Bsz, L, D, N = 1, 2048, 512, 128
        return {
            "u": _w((lambda *s: torch.randn(*s, dtype=torch.bfloat16) * 0.05)(Bsz, L, D)),
            "log_A_real": _w((lambda *s: torch.randn(*s, dtype=torch.bfloat16) * 3.2)(D, N) * 0.5),
            "A_imag": _w((lambda *s: torch.randn(*s, dtype=torch.bfloat16) * 0.2)(D, N) * 3.14),
            "C_real": _w((lambda *s: torch.randn(*s, dtype=torch.bfloat16) * 0.2)(D, N) / N ** 0.5),
            "C_imag": _w((lambda *s: torch.randn(*s, dtype=torch.bfloat16) * 0.2)(D, N) / N ** 0.5),
            "log_dt": _w((lambda *s: torch.randn(*s, dtype=torch.bfloat16) * 0.2)(D) * 0.5 - 4.0),
            "D_skip": _w((lambda *s: torch.randn(*s, dtype=torch.bfloat16) * 0.2)(D)),
        }
    _A_in = _A_setup()

    def _B_setup():
        B, S, D, Dff = 1, 2048, 512, 1792
        return {
            "x": _w((lambda *s: torch.randn(*s, dtype=torch.bfloat16) * 0.05)(B, S, D)),
            "w1": _w((lambda *s: torch.randn(*s, dtype=torch.bfloat16) * 0.05)(D, Dff)),
            "w2": _w((lambda *s: torch.randn(*s, dtype=torch.bfloat16) * 0.05)(Dff, D)),
        }
    _B_in = _B_setup()

    return {
        "A_u": _A_in["u"],
        "A_log_A_real": _A_in["log_A_real"],
        "A_A_imag": _A_in["A_imag"],
        "A_C_real": _A_in["C_real"],
        "A_C_imag": _A_in["C_imag"],
        "A_log_dt": _A_in["log_dt"],
        "A_D_skip": _A_in["D_skip"],
        "B_x": _B_in["x"],
        "B_w1": _B_in["w1"],
        "B_w2": _B_in["w2"],
    }

def reference(A_u, A_log_A_real, A_A_imag, A_C_real, A_C_imag, A_log_dt, A_D_skip, B_x, B_w1, B_w2):
    def _A_ref(u, log_A_real, A_imag, C_real, C_imag, log_dt, D_skip):
        L = u.shape[1]
        dt = torch.exp(log_dt)
        A = -torch.exp(log_A_real) + 1j * A_imag
        C = (C_real + 1j * C_imag) * dt[:, None]
        pos = (lambda x, dt: x.to(dt))(torch.arange(L), log_dt.dtype)
        P = torch.exp((A * dt[:, None])[:, :, None] * pos[None, None, :])
        K = 2.0 * torch.einsum("dn,dnl->dl", C, P).real
        L2 = 2 * L
        u_t = (lambda x, *d: x.permute(*d))(u, 0, 2, 1)
        Kf = (lambda x, *a, **k: torch.fft.rfft(x.float(), *a, **k))(K, L2)
        Uf = (lambda x, *a, **k: torch.fft.rfft(x.float(), *a, **k))(u_t, L2)
        y = (lambda x, *a, **k: torch.fft.irfft(x, *a, **k).to(torch.bfloat16))(Uf * Kf[None, :, :], L2)[:, :, :L]
        y = (lambda x, *d: x.permute(*d))(y, 0, 2, 1)
        return y + u * D_skip[None, None, :]

    def _B_ref(x, w1, w2):
        h = torch.einsum("bsd,df->bsf", x, w1)
        zero = torch.zeros_like(h)
        h = torch.maximum(h, zero)
        return torch.einsum("bsf,fd->bsd", h, w2)

    x = A_u
    x = x + _A_ref(_layernorm(x, axis=-1), A_log_A_real, A_A_imag, A_C_real, A_C_imag, A_log_dt, A_D_skip)
    x = x + _B_ref(_layernorm(x, axis=-1), B_w1, B_w2)
    x = x + _A_ref(_layernorm(x, axis=-1), A_log_A_real, A_A_imag, A_C_real, A_C_imag, A_log_dt, A_D_skip)
    x = x + _B_ref(_layernorm(x, axis=-1), B_w1, B_w2)
    return x
```

```asm
; @launch kernel=prep_kernel grid=(696,1,1) block=(256,1,1) lds=24384
; @launch kernel=conv1_kernel grid=(512,1,1) block=(512,1,1) lds=36864
; @launch kernel=gemm1a_kernel grid=(224,1,1) block=(768,1,1) lds=133120
; @launch kernel=gemm2a_kernel grid=(256,1,1) block=(512,1,1) lds=139264
; @launch kernel=conv2_kernel grid=(512,1,1) block=(512,1,1) lds=36864
; @launch kernel=gemm1b_kernel grid=(224,1,1) block=(768,1,1) lds=133120
; @launch kernel=gemm2b_kernel grid=(256,1,1) block=(512,1,1) lds=139264
.amdgcn_target "amdgcn-amd-amdhsa--gfx950"
.text
.globl prep_kernel
.p2align 8
.type prep_kernel,@function
prep_kernel:
    s_load_dwordx16 s[4:19], s[0:1], 0
    s_load_dwordx8 s[20:27], s[0:1], 64
    s_load_dwordx2 s[28:29], s[0:1], 96
    s_cmp_ge_u32 s2, 696
    s_cbranch_scc1 prep_kernel_end
    s_waitcnt lgkmcnt(0)
    s_mov_b32 s32, s28
    s_mov_b32 s33, s29
    s_mov_b32 s34, 268435456
    s_mov_b32 s35, 0x00020000
    s_cmp_ge_u32 s2, 668
    s_cbranch_scc1 prep_kernel_pf
    s_cmp_ge_u32 s2, 640
    s_cbranch_scc1 prep_kernel_colsum
    s_cmp_ge_u32 s2, 512
    s_cbranch_scc1 prep_kernel_ln
    s_mov_b32 s36, s6
    s_mov_b32 s37, s7
    s_mov_b32 s38, 131072
    s_mov_b32 s39, 0x00020000
    s_mov_b32 s40, s8
    s_mov_b32 s41, s9
    s_mov_b32 s42, 131072
    s_mov_b32 s43, 0x00020000
    s_mov_b32 s44, s10
    s_mov_b32 s45, s11
    s_mov_b32 s46, 131072
    s_mov_b32 s47, 0x00020000
    s_mov_b32 s48, s12
    s_mov_b32 s49, s13
    s_mov_b32 s50, 131072
    s_mov_b32 s51, 0x00020000
    v_and_b32 v1, 63, v0
    v_and_b32 v2, 15, v0
    v_lshrrev_b32 v3, 4, v1
    v_lshrrev_b32 v4, 6, v0
    v_and_b32 v5, 127, v0
    v_lshlrev_b32 v5, 1, v5
    s_lshl_b32 s3, s2, 8
    buffer_load_ushort v8, v5, s[36:39], s3 offen
    buffer_load_ushort v9, v5, s[40:43], s3 offen
    buffer_load_ushort v10, v5, s[44:47], s3 offen
    buffer_load_ushort v11, v5, s[48:51], s3 offen
    s_lshr_b32 s3, s2, 1
    s_lshl_b32 s3, s3, 2
    s_add_u32 s14, s14, s3
    s_addc_u32 s15, s15, 0
    s_load_dword s60, s[14:15], 0
    v_lshlrev_b32 v6, 3, v2
    v_cvt_f32_u32 v24, v6
    v_lshrrev_b32 v6, 3, v2
    v_lshlrev_b32 v6, 7, v6
    v_and_b32 v7, 7, v2
    v_add_u32 v6, v6, v7
    v_cvt_f32_u32 v25, v6
    v_cmp_gt_u32 vcc, 8, v2
    v_lshrrev_b32 v6, 2, v2
    v_lshlrev_b32 v6, 7, v6
    v_and_b32 v7, 3, v2
    v_lshl_add_u32 v6, v7, 1, v6
    v_add_u32 v6, 256, v6
    v_and_b32 v7, 7, v2
    v_lshrrev_b32 v28, 1, v7
    v_lshlrev_b32 v28, 7, v28
    v_and_b32 v7, 1, v7
    v_lshl_add_u32 v28, v7, 2, v28
    v_add_u32 v28, 512, v28
    v_cndmask_b32 v6, v28, v6, vcc
    v_cvt_f32_u32 v26, v6
    v_lshlrev_b32 v6, 7, v2
    v_add_u32 v6, 1024, v6
    v_mov_b32 v7, 2048
    v_cndmask_b32 v6, v7, v6, vcc
    v_cvt_f32_u32 v27, v6
    v_lshlrev_b32 v6, 3, v0
    v_sub_u32 v6, 2047, v6
    v_subrev_u32 v7, 0, v6
    v_subrev_u32 v28, 1, v6
    v_cvt_f32_u32 v7, v7
    v_cvt_f32_u32 v28, v28
    v_cvt_pk_bf16_f32 v7, v7, v28
    v_and_b32 v28, 0xffff0000, v7
    v_lshlrev_b32 v7, 16, v7
    v_cvt_u32_f32 v7, v7
    v_cvt_u32_f32 v28, v28
    v_lshrrev_b32 v30, 3, v7
    v_lshrrev_b32 v31, 3, v28
    v_add_lshl_u32 v112, v7, v30, 2
    v_add_lshl_u32 v113, v28, v31, 2
    v_subrev_u32 v7, 2, v6
    v_subrev_u32 v28, 3, v6
    v_cvt_f32_u32 v7, v7
    v_cvt_f32_u32 v28, v28
    v_cvt_pk_bf16_f32 v7, v7, v28
    v_and_b32 v28, 0xffff0000, v7
    v_lshlrev_b32 v7, 16, v7
    v_cvt_u32_f32 v7, v7
    v_cvt_u32_f32 v28, v28
    v_lshrrev_b32 v30, 3, v7
    v_lshrrev_b32 v31, 3, v28
    v_add_lshl_u32 v114, v7, v30, 2
    v_add_lshl_u32 v115, v28, v31, 2
    v_subrev_u32 v7, 4, v6
    v_subrev_u32 v28, 5, v6
    v_cvt_f32_u32 v7, v7
    v_cvt_f32_u32 v28, v28
    v_cvt_pk_bf16_f32 v7, v7, v28
    v_and_b32 v28, 0xffff0000, v7
    v_lshlrev_b32 v7, 16, v7
    v_cvt_u32_f32 v7, v7
    v_cvt_u32_f32 v28, v28
    v_lshrrev_b32 v30, 3, v7
    v_lshrrev_b32 v31, 3, v28
    v_add_lshl_u32 v116, v7, v30, 2
    v_add_lshl_u32 v117, v28, v31, 2
    v_subrev_u32 v7, 6, v6
    v_subrev_u32 v28, 7, v6
    v_cvt_f32_u32 v7, v7
    v_cvt_f32_u32 v28, v28
    v_cvt_pk_bf16_f32 v7, v7, v28
    v_and_b32 v28, 0xffff0000, v7
    v_lshlrev_b32 v7, 16, v7
    v_cvt_u32_f32 v7, v7
    v_cvt_u32_f32 v28, v28
    v_lshrrev_b32 v30, 3, v7
    v_lshrrev_b32 v31, 3, v28
    v_add_lshl_u32 v118, v7, v30, 2
    v_add_lshl_u32 v119, v28, v31, 2
    v_cmp_gt_u32 vcc, 2, v3
    v_lshrrev_b32 v7, 1, v3
    v_lshlrev_b32 v7, 7, v7
    v_and_b32 v28, 1, v3
    v_lshl_add_u32 v7, v28, 2, v7
    v_add_u32 v7, v7, v4
    v_lshl_add_u32 v120, v2, 3, v7
    v_lshlrev_b32 v7, 7, v3
    v_lshl_add_u32 v7, v4, 1, v7
    v_add_u32 v7, 256, v7
    v_lshlrev_b32 v28, 8, v3
    v_lshrrev_b32 v30, 1, v4
    v_lshl_add_u32 v28, v30, 7, v28
    v_and_b32 v30, 1, v4
    v_lshl_add_u32 v28, v30, 2, v28
    v_cndmask_b32 v7, v28, v7, vcc
    v_lshl_add_u32 v121, v2, 3, v7
    v_lshl_add_u32 v7, v3, 2, v4
    v_lshlrev_b32 v7, 7, v7
    v_add_u32 v7, 1024, v7
    v_mov_b32 v28, 2048
    v_cndmask_b32 v7, v28, v7, vcc
    v_lshl_add_u32 v122, v2, 3, v7
    v_lshrrev_b32 v7, 3, v120
    v_add_lshl_u32 v120, v120, v7, 2
    v_lshrrev_b32 v7, 3, v121
    v_add_lshl_u32 v121, v121, v7, 2
    v_lshrrev_b32 v7, 3, v122
    v_add_lshl_u32 v122, v122, v7, 2
    s_waitcnt lgkmcnt(0)
    s_and_b32 s61, s2, 1
    s_lshl_b32 s61, s61, 4
    s_lshr_b32 s60, s60, s61
    s_lshl_b32 s60, s60, 16
    v_mov_b32 v6, s60
    v_mul_f32 v6, 0x3fb8aa3b, v6
    v_exp_f32 v6, v6
    s_nop 0
    v_cvt_pk_bf16_f32 v6, v6, v6
    v_lshlrev_b32 v29, 16, v6
    v_mov_b32 v100, 0
    v_mov_b32 v101, 0
    v_mov_b32 v102, 0
    v_mov_b32 v103, 0
    v_mov_b32 v104, 0
    v_mov_b32 v105, 0
    v_mov_b32 v106, 0
    v_mov_b32 v107, 0
    v_mov_b32 v108, 0
    v_mov_b32 v109, 0
    v_mov_b32 v110, 0
    v_mov_b32 v111, 0
    s_waitcnt vmcnt(0)
    v_lshlrev_b32 v64, 16, v8
    v_lshlrev_b32 v65, 16, v9
    v_lshlrev_b32 v66, 16, v10
    v_lshlrev_b32 v67, 16, v11
    v_mul_f32 v64, 0x3fb8aa3b, v64
    v_exp_f32 v64, v64
    v_mul_f32 v65, v65, v29
    v_cvt_pk_bf16_f32 v64, v64, v64
    v_lshlrev_b32 v64, 16, v64
    v_mul_f32 v64, v64, v29
    v_mul_f32 v32, 0xbfb8aa3b, v64
    v_mul_f32 v33, 0x3e22f983, v65
    v_mul_f32 v34, v66, v29
    v_mul_f32 v35, v67, v29
    v_lshlrev_b32 v5, 3, v5
    ds_write_b128 v5, v[32:35] offset:22080
    v_lshlrev_b32 v5, 9, v4
    v_lshl_add_u32 v5, v3, 7, v5
    s_waitcnt lgkmcnt(0)
    s_barrier
    ds_read_b128 v[32:35], v5 offset:22080
    s_mov_b32 s61, 0
prep_kernel_kloop:
    s_waitcnt lgkmcnt(0)
    v_mov_b32 v36, v32
    v_mov_b32 v37, v33
    v_mov_b32 v38, v34
    v_mov_b32 v39, v35
    v_add_u32 v5, 16, v5
    ds_read_b128 v[32:35], v5 offset:22080
    v_mul_f32 v64, v36, v24
    v_mul_f32 v65, v36, v25
    v_mul_f32 v66, v36, v26
    v_mul_f32 v67, v36, v27
    v_mul_f32 v68, v37, v24
    v_mul_f32 v69, v37, v25
    v_mul_f32 v70, v37, v26
    v_mul_f32 v71, v37, v27
    v_exp_f32 v72, v64
    v_exp_f32 v73, v65
    v_exp_f32 v74, v66
    v_exp_f32 v75, v67
    v_fract_f32 v68, v68
    v_fract_f32 v69, v69
    v_fract_f32 v70, v70
    v_fract_f32 v71, v71
    v_cos_f32 v76, v68
    v_cos_f32 v77, v69
    v_cos_f32 v78, v70
    v_cos_f32 v79, v71
    v_sin_f32 v80, v68
    v_sin_f32 v81, v69
    v_sin_f32 v82, v70
    v_sin_f32 v83, v71
    v_mul_f32 v76, v72, v76
    v_mul_f32 v77, v73, v77
    v_mul_f32 v78, v74, v78
    v_mul_f32 v79, v75, v79
    v_mul_f32 v80, v72, v80
    v_mul_f32 v81, v73, v81
    v_mul_f32 v82, v74, v82
    v_mul_f32 v83, v75, v83
    v_mul_f32 v84, v38, v76
    v_mul_f32 v85, v38, v80
    v_fma_f32 v84, -v39, v80, v84
    v_fma_f32 v85, -v39, v76, -v85
    v_cvt_pk_bf16_f32 v40, v77, v81
    v_cvt_pk_bf16_f32 v44, v78, v82
    v_cvt_pk_bf16_f32 v48, v79, v83
    v_cvt_pk_bf16_f32 v86, v84, v85
    v_lshlrev_b32 v64, 16, v40
    v_and_b32 v65, 0xffff0000, v40
    v_lshlrev_b32 v66, 16, v44
    v_and_b32 v67, 0xffff0000, v44
    v_lshlrev_b32 v68, 16, v48
    v_and_b32 v69, 0xffff0000, v48
    v_lshlrev_b32 v70, 16, v86
    v_and_b32 v71, 0xffff0000, v86
    v_sub_f32 v64, v77, v64
    v_sub_f32 v65, v81, v65
    v_sub_f32 v66, v78, v66
    v_sub_f32 v67, v82, v67
    v_sub_f32 v68, v79, v68
    v_sub_f32 v69, v83, v69
    v_sub_f32 v70, v84, v70
    v_sub_f32 v71, v85, v71
    v_cvt_pk_bf16_f32 v52, v64, v65
    v_cvt_pk_bf16_f32 v56, v66, v67
    v_cvt_pk_bf16_f32 v60, v68, v69
    v_cvt_pk_bf16_f32 v90, v70, v71
    s_waitcnt lgkmcnt(0)
    v_mov_b32 v36, v32
    v_mov_b32 v37, v33
    v_mov_b32 v38, v34
    v_mov_b32 v39, v35
    v_add_u32 v5, 16, v5
    ds_read_b128 v[32:35], v5 offset:22080
    v_mul_f32 v64, v36, v24
    v_mul_f32 v65, v36, v25
    v_mul_f32 v66, v36, v26
    v_mul_f32 v67, v36, v27
    v_mul_f32 v68, v37, v24
    v_mul_f32 v69, v37, v25
    v_mul_f32 v70, v37, v26
    v_mul_f32 v71, v37, v27
    v_exp_f32 v72, v64
    v_exp_f32 v73, v65
    v_exp_f32 v74, v66
    v_exp_f32 v75, v67
    v_fract_f32 v68, v68
    v_fract_f32 v69, v69
    v_fract_f32 v70, v70
    v_fract_f32 v71, v71
    v_cos_f32 v76, v68
    v_cos_f32 v77, v69
    v_cos_f32 v78, v70
    v_cos_f32 v79, v71
    v_sin_f32 v80, v68
    v_sin_f32 v81, v69
    v_sin_f32 v82, v70
    v_sin_f32 v83, v71
    v_mul_f32 v76, v72, v76
    v_mul_f32 v77, v73, v77
    v_mul_f32 v78, v74, v78
    v_mul_f32 v79, v75, v79
    v_mul_f32 v80, v72, v80
    v_mul_f32 v81, v73, v81
    v_mul_f32 v82, v74, v82
    v_mul_f32 v83, v75, v83
    v_mul_f32 v84, v38, v76
    v_mul_f32 v85, v38, v80
    v_fma_f32 v84, -v39, v80, v84
    v_fma_f32 v85, -v39, v76, -v85
    v_cvt_pk_bf16_f32 v41, v77, v81
    v_cvt_pk_bf16_f32 v45, v78, v82
    v_cvt_pk_bf16_f32 v49, v79, v83
    v_cvt_pk_bf16_f32 v87, v84, v85
    v_lshlrev_b32 v64, 16, v41
    v_and_b32 v65, 0xffff0000, v41
    v_lshlrev_b32 v66, 16, v45
    v_and_b32 v67, 0xffff0000, v45
    v_lshlrev_b32 v68, 16, v49
    v_and_b32 v69, 0xffff0000, v49
    v_lshlrev_b32 v70, 16, v87
    v_and_b32 v71, 0xffff0000, v87
    v_sub_f32 v64, v77, v64
    v_sub_f32 v65, v81, v65
    v_sub_f32 v66, v78, v66
    v_sub_f32 v67, v82, v67
    v_sub_f32 v68, v79, v68
    v_sub_f32 v69, v83, v69
    v_sub_f32 v70, v84, v70
    v_sub_f32 v71, v85, v71
    v_cvt_pk_bf16_f32 v53, v64, v65
    v_cvt_pk_bf16_f32 v57, v66, v67
    v_cvt_pk_bf16_f32 v61, v68, v69
    v_cvt_pk_bf16_f32 v91, v70, v71
    s_waitcnt lgkmcnt(0)
    v_mov_b32 v36, v32
    v_mov_b32 v37, v33
    v_mov_b32 v38, v34
    v_mov_b32 v39, v35
    v_add_u32 v5, 16, v5
    ds_read_b128 v[32:35], v5 offset:22080
    v_mul_f32 v64, v36, v24
    v_mul_f32 v65, v36, v25
    v_mul_f32 v66, v36, v26
    v_mul_f32 v67, v36, v27
    v_mul_f32 v68, v37, v24
    v_mul_f32 v69, v37, v25
    v_mul_f32 v70, v37, v26
    v_mul_f32 v71, v37, v27
    v_exp_f32 v72, v64
    v_exp_f32 v73, v65
    v_exp_f32 v74, v66
    v_exp_f32 v75, v67
    v_fract_f32 v68, v68
    v_fract_f32 v69, v69
    v_fract_f32 v70, v70
    v_fract_f32 v71, v71
    v_cos_f32 v76, v68
    v_cos_f32 v77, v69
    v_cos_f32 v78, v70
    v_cos_f32 v79, v71
    v_sin_f32 v80, v68
    v_sin_f32 v81, v69
    v_sin_f32 v82, v70
    v_sin_f32 v83, v71
    v_mul_f32 v76, v72, v76
    v_mul_f32 v77, v73, v77
    v_mul_f32 v78, v74, v78
    v_mul_f32 v79, v75, v79
    v_mul_f32 v80, v72, v80
    v_mul_f32 v81, v73, v81
    v_mul_f32 v82, v74, v82
    v_mul_f32 v83, v75, v83
    v_mul_f32 v84, v38, v76
    v_mul_f32 v85, v38, v80
    v_fma_f32 v84, -v39, v80, v84
    v_fma_f32 v85, -v39, v76, -v85
    v_cvt_pk_bf16_f32 v42, v77, v81
    v_cvt_pk_bf16_f32 v46, v78, v82
    v_cvt_pk_bf16_f32 v50, v79, v83
    v_cvt_pk_bf16_f32 v88, v84, v85
    v_lshlrev_b32 v64, 16, v42
    v_and_b32 v65, 0xffff0000, v42
    v_lshlrev_b32 v66, 16, v46
    v_and_b32 v67, 0xffff0000, v46
    v_lshlrev_b32 v68, 16, v50
    v_and_b32 v69, 0xffff0000, v50
    v_lshlrev_b32 v70, 16, v88
    v_and_b32 v71, 0xffff0000, v88
    v_sub_f32 v64, v77, v64
    v_sub_f32 v65, v81, v65
    v_sub_f32 v66, v78, v66
    v_sub_f32 v67, v82, v67
    v_sub_f32 v68, v79, v68
    v_sub_f32 v69, v83, v69
    v_sub_f32 v70, v84, v70
    v_sub_f32 v71, v85, v71
    v_cvt_pk_bf16_f32 v54, v64, v65
    v_cvt_pk_bf16_f32 v58, v66, v67
    v_cvt_pk_bf16_f32 v62, v68, v69
    v_cvt_pk_bf16_f32 v92, v70, v71
    s_waitcnt lgkmcnt(0)
    v_mov_b32 v36, v32
    v_mov_b32 v37, v33
    v_mov_b32 v38, v34
    v_mov_b32 v39, v35
    v_add_u32 v5, 16, v5
    ds_read_b128 v[32:35], v5 offset:22080
    v_mul_f32 v64, v36, v24
    v_mul_f32 v65, v36, v25
    v_mul_f32 v66, v36, v26
    v_mul_f32 v67, v36, v27
    v_mul_f32 v68, v37, v24
    v_mul_f32 v69, v37, v25
    v_mul_f32 v70, v37, v26
    v_mul_f32 v71, v37, v27
    v_exp_f32 v72, v64
    v_exp_f32 v73, v65
    v_exp_f32 v74, v66
    v_exp_f32 v75, v67
    v_fract_f32 v68, v68
    v_fract_f32 v69, v69
    v_fract_f32 v70, v70
    v_fract_f32 v71, v71
    v_cos_f32 v76, v68
    v_cos_f32 v77, v69
    v_cos_f32 v78, v70
    v_cos_f32 v79, v71
    v_sin_f32 v80, v68
    v_sin_f32 v81, v69
    v_sin_f32 v82, v70
    v_sin_f32 v83, v71
    v_mul_f32 v76, v72, v76
    v_mul_f32 v77, v73, v77
    v_mul_f32 v78, v74, v78
    v_mul_f32 v79, v75, v79
    v_mul_f32 v80, v72, v80
    v_mul_f32 v81, v73, v81
    v_mul_f32 v82, v74, v82
    v_mul_f32 v83, v75, v83
    v_mul_f32 v84, v38, v76
    v_mul_f32 v85, v38, v80
    v_fma_f32 v84, -v39, v80, v84
    v_fma_f32 v85, -v39, v76, -v85
    v_cvt_pk_bf16_f32 v43, v77, v81
    v_cvt_pk_bf16_f32 v47, v78, v82
    v_cvt_pk_bf16_f32 v51, v79, v83
    v_cvt_pk_bf16_f32 v89, v84, v85
    v_lshlrev_b32 v64, 16, v43
    v_and_b32 v65, 0xffff0000, v43
    v_lshlrev_b32 v66, 16, v47
    v_and_b32 v67, 0xffff0000, v47
    v_lshlrev_b32 v68, 16, v51
    v_and_b32 v69, 0xffff0000, v51
    v_lshlrev_b32 v70, 16, v89
    v_and_b32 v71, 0xffff0000, v89
    v_sub_f32 v64, v77, v64
    v_sub_f32 v65, v81, v65
    v_sub_f32 v66, v78, v66
    v_sub_f32 v67, v82, v67
    v_sub_f32 v68, v79, v68
    v_sub_f32 v69, v83, v69
    v_sub_f32 v70, v84, v70
    v_sub_f32 v71, v85, v71
    v_cvt_pk_bf16_f32 v55, v64, v65
    v_cvt_pk_bf16_f32 v59, v66, v67
    v_cvt_pk_bf16_f32 v63, v68, v69
    v_cvt_pk_bf16_f32 v93, v70, v71
    s_add_u32 s61, s61, 1
    s_cmp_lt_u32 s61, 2
    v_mfma_f32_16x16x32_bf16 v[100:103], v[40:43], v[86:89], v[100:103]
    v_mfma_f32_16x16x32_bf16 v[104:107], v[44:47], v[86:89], v[104:107]
    v_mfma_f32_16x16x32_bf16 v[108:111], v[48:51], v[86:89], v[108:111]
    v_mfma_f32_16x16x32_bf16 v[100:103], v[40:43], v[90:93], v[100:103]
    v_mfma_f32_16x16x32_bf16 v[104:107], v[44:47], v[90:93], v[104:107]
    v_mfma_f32_16x16x32_bf16 v[108:111], v[48:51], v[90:93], v[108:111]
    v_mfma_f32_16x16x32_bf16 v[100:103], v[52:55], v[86:89], v[100:103]
    v_mfma_f32_16x16x32_bf16 v[104:107], v[56:59], v[86:89], v[104:107]
    v_mfma_f32_16x16x32_bf16 v[108:111], v[60:63], v[86:89], v[108:111]
    s_cbranch_scc1 prep_kernel_kloop
    s_waitcnt lgkmcnt(0)
    v_mul_u32_u24 v6, 3072, v4
    v_lshl_add_u32 v6, v1, 2, v6
    v_lshlrev_b32 v7, 2, v0
    s_nop 7
    s_nop 1
    ds_write_b32 v6, v100 offset:0
    ds_write_b32 v6, v101 offset:256
    ds_write_b32 v6, v102 offset:512
    ds_write_b32 v6, v103 offset:768
    ds_write_b32 v6, v104 offset:1024
    ds_write_b32 v6, v105 offset:1280
    ds_write_b32 v6, v106 offset:1536
    ds_write_b32 v6, v107 offset:1792
    ds_write_b32 v6, v108 offset:2048
    ds_write_b32 v6, v109 offset:2304
    ds_write_b32 v6, v110 offset:2560
    ds_write_b32 v6, v111 offset:2816
    s_waitcnt lgkmcnt(0)
    s_barrier
    ds_read_b32 v32, v7 offset:0
    ds_read_b32 v33, v7 offset:3072
    ds_read_b32 v34, v7 offset:6144
    ds_read_b32 v35, v7 offset:9216
    ds_read_b32 v36, v7 offset:1024
    ds_read_b32 v37, v7 offset:4096
    ds_read_b32 v38, v7 offset:7168
    ds_read_b32 v39, v7 offset:10240
    ds_read_b32 v40, v7 offset:2048
    ds_read_b32 v41, v7 offset:5120
    ds_read_b32 v42, v7 offset:8192
    ds_read_b32 v43, v7 offset:11264
    s_waitcnt lgkmcnt(0)
    v_add_f32 v32, v32, v33
    v_add_f32 v34, v34, v35
    v_add_f32 v32, v32, v34
    v_add_f32 v32, v32, v32
    v_add_f32 v36, v36, v37
    v_add_f32 v38, v38, v39
    v_add_f32 v36, v36, v38
    v_add_f32 v36, v36, v36
    v_add_f32 v40, v40, v41
    v_add_f32 v42, v42, v43
    v_add_f32 v40, v40, v42
    v_add_f32 v40, v40, v40
    ds_write_b32 v120, v32 offset:12288
    ds_write_b32 v121, v36 offset:12288
    ds_write_b32 v122, v40 offset:12288
    s_waitcnt lgkmcnt(0)
    s_barrier
    ds_read_b32 v32, v112 offset:12288
    ds_read_b32 v33, v113 offset:12288
    ds_read_b32 v34, v114 offset:12288
    ds_read_b32 v35, v115 offset:12288
    ds_read_b32 v36, v116 offset:12288
    ds_read_b32 v37, v117 offset:12288
    ds_read_b32 v38, v118 offset:12288
    ds_read_b32 v39, v119 offset:12288
    s_mul_i32 s3, s2, 4224
    s_add_u32 s3, s3, 16777216
    v_lshlrev_b32 v6, 4, v0
    v_mov_b32 v68, 0
    v_mov_b32 v69, 0
    v_mov_b32 v70, 0
    v_mov_b32 v71, 0
    s_waitcnt lgkmcnt(0)
    v_cvt_pk_bf16_f32 v64, v32, v33
    v_cvt_pk_bf16_f32 v65, v34, v35
    v_cvt_pk_bf16_f32 v66, v36, v37
    v_cvt_pk_bf16_f32 v67, v38, v39
    buffer_store_dwordx4 v[64:67], v6, s[32:35], s3 offen sc0 sc1
    v_cmp_gt_u32 vcc, 8, v0
    s_and_saveexec_b64 s[62:63], vcc
    s_cbranch_execz prep_kernel_end
    v_add_u32 v6, 4096, v6
    buffer_store_dwordx4 v[68:71], v6, s[32:35], s3 offen
    s_branch prep_kernel_end
prep_kernel_ln:
    s_setprio 3
    s_mov_b32 s36, s4
    s_mov_b32 s37, s5
    s_mov_b32 s38, 2097152
    s_mov_b32 s39, 0x00020000
    s_sub_u32 s3, s2, 512
    v_and_b32 v1, 63, v0
    v_lshrrev_b32 v4, 6, v0
    v_lshlrev_b32 v5, 12, v4
    v_lshl_add_u32 v5, v1, 4, v5
    s_lshl_b32 s40, s3, 14
    buffer_load_dwordx4 v[8:11], v5, s[36:39], s40 offen offset:0
    buffer_load_dwordx4 v[12:15], v5, s[36:39], s40 offen offset:1024
    buffer_load_dwordx4 v[16:19], v5, s[36:39], s40 offen offset:2048
    buffer_load_dwordx4 v[20:23], v5, s[36:39], s40 offen offset:3072
    v_mul_u32_u24 v40, 4352, v4
    v_lshl_add_u32 v40, v1, 4, v40
    s_waitcnt vmcnt(3)
    ds_write_b128 v40, v[8:11] offset:0
    v_lshlrev_b32 v64, 16, v8
    v_and_b32 v65, 0xffff0000, v8
    v_lshlrev_b32 v66, 16, v9
    v_and_b32 v67, 0xffff0000, v9
    v_lshlrev_b32 v68, 16, v10
    v_and_b32 v69, 0xffff0000, v10
    v_lshlrev_b32 v70, 16, v11
    v_and_b32 v71, 0xffff0000, v11
    v_add_f32 v48, v64, v65
    v_add_f32 v52, v66, v67
    v_add_f32 v48, v48, v68
    v_add_f32 v52, v52, v69
    v_add_f32 v48, v48, v70
    v_add_f32 v52, v52, v71
    v_add_f32 v48, v48, v52
    s_waitcnt vmcnt(2)
    ds_write_b128 v40, v[12:15] offset:1088
    v_lshlrev_b32 v72, 16, v12
    v_and_b32 v73, 0xffff0000, v12
    v_lshlrev_b32 v74, 16, v13
    v_and_b32 v75, 0xffff0000, v13
    v_lshlrev_b32 v76, 16, v14
    v_and_b32 v77, 0xffff0000, v14
    v_lshlrev_b32 v78, 16, v15
    v_and_b32 v79, 0xffff0000, v15
    v_add_f32 v49, v72, v73
    v_add_f32 v53, v74, v75
    v_add_f32 v49, v49, v76
    v_add_f32 v53, v53, v77
    v_add_f32 v49, v49, v78
    v_add_f32 v53, v53, v79
    v_add_f32 v49, v49, v53
    s_waitcnt vmcnt(1)
    ds_write_b128 v40, v[16:19] offset:2176
    v_lshlrev_b32 v80, 16, v16
    v_and_b32 v81, 0xffff0000, v16
    v_lshlrev_b32 v82, 16, v17
    v_and_b32 v83, 0xffff0000, v17
    v_lshlrev_b32 v84, 16, v18
    v_and_b32 v85, 0xffff0000, v18
    v_lshlrev_b32 v86, 16, v19
    v_and_b32 v87, 0xffff0000, v19
    v_add_f32 v50, v80, v81
    v_add_f32 v54, v82, v83
    v_add_f32 v50, v50, v84
    v_add_f32 v54, v54, v85
    v_add_f32 v50, v50, v86
    v_add_f32 v54, v54, v87
    v_add_f32 v50, v50, v54
    s_waitcnt vmcnt(0)
    ds_write_b128 v40, v[20:23] offset:3264
    v_lshlrev_b32 v88, 16, v20
    v_and_b32 v89, 0xffff0000, v20
    v_lshlrev_b32 v90, 16, v21
    v_and_b32 v91, 0xffff0000, v21
    v_lshlrev_b32 v92, 16, v22
    v_and_b32 v93, 0xffff0000, v22
    v_lshlrev_b32 v94, 16, v23
    v_and_b32 v95, 0xffff0000, v23
    v_add_f32 v51, v88, v89
    v_add_f32 v55, v90, v91
    v_add_f32 v51, v51, v92
    v_add_f32 v55, v55, v93
    v_add_f32 v51, v51, v94
    v_add_f32 v55, v55, v95
    v_add_f32 v51, v51, v55
    s_nop 1
    v_add_f32_dpp v56, v48, v48 quad_perm:[1,0,3,2] row_mask:0xf bank_mask:0xf
    v_add_f32_dpp v57, v49, v49 quad_perm:[1,0,3,2] row_mask:0xf bank_mask:0xf
    v_add_f32_dpp v58, v50, v50 quad_perm:[1,0,3,2] row_mask:0xf bank_mask:0xf
    v_add_f32_dpp v59, v51, v51 quad_perm:[1,0,3,2] row_mask:0xf bank_mask:0xf
    v_add_f32_dpp v48, v56, v56 quad_perm:[2,3,0,1] row_mask:0xf bank_mask:0xf
    v_add_f32_dpp v49, v57, v57 quad_perm:[2,3,0,1] row_mask:0xf bank_mask:0xf
    v_add_f32_dpp v50, v58, v58 quad_perm:[2,3,0,1] row_mask:0xf bank_mask:0xf
    v_add_f32_dpp v51, v59, v59 quad_perm:[2,3,0,1] row_mask:0xf bank_mask:0xf
    v_add_f32_dpp v56, v48, v48 row_half_mirror row_mask:0xf bank_mask:0xf
    v_add_f32_dpp v57, v49, v49 row_half_mirror row_mask:0xf bank_mask:0xf
    v_add_f32_dpp v58, v50, v50 row_half_mirror row_mask:0xf bank_mask:0xf
    v_add_f32_dpp v59, v51, v51 row_half_mirror row_mask:0xf bank_mask:0xf
    v_add_f32_dpp v48, v56, v56 row_mirror row_mask:0xf bank_mask:0xf
    v_add_f32_dpp v49, v57, v57 row_mirror row_mask:0xf bank_mask:0xf
    v_add_f32_dpp v50, v58, v58 row_mirror row_mask:0xf bank_mask:0xf
    v_add_f32_dpp v51, v59, v59 row_mirror row_mask:0xf bank_mask:0xf
    v_mov_b32 v56, v48
    v_mov_b32 v57, v49
    v_mov_b32 v58, v50
    v_mov_b32 v59, v51
    s_nop 0
    v_permlane16_swap_b32 v56, v48
    v_permlane16_swap_b32 v57, v49
    v_permlane16_swap_b32 v58, v50
    v_permlane16_swap_b32 v59, v51
    v_add_f32 v48, v48, v56
    v_add_f32 v49, v49, v57
    v_add_f32 v50, v50, v58
    v_add_f32 v51, v51, v59
    v_mov_b32 v56, v48
    v_mov_b32 v57, v49
    v_mov_b32 v58, v50
    v_mov_b32 v59, v51
    s_nop 0
    v_permlane32_swap_b32 v56, v48
    v_permlane32_swap_b32 v57, v49
    v_permlane32_swap_b32 v58, v50
    v_permlane32_swap_b32 v59, v51
    v_add_f32 v48, v48, v56
    v_add_f32 v49, v49, v57
    v_add_f32 v50, v50, v58
    v_add_f32 v51, v51, v59
    v_mul_f32 v48, 0x3b000000, v48
    v_mul_f32 v49, 0x3b000000, v49
    v_mul_f32 v50, 0x3b000000, v50
    v_mul_f32 v51, 0x3b000000, v51
    v_sub_f32 v64, v64, v48
    v_sub_f32 v65, v65, v48
    v_sub_f32 v66, v66, v48
    v_sub_f32 v67, v67, v48
    v_sub_f32 v68, v68, v48
    v_sub_f32 v69, v69, v48
    v_sub_f32 v70, v70, v48
    v_sub_f32 v71, v71, v48
    v_sub_f32 v72, v72, v49
    v_sub_f32 v73, v73, v49
    v_sub_f32 v74, v74, v49
    v_sub_f32 v75, v75, v49
    v_sub_f32 v76, v76, v49
    v_sub_f32 v77, v77, v49
    v_sub_f32 v78, v78, v49
    v_sub_f32 v79, v79, v49
    v_sub_f32 v80, v80, v50
    v_sub_f32 v81, v81, v50
    v_sub_f32 v82, v82, v50
    v_sub_f32 v83, v83, v50
    v_sub_f32 v84, v84, v50
    v_sub_f32 v85, v85, v50
    v_sub_f32 v86, v86, v50
    v_sub_f32 v87, v87, v50
    v_sub_f32 v88, v88, v51
    v_sub_f32 v89, v89, v51
    v_sub_f32 v90, v90, v51
    v_sub_f32 v91, v91, v51
    v_sub_f32 v92, v92, v51
    v_sub_f32 v93, v93, v51
    v_sub_f32 v94, v94, v51
    v_sub_f32 v95, v95, v51
    v_mul_f32 v52, v64, v64
    v_mul_f32 v53, v72, v72
    v_mul_f32 v54, v80, v80
    v_mul_f32 v55, v88, v88
    v_fmac_f32 v52, v65, v65
    v_fmac_f32 v53, v73, v73
    v_fmac_f32 v54, v81, v81
    v_fmac_f32 v55, v89, v89
    v_fmac_f32 v52, v66, v66
    v_fmac_f32 v53, v74, v74
    v_fmac_f32 v54, v82, v82
    v_fmac_f32 v55, v90, v90
    v_fmac_f32 v52, v67, v67
    v_fmac_f32 v53, v75, v75
    v_fmac_f32 v54, v83, v83
    v_fmac_f32 v55, v91, v91
    v_fmac_f32 v52, v68, v68
    v_fmac_f32 v53, v76, v76
    v_fmac_f32 v54, v84, v84
    v_fmac_f32 v55, v92, v92
    v_fmac_f32 v52, v69, v69
    v_fmac_f32 v53, v77, v77
    v_fmac_f32 v54, v85, v85
    v_fmac_f32 v55, v93, v93
    v_fmac_f32 v52, v70, v70
    v_fmac_f32 v53, v78, v78
    v_fmac_f32 v54, v86, v86
    v_fmac_f32 v55, v94, v94
    v_fmac_f32 v52, v71, v71
    v_fmac_f32 v53, v79, v79
    v_fmac_f32 v54, v87, v87
    v_fmac_f32 v55, v95, v95
    s_nop 1
    v_add_f32_dpp v56, v52, v52 quad_perm:[1,0,3,2] row_mask:0xf bank_mask:0xf
    v_add_f32_dpp v57, v53, v53 quad_perm:[1,0,3,2] row_mask:0xf bank_mask:0xf
    v_add_f32_dpp v58, v54, v54 quad_perm:[1,0,3,2] row_mask:0xf bank_mask:0xf
    v_add_f32_dpp v59, v55, v55 quad_perm:[1,0,3,2] row_mask:0xf bank_mask:0xf
    v_add_f32_dpp v52, v56, v56 quad_perm:[2,3,0,1] row_mask:0xf bank_mask:0xf
    v_add_f32_dpp v53, v57, v57 quad_perm:[2,3,0,1] row_mask:0xf bank_mask:0xf
    v_add_f32_dpp v54, v58, v58 quad_perm:[2,3,0,1] row_mask:0xf bank_mask:0xf
    v_add_f32_dpp v55, v59, v59 quad_perm:[2,3,0,1] row_mask:0xf bank_mask:0xf
    v_add_f32_dpp v56, v52, v52 row_half_mirror row_mask:0xf bank_mask:0xf
    v_add_f32_dpp v57, v53, v53 row_half_mirror row_mask:0xf bank_mask:0xf
    v_add_f32_dpp v58, v54, v54 row_half_mirror row_mask:0xf bank_mask:0xf
    v_add_f32_dpp v59, v55, v55 row_half_mirror row_mask:0xf bank_mask:0xf
    v_add_f32_dpp v52, v56, v56 row_mirror row_mask:0xf bank_mask:0xf
    v_add_f32_dpp v53, v57, v57 row_mirror row_mask:0xf bank_mask:0xf
    v_add_f32_dpp v54, v58, v58 row_mirror row_mask:0xf bank_mask:0xf
    v_add_f32_dpp v55, v59, v59 row_mirror row_mask:0xf bank_mask:0xf
    v_mov_b32 v56, v52
    v_mov_b32 v57, v53
    v_mov_b32 v58, v54
    v_mov_b32 v59, v55
    s_nop 0
    v_permlane16_swap_b32 v56, v52
    v_permlane16_swap_b32 v57, v53
    v_permlane16_swap_b32 v58, v54
    v_permlane16_swap_b32 v59, v55
    v_add_f32 v52, v52, v56
    v_add_f32 v53, v53, v57
    v_add_f32 v54, v54, v58
    v_add_f32 v55, v55, v59
    v_mov_b32 v56, v52
    v_mov_b32 v57, v53
    v_mov_b32 v58, v54
    v_mov_b32 v59, v55
    s_nop 0
    v_permlane32_swap_b32 v56, v52
    v_permlane32_swap_b32 v57, v53
    v_permlane32_swap_b32 v58, v54
    v_permlane32_swap_b32 v59, v55
    v_add_f32 v52, v52, v56
    v_add_f32 v53, v53, v57
    v_add_f32 v54, v54, v58
    v_add_f32 v55, v55, v59
    v_mov_b32 v72, v48
    v_mov_b32 v73, v52
    v_cmp_eq_u32 vcc, 1, v1
    s_nop 1
    v_cndmask_b32 v72, v72, v49, vcc
    v_cndmask_b32 v73, v73, v53, vcc
    v_cmp_eq_u32 vcc, 2, v1
    s_nop 1
    v_cndmask_b32 v72, v72, v50, vcc
    v_cndmask_b32 v73, v73, v54, vcc
    v_cmp_eq_u32 vcc, 3, v1
    s_nop 1
    v_cndmask_b32 v72, v72, v51, vcc
    v_cndmask_b32 v73, v73, v55, vcc
    v_lshl_add_u32 v74, v4, 2, v1
    v_lshlrev_b32 v74, 2, v74
    s_lshl_b32 s41, s3, 6
    s_add_u32 s41, s41, 19922944
    v_mov_b32 v75, 0
    v_cmp_gt_u32 vcc, 4, v1
    s_and_saveexec_b64 s[62:63], vcc
    buffer_store_dword v72, v74, s[32:35], s41 offen
    s_add_u32 s42, s41, 8192
    buffer_store_dword v75, v74, s[32:35], s42 offen
    s_add_u32 s42, s41, 16384
    buffer_store_dword v73, v74, s[32:35], s42 offen
    s_mov_b64 exec, s[62:63]
    s_waitcnt lgkmcnt(0)
    s_barrier
    v_lshrrev_b32 v6, 4, v1
    v_lshrrev_b32 v7, 2, v1
    v_and_b32 v7, 3, v7
    v_and_b32 v28, 3, v1
    v_mul_u32_u24 v7, 1088, v7
    v_lshl_add_u32 v7, v6, 5, v7
    v_lshl_add_u32 v7, v28, 3, v7
    v_lshl_add_u32 v7, v4, 8, v7
    ds_read_b64_tr_b16 v[8:9], v7 offset:0
    ds_read_b64_tr_b16 v[10:11], v7 offset:4352
    ds_read_b64_tr_b16 v[12:13], v7 offset:8704
    ds_read_b64_tr_b16 v[14:15], v7 offset:13056
    ds_read_b64_tr_b16 v[16:17], v7 offset:128
    ds_read_b64_tr_b16 v[18:19], v7 offset:4480
    ds_read_b64_tr_b16 v[20:21], v7 offset:8832
    ds_read_b64_tr_b16 v[22:23], v7 offset:13184
    v_lshl_add_u32 v6, v4, 7, v1
    v_lshlrev_b32 v6, 12, v6
    s_lshl_b32 s41, s3, 5
    s_add_u32 s41, s41, 0
    s_add_u32 s42, s41, 262144
    s_waitcnt lgkmcnt(0)
    buffer_store_dwordx4 v[8:11], v6, s[32:35], s41 offen offset:0 sc0 sc1
    buffer_store_dwordx4 v[12:15], v6, s[32:35], s41 offen offset:16 sc0 sc1
    buffer_store_dwordx4 v[16:19], v6, s[32:35], s42 offen offset:0 sc0 sc1
    buffer_store_dwordx4 v[20:23], v6, s[32:35], s42 offen offset:16 sc0 sc1
    s_branch prep_kernel_end
prep_kernel_pf:
    s_mov_b32 s36, s22
    s_mov_b32 s37, s23
    s_mov_b32 s38, 1835008
    s_mov_b32 s39, 0x00020000
    s_sub_u32 s3, s2, 668
    s_lshl_b32 s40, s3, 16
    v_lshlrev_b32 v5, 4, v0
    buffer_load_dwordx4 v[8:11], v5, s[36:39], s40 offen
    s_add_u32 s40, s40, 4096
    buffer_load_dwordx4 v[12:15], v5, s[36:39], s40 offen
    s_add_u32 s40, s40, 4096
    buffer_load_dwordx4 v[16:19], v5, s[36:39], s40 offen
    s_add_u32 s40, s40, 4096
    buffer_load_dwordx4 v[20:23], v5, s[36:39], s40 offen
    s_add_u32 s40, s40, 4096
    buffer_load_dwordx4 v[24:27], v5, s[36:39], s40 offen
    s_add_u32 s40, s40, 4096
    buffer_load_dwordx4 v[28:31], v5, s[36:39], s40 offen
    s_add_u32 s40, s40, 4096
    buffer_load_dwordx4 v[32:35], v5, s[36:39], s40 offen
    s_add_u32 s40, s40, 4096
    buffer_load_dwordx4 v[36:39], v5, s[36:39], s40 offen
    s_add_u32 s40, s40, 4096
    buffer_load_dwordx4 v[40:43], v5, s[36:39], s40 offen
    s_add_u32 s40, s40, 4096
    buffer_load_dwordx4 v[44:47], v5, s[36:39], s40 offen
    s_add_u32 s40, s40, 4096
    buffer_load_dwordx4 v[48:51], v5, s[36:39], s40 offen
    s_add_u32 s40, s40, 4096
    buffer_load_dwordx4 v[52:55], v5, s[36:39], s40 offen
    s_add_u32 s40, s40, 4096
    buffer_load_dwordx4 v[56:59], v5, s[36:39], s40 offen
    s_add_u32 s40, s40, 4096
    buffer_load_dwordx4 v[60:63], v5, s[36:39], s40 offen
    s_add_u32 s40, s40, 4096
    buffer_load_dwordx4 v[64:67], v5, s[36:39], s40 offen
    s_add_u32 s40, s40, 4096
    buffer_load_dwordx4 v[68:71], v5, s[36:39], s40 offen
    s_add_u32 s40, s40, 4096
    s_waitcnt vmcnt(0)
    s_branch prep_kernel_end
prep_kernel_colsum:
    s_setprio 3
    s_mov_b32 s36, s20
    s_mov_b32 s37, s21
    s_mov_b32 s38, 1835008
    s_mov_b32 s39, 0x00020000
    s_sub_u32 s3, s2, 640
    v_and_b32 v1, 7, v0
    v_lshrrev_b32 v2, 3, v0
    v_mul_u32_u24 v5, 57344, v2
    v_lshl_add_u32 v5, v1, 4, v5
    s_lshl_b32 s40, s3, 7
    buffer_load_dwordx4 v[8:11], v5, s[36:39], s40 offen
    s_add_u32 s40, s40, 3584
    buffer_load_dwordx4 v[12:15], v5, s[36:39], s40 offen
    s_add_u32 s40, s40, 3584
    buffer_load_dwordx4 v[16:19], v5, s[36:39], s40 offen
    s_add_u32 s40, s40, 3584
    buffer_load_dwordx4 v[20:23], v5, s[36:39], s40 offen
    s_add_u32 s40, s40, 3584
    buffer_load_dwordx4 v[24:27], v5, s[36:39], s40 offen
    s_add_u32 s40, s40, 3584
    buffer_load_dwordx4 v[28:31], v5, s[36:39], s40 offen
    s_add_u32 s40, s40, 3584
    buffer_load_dwordx4 v[32:35], v5, s[36:39], s40 offen
    s_add_u32 s40, s40, 3584
    buffer_load_dwordx4 v[36:39], v5, s[36:39], s40 offen
    s_add_u32 s40, s40, 3584
    buffer_load_dwordx4 v[40:43], v5, s[36:39], s40 offen
    s_add_u32 s40, s40, 3584
    buffer_load_dwordx4 v[44:47], v5, s[36:39], s40 offen
    s_add_u32 s40, s40, 3584
    buffer_load_dwordx4 v[48:51], v5, s[36:39], s40 offen
    s_add_u32 s40, s40, 3584
    buffer_load_dwordx4 v[52:55], v5, s[36:39], s40 offen
    s_add_u32 s40, s40, 3584
    buffer_load_dwordx4 v[56:59], v5, s[36:39], s40 offen
    s_add_u32 s40, s40, 3584
    buffer_load_dwordx4 v[60:63], v5, s[36:39], s40 offen
    s_add_u32 s40, s40, 3584
    buffer_load_dwordx4 v[64:67], v5, s[36:39], s40 offen
    s_add_u32 s40, s40, 3584
    buffer_load_dwordx4 v[68:71], v5, s[36:39], s40 offen
    s_add_u32 s40, s40, 3584
    v_mov_b32 v80, 0
    v_mov_b32 v81, 0
    v_mov_b32 v82, 0
    v_mov_b32 v83, 0
    v_mov_b32 v84, 0
    v_mov_b32 v85, 0
    v_mov_b32 v86, 0
    v_mov_b32 v87, 0
    s_waitcnt vmcnt(15)
    v_lshlrev_b32 v72, 16, v8
    v_add_f32 v80, v80, v72
    v_and_b32 v72, 0xffff0000, v8
    v_add_f32 v81, v81, v72
    v_lshlrev_b32 v72, 16, v9
    v_add_f32 v82, v82, v72
    v_and_b32 v72, 0xffff0000, v9
    v_add_f32 v83, v83, v72
    v_lshlrev_b32 v72, 16, v10
    v_add_f32 v84, v84, v72
    v_and_b32 v72, 0xffff0000, v10
    v_add_f32 v85, v85, v72
    v_lshlrev_b32 v72, 16, v11
    v_add_f32 v86, v86, v72
    v_and_b32 v72, 0xffff0000, v11
    v_add_f32 v87, v87, v72
    s_waitcnt vmcnt(14)
    v_lshlrev_b32 v72, 16, v12
    v_add_f32 v80, v80, v72
    v_and_b32 v72, 0xffff0000, v12
    v_add_f32 v81, v81, v72
    v_lshlrev_b32 v72, 16, v13
    v_add_f32 v82, v82, v72
    v_and_b32 v72, 0xffff0000, v13
    v_add_f32 v83, v83, v72
    v_lshlrev_b32 v72, 16, v14
    v_add_f32 v84, v84, v72
    v_and_b32 v72, 0xffff0000, v14
    v_add_f32 v85, v85, v72
    v_lshlrev_b32 v72, 16, v15
    v_add_f32 v86, v86, v72
    v_and_b32 v72, 0xffff0000, v15
    v_add_f32 v87, v87, v72
    s_waitcnt vmcnt(13)
    v_lshlrev_b32 v72, 16, v16
    v_add_f32 v80, v80, v72
    v_and_b32 v72, 0xffff0000, v16
    v_add_f32 v81, v81, v72
    v_lshlrev_b32 v72, 16, v17
    v_add_f32 v82, v82, v72
    v_and_b32 v72, 0xffff0000, v17
    v_add_f32 v83, v83, v72
    v_lshlrev_b32 v72, 16, v18
    v_add_f32 v84, v84, v72
    v_and_b32 v72, 0xffff0000, v18
    v_add_f32 v85, v85, v72
    v_lshlrev_b32 v72, 16, v19
    v_add_f32 v86, v86, v72
    v_and_b32 v72, 0xffff0000, v19
    v_add_f32 v87, v87, v72
    s_waitcnt vmcnt(12)
    v_lshlrev_b32 v72, 16, v20
    v_add_f32 v80, v80, v72
    v_and_b32 v72, 0xffff0000, v20
    v_add_f32 v81, v81, v72
    v_lshlrev_b32 v72, 16, v21
    v_add_f32 v82, v82, v72
    v_and_b32 v72, 0xffff0000, v21
    v_add_f32 v83, v83, v72
    v_lshlrev_b32 v72, 16, v22
    v_add_f32 v84, v84, v72
    v_and_b32 v72, 0xffff0000, v22
    v_add_f32 v85, v85, v72
    v_lshlrev_b32 v72, 16, v23
    v_add_f32 v86, v86, v72
    v_and_b32 v72, 0xffff0000, v23
    v_add_f32 v87, v87, v72
    s_waitcnt vmcnt(11)
    v_lshlrev_b32 v72, 16, v24
    v_add_f32 v80, v80, v72
    v_and_b32 v72, 0xffff0000, v24
    v_add_f32 v81, v81, v72
    v_lshlrev_b32 v72, 16, v25
    v_add_f32 v82, v82, v72
    v_and_b32 v72, 0xffff0000, v25
    v_add_f32 v83, v83, v72
    v_lshlrev_b32 v72, 16, v26
    v_add_f32 v84, v84, v72
    v_and_b32 v72, 0xffff0000, v26
    v_add_f32 v85, v85, v72
    v_lshlrev_b32 v72, 16, v27
    v_add_f32 v86, v86, v72
    v_and_b32 v72, 0xffff0000, v27
    v_add_f32 v87, v87, v72
    s_waitcnt vmcnt(10)
    v_lshlrev_b32 v72, 16, v28
    v_add_f32 v80, v80, v72
    v_and_b32 v72, 0xffff0000, v28
    v_add_f32 v81, v81, v72
    v_lshlrev_b32 v72, 16, v29
    v_add_f32 v82, v82, v72
    v_and_b32 v72, 0xffff0000, v29
    v_add_f32 v83, v83, v72
    v_lshlrev_b32 v72, 16, v30
    v_add_f32 v84, v84, v72
    v_and_b32 v72, 0xffff0000, v30
    v_add_f32 v85, v85, v72
    v_lshlrev_b32 v72, 16, v31
    v_add_f32 v86, v86, v72
    v_and_b32 v72, 0xffff0000, v31
    v_add_f32 v87, v87, v72
    s_waitcnt vmcnt(9)
    v_lshlrev_b32 v72, 16, v32
    v_add_f32 v80, v80, v72
    v_and_b32 v72, 0xffff0000, v32
    v_add_f32 v81, v81, v72
    v_lshlrev_b32 v72, 16, v33
    v_add_f32 v82, v82, v72
    v_and_b32 v72, 0xffff0000, v33
    v_add_f32 v83, v83, v72
    v_lshlrev_b32 v72, 16, v34
    v_add_f32 v84, v84, v72
    v_and_b32 v72, 0xffff0000, v34
    v_add_f32 v85, v85, v72
    v_lshlrev_b32 v72, 16, v35
    v_add_f32 v86, v86, v72
    v_and_b32 v72, 0xffff0000, v35
    v_add_f32 v87, v87, v72
    s_waitcnt vmcnt(8)
    v_lshlrev_b32 v72, 16, v36
    v_add_f32 v80, v80, v72
    v_and_b32 v72, 0xffff0000, v36
    v_add_f32 v81, v81, v72
    v_lshlrev_b32 v72, 16, v37
    v_add_f32 v82, v82, v72
    v_and_b32 v72, 0xffff0000, v37
    v_add_f32 v83, v83, v72
    v_lshlrev_b32 v72, 16, v38
    v_add_f32 v84, v84, v72
    v_and_b32 v72, 0xffff0000, v38
    v_add_f32 v85, v85, v72
    v_lshlrev_b32 v72, 16, v39
    v_add_f32 v86, v86, v72
    v_and_b32 v72, 0xffff0000, v39
    v_add_f32 v87, v87, v72
    s_waitcnt vmcnt(7)
    v_lshlrev_b32 v72, 16, v40
    v_add_f32 v80, v80, v72
    v_and_b32 v72, 0xffff0000, v40
    v_add_f32 v81, v81, v72
    v_lshlrev_b32 v72, 16, v41
    v_add_f32 v82, v82, v72
    v_and_b32 v72, 0xffff0000, v41
    v_add_f32 v83, v83, v72
    v_lshlrev_b32 v72, 16, v42
    v_add_f32 v84, v84, v72
    v_and_b32 v72, 0xffff0000, v42
    v_add_f32 v85, v85, v72
    v_lshlrev_b32 v72, 16, v43
    v_add_f32 v86, v86, v72
    v_and_b32 v72, 0xffff0000, v43
    v_add_f32 v87, v87, v72
    s_waitcnt vmcnt(6)
    v_lshlrev_b32 v72, 16, v44
    v_add_f32 v80, v80, v72
    v_and_b32 v72, 0xffff0000, v44
    v_add_f32 v81, v81, v72
    v_lshlrev_b32 v72, 16, v45
    v_add_f32 v82, v82, v72
    v_and_b32 v72, 0xffff0000, v45
    v_add_f32 v83, v83, v72
    v_lshlrev_b32 v72, 16, v46
    v_add_f32 v84, v84, v72
    v_and_b32 v72, 0xffff0000, v46
    v_add_f32 v85, v85, v72
    v_lshlrev_b32 v72, 16, v47
    v_add_f32 v86, v86, v72
    v_and_b32 v72, 0xffff0000, v47
    v_add_f32 v87, v87, v72
    s_waitcnt vmcnt(5)
    v_lshlrev_b32 v72, 16, v48
    v_add_f32 v80, v80, v72
    v_and_b32 v72, 0xffff0000, v48
    v_add_f32 v81, v81, v72
    v_lshlrev_b32 v72, 16, v49
    v_add_f32 v82, v82, v72
    v_and_b32 v72, 0xffff0000, v49
    v_add_f32 v83, v83, v72
    v_lshlrev_b32 v72, 16, v50
    v_add_f32 v84, v84, v72
    v_and_b32 v72, 0xffff0000, v50
    v_add_f32 v85, v85, v72
    v_lshlrev_b32 v72, 16, v51
    v_add_f32 v86, v86, v72
    v_and_b32 v72, 0xffff0000, v51
    v_add_f32 v87, v87, v72
    s_waitcnt vmcnt(4)
    v_lshlrev_b32 v72, 16, v52
    v_add_f32 v80, v80, v72
    v_and_b32 v72, 0xffff0000, v52
    v_add_f32 v81, v81, v72
    v_lshlrev_b32 v72, 16, v53
    v_add_f32 v82, v82, v72
    v_and_b32 v72, 0xffff0000, v53
    v_add_f32 v83, v83, v72
    v_lshlrev_b32 v72, 16, v54
    v_add_f32 v84, v84, v72
    v_and_b32 v72, 0xffff0000, v54
    v_add_f32 v85, v85, v72
    v_lshlrev_b32 v72, 16, v55
    v_add_f32 v86, v86, v72
    v_and_b32 v72, 0xffff0000, v55
    v_add_f32 v87, v87, v72
    s_waitcnt vmcnt(3)
    v_lshlrev_b32 v72, 16, v56
    v_add_f32 v80, v80, v72
    v_and_b32 v72, 0xffff0000, v56
    v_add_f32 v81, v81, v72
    v_lshlrev_b32 v72, 16, v57
    v_add_f32 v82, v82, v72
    v_and_b32 v72, 0xffff0000, v57
    v_add_f32 v83, v83, v72
    v_lshlrev_b32 v72, 16, v58
    v_add_f32 v84, v84, v72
    v_and_b32 v72, 0xffff0000, v58
    v_add_f32 v85, v85, v72
    v_lshlrev_b32 v72, 16, v59
    v_add_f32 v86, v86, v72
    v_and_b32 v72, 0xffff0000, v59
    v_add_f32 v87, v87, v72
    s_waitcnt vmcnt(2)
    v_lshlrev_b32 v72, 16, v60
    v_add_f32 v80, v80, v72
    v_and_b32 v72, 0xffff0000, v60
    v_add_f32 v81, v81, v72
    v_lshlrev_b32 v72, 16, v61
    v_add_f32 v82, v82, v72
    v_and_b32 v72, 0xffff0000, v61
    v_add_f32 v83, v83, v72
    v_lshlrev_b32 v72, 16, v62
    v_add_f32 v84, v84, v72
    v_and_b32 v72, 0xffff0000, v62
    v_add_f32 v85, v85, v72
    v_lshlrev_b32 v72, 16, v63
    v_add_f32 v86, v86, v72
    v_and_b32 v72, 0xffff0000, v63
    v_add_f32 v87, v87, v72
    s_waitcnt vmcnt(1)
    v_lshlrev_b32 v72, 16, v64
    v_add_f32 v80, v80, v72
    v_and_b32 v72, 0xffff0000, v64
    v_add_f32 v81, v81, v72
    v_lshlrev_b32 v72, 16, v65
    v_add_f32 v82, v82, v72
    v_and_b32 v72, 0xffff0000, v65
    v_add_f32 v83, v83, v72
    v_lshlrev_b32 v72, 16, v66
    v_add_f32 v84, v84, v72
    v_and_b32 v72, 0xffff0000, v66
    v_add_f32 v85, v85, v72
    v_lshlrev_b32 v72, 16, v67
    v_add_f32 v86, v86, v72
    v_and_b32 v72, 0xffff0000, v67
    v_add_f32 v87, v87, v72
    s_waitcnt vmcnt(0)
    v_lshlrev_b32 v72, 16, v68
    v_add_f32 v80, v80, v72
    v_and_b32 v72, 0xffff0000, v68
    v_add_f32 v81, v81, v72
    v_lshlrev_b32 v72, 16, v69
    v_add_f32 v82, v82, v72
    v_and_b32 v72, 0xffff0000, v69
    v_add_f32 v83, v83, v72
    v_lshlrev_b32 v72, 16, v70
    v_add_f32 v84, v84, v72
    v_and_b32 v72, 0xffff0000, v70
    v_add_f32 v85, v85, v72
    v_lshlrev_b32 v72, 16, v71
    v_add_f32 v86, v86, v72
    v_and_b32 v72, 0xffff0000, v71
    v_add_f32 v87, v87, v72
    v_lshlrev_b32 v6, 5, v0
    ds_write_b128 v6, v[80:83]
    ds_write_b128 v6, v[84:87] offset:16
    s_waitcnt lgkmcnt(0)
    s_barrier
    v_cmp_gt_u32 vcc, 64, v0
    s_and_saveexec_b64 s[62:63], vcc
    s_cbranch_execz prep_kernel_end
    v_lshlrev_b32 v6, 2, v0
    ds_read_b32 v8, v6 offset:0
    ds_read_b32 v9, v6 offset:256
    ds_read_b32 v10, v6 offset:512
    ds_read_b32 v11, v6 offset:768
    ds_read_b32 v12, v6 offset:1024
    ds_read_b32 v13, v6 offset:1280
    ds_read_b32 v14, v6 offset:1536
    ds_read_b32 v15, v6 offset:1792
    ds_read_b32 v16, v6 offset:2048
    ds_read_b32 v17, v6 offset:2304
    ds_read_b32 v18, v6 offset:2560
    ds_read_b32 v19, v6 offset:2816
    ds_read_b32 v20, v6 offset:3072
    ds_read_b32 v21, v6 offset:3328
    ds_read_b32 v22, v6 offset:3584
    ds_read_b32 v23, v6 offset:3840
    ds_read_b32 v24, v6 offset:4096
    ds_read_b32 v25, v6 offset:4352
    ds_read_b32 v26, v6 offset:4608
    ds_read_b32 v27, v6 offset:4864
    ds_read_b32 v28, v6 offset:5120
    ds_read_b32 v29, v6 offset:5376
    ds_read_b32 v30, v6 offset:5632
    ds_read_b32 v31, v6 offset:5888
    ds_read_b32 v32, v6 offset:6144
    ds_read_b32 v33, v6 offset:6400
    ds_read_b32 v34, v6 offset:6656
    ds_read_b32 v35, v6 offset:6912
    ds_read_b32 v36, v6 offset:7168
    ds_read_b32 v37, v6 offset:7424
    ds_read_b32 v38, v6 offset:7680
    ds_read_b32 v39, v6 offset:7936
    s_waitcnt lgkmcnt(0)
    v_add_f32 v8, v8, v9
    v_add_f32 v8, v8, v10
    v_add_f32 v8, v8, v11
    v_add_f32 v8, v8, v12
    v_add_f32 v8, v8, v13
    v_add_f32 v8, v8, v14
    v_add_f32 v8, v8, v15
    v_add_f32 v8, v8, v16
    v_add_f32 v8, v8, v17
    v_add_f32 v8, v8, v18
    v_add_f32 v8, v8, v19
    v_add_f32 v8, v8, v20
    v_add_f32 v8, v8, v21
    v_add_f32 v8, v8, v22
    v_add_f32 v8, v8, v23
    v_add_f32 v8, v8, v24
    v_add_f32 v8, v8, v25
    v_add_f32 v8, v8, v26
    v_add_f32 v8, v8, v27
    v_add_f32 v8, v8, v28
    v_add_f32 v8, v8, v29
    v_add_f32 v8, v8, v30
    v_add_f32 v8, v8, v31
    v_add_f32 v8, v8, v32
    v_add_f32 v8, v8, v33
    v_add_f32 v8, v8, v34
    v_add_f32 v8, v8, v35
    v_add_f32 v8, v8, v36
    v_add_f32 v8, v8, v37
    v_add_f32 v8, v8, v38
    v_add_f32 v8, v8, v39
    s_lshl_b32 s41, s3, 8
    s_add_u32 s41, s41, 20054016
    buffer_store_dword v8, v6, s[32:35], s41 offen
prep_kernel_end:
    s_endpgm
.text
.globl conv1_kernel
.p2align 8
.type conv1_kernel,@function
conv1_kernel:
    s_load_dwordx16 s[4:19], s[0:1], 0
    s_load_dwordx8 s[20:27], s[0:1], 64
    s_load_dwordx2 s[28:29], s[0:1], 96
    s_cmp_ge_u32 s2, 512
    s_cbranch_scc1 conv1_kernel_end
    v_lshlrev_b32 v1, 4, v0
    v_lshlrev_b32 v2, 3, v0
    v_lshrrev_b32 v45, 6, v0
    s_lshl_b32 s3, s2, 12
    s_add_u32 s36, s3, 0
    s_add_u32 s37, s3, 2097152
    s_mul_i32 s38, s2, 4224
    s_add_u32 s38, s38, 16777216
    s_mov_b32 s39, 19922944
    s_mov_b32 s40, 19931136
    s_mov_b32 s41, 19939328
    v_readfirstlane_b32 s46, v45
    s_waitcnt lgkmcnt(0)
    s_mov_b32 s32, s28
    s_mov_b32 s33, s29
    s_mov_b32 s34, 268435456
    s_mov_b32 s35, 0x00020000
    buffer_load_dwordx4 v[16:19], v1, s[32:35], s39 offen
    buffer_load_dwordx4 v[20:23], v1, s[32:35], s40 offen
    buffer_load_dwordx4 v[24:27], v1, s[32:35], s41 offen
    buffer_load_dwordx2 v[4:5], v2, s[32:35], s36 offen
    s_lshr_b32 s3, s2, 1
    s_lshl_b32 s3, s3, 2
    s_add_u32 s16, s16, s3
    s_addc_u32 s17, s17, 0
    s_load_dword s42, s[16:17], 0
    v_mov_b32 v40, 0
    v_mov_b32 v41, 0
    v_mov_b32 v42, 0
    v_mov_b32 v43, 0
    s_cmp_ge_u32 s46, 4
    s_cbranch_scc1 conv1_kernel_nok
    buffer_load_dwordx4 v[8:11], v1, s[32:35], s38 offen
    buffer_load_dwordx2 v[12:13], v1, s[32:35], s38 offen offset:16
conv1_kernel_nok:
    v_and_b32 v44, 63, v0
    v_and_b32 v46, 31, v44
    v_lshrrev_b32 v47, 5, v44
    v_and_b32 v48, 3, v46
    v_sub_u32 v48, 3, v48
    v_mul_u32_u24 v48, 4160, v48
    v_lshrrev_b32 v49, 2, v46
    v_lshlrev_b32 v49, 3, v49
    v_sub_u32 v48, v48, v49
    v_lshl_add_u32 v48, v47, 4, v48
    v_lshlrev_b32 v49, 9, v45
    v_sub_u32 v48, v48, v49
    v_add_u32 v48, 1592, v48
    v_lshlrev_b32 v49, 3, v45
    v_sub_u32 v49, v46, v49
    v_add_u32 v49, 25, v49
    v_mul_u32_u24 v49, 80, v49
    v_lshl_add_u32 v49, v47, 4, v49
    v_add_u32 v49, 16640, v49
    v_lshrrev_b32 v50, 3, v0
    v_and_b32 v51, 7, v0
    v_mul_u32_u24 v57, 80, v50
    v_lshl_add_u32 v57, v51, 3, v57
    v_mul_u32_u24 v58, 144, v50
    v_lshl_add_u32 v58, v51, 4, v58
    v_mul_u32_u24 v59, 9216, v45
    v_mul_u32_u24 v50, 144, v46
    v_add_u32 v59, v59, v50
    v_lshl_add_u32 v59, v47, 4, v59
    v_mov_b32 v64, 0
    v_mov_b32 v65, 0
    v_mov_b32 v66, 0
    v_mov_b32 v67, 0
    v_mov_b32 v68, 0
    v_mov_b32 v69, 0
    v_mov_b32 v70, 0
    v_mov_b32 v71, 0
    v_mov_b32 v72, 0
    v_mov_b32 v73, 0
    v_mov_b32 v74, 0
    v_mov_b32 v75, 0
    v_mov_b32 v76, 0
    v_mov_b32 v77, 0
    v_mov_b32 v78, 0
    v_mov_b32 v79, 0
    v_mov_b32 v80, 0
    v_mov_b32 v81, 0
    v_mov_b32 v82, 0
    v_mov_b32 v83, 0
    v_mov_b32 v84, 0
    v_mov_b32 v85, 0
    v_mov_b32 v86, 0
    v_mov_b32 v87, 0
    v_mov_b32 v88, 0
    v_mov_b32 v89, 0
    v_mov_b32 v90, 0
    v_mov_b32 v91, 0
    v_mov_b32 v92, 0
    v_mov_b32 v93, 0
    v_mov_b32 v94, 0
    v_mov_b32 v95, 0
    s_cmp_ge_u32 s46, 4
    s_cbranch_scc1 conv1_kernel_hi
    v_cmp_gt_u32 vcc, 4, v0
    s_and_saveexec_b64 s[44:45], vcc
    ds_write_b128 v1, v[40:43] offset:4096
    ds_write_b128 v1, v[40:43] offset:8256
    ds_write_b128 v1, v[40:43] offset:12416
    ds_write_b128 v1, v[40:43] offset:16576
    s_mov_b64 exec, s[44:45]
    s_waitcnt vmcnt(0)
    ds_write_b128 v1, v[8:11] offset:0
    v_alignbyte_b32 v52, v9, v8, 2
    v_alignbyte_b32 v53, v10, v9, 2
    v_alignbyte_b32 v54, v11, v10, 2
    v_alignbyte_b32 v55, v12, v11, 2
    v_alignbyte_b32 v56, v13, v12, 2
    v_mov_b32 v60, v9
    v_mov_b32 v61, v10
    v_mov_b32 v62, v11
    v_mov_b32 v63, v12
    ds_write_b128 v1, v[52:55] offset:4160
    ds_write_b128 v1, v[60:63] offset:8320
    v_mov_b32 v8, v53
    v_mov_b32 v9, v54
    v_mov_b32 v10, v55
    v_mov_b32 v11, v56
    ds_write_b128 v1, v[8:11] offset:12480
    s_branch conv1_kernel_join
conv1_kernel_hi:
    v_cmp_gt_u32 vcc, 416, v0
    s_and_saveexec_b64 s[44:45], vcc
    ds_write_b128 v1, v[40:43] offset:12544
    s_mov_b64 exec, s[44:45]
conv1_kernel_join:
    s_waitcnt vmcnt(1)
    v_mul_f32 v20, 0x3b000000, v20
    v_mul_f32 v24, 0x3b000000, v24
    v_add_f32 v16, v16, v20
    v_fma_f32 v24, -v20, v20, v24
    v_max_f32 v24, 0, v24
    v_mul_f32 v21, 0x3b000000, v21
    v_mul_f32 v25, 0x3b000000, v25
    v_add_f32 v17, v17, v21
    v_fma_f32 v25, -v21, v21, v25
    v_max_f32 v25, 0, v25
    v_mul_f32 v22, 0x3b000000, v22
    v_mul_f32 v26, 0x3b000000, v26
    v_add_f32 v18, v18, v22
    v_fma_f32 v26, -v22, v22, v26
    v_max_f32 v26, 0, v26
    v_mul_f32 v23, 0x3b000000, v23
    v_mul_f32 v27, 0x3b000000, v27
    v_add_f32 v19, v19, v23
    v_fma_f32 v27, -v23, v23, v27
    v_max_f32 v27, 0, v27
    v_cvt_pk_bf16_f32 v50, v16, v17
    v_lshlrev_b32 v16, 16, v50
    v_and_b32 v17, 0xffff0000, v50
    v_cvt_pk_bf16_f32 v51, v24, v25
    v_lshlrev_b32 v24, 16, v51
    v_and_b32 v25, 0xffff0000, v51
    v_cvt_pk_bf16_f32 v50, v18, v19
    v_lshlrev_b32 v18, 16, v50
    v_and_b32 v19, 0xffff0000, v50
    v_cvt_pk_bf16_f32 v51, v26, v27
    v_lshlrev_b32 v26, 16, v51
    v_and_b32 v27, 0xffff0000, v51
    v_add_f32 v24, 0x3727c5ac, v24
    v_add_f32 v25, 0x3727c5ac, v25
    v_add_f32 v26, 0x3727c5ac, v26
    v_add_f32 v27, 0x3727c5ac, v27
    v_cvt_pk_bf16_f32 v51, v24, v25
    v_lshlrev_b32 v24, 16, v51
    v_and_b32 v25, 0xffff0000, v51
    v_cvt_pk_bf16_f32 v51, v26, v27
    v_lshlrev_b32 v26, 16, v51
    v_and_b32 v27, 0xffff0000, v51
    v_sqrt_f32 v20, v24
    v_sqrt_f32 v21, v25
    v_sqrt_f32 v22, v26
    v_sqrt_f32 v23, v27
    s_nop 0
    v_cvt_pk_bf16_f32 v51, v20, v21
    v_lshlrev_b32 v20, 16, v51
    v_and_b32 v21, 0xffff0000, v51
    v_cvt_pk_bf16_f32 v51, v22, v23
    v_lshlrev_b32 v22, 16, v51
    v_and_b32 v23, 0xffff0000, v51
    v_rcp_f32 v24, v20
    v_rcp_f32 v25, v21
    v_rcp_f32 v26, v22
    v_rcp_f32 v27, v23
    s_waitcnt vmcnt(0)
    v_lshlrev_b32 v28, 16, v4
    v_and_b32 v29, 0xffff0000, v4
    v_lshlrev_b32 v30, 16, v5
    v_and_b32 v31, 0xffff0000, v5
    v_sub_f32 v32, v28, v16
    v_sub_f32 v33, v29, v17
    v_sub_f32 v34, v30, v18
    v_sub_f32 v35, v31, v19
    v_cvt_pk_bf16_f32 v50, v32, v33
    v_lshlrev_b32 v32, 16, v50
    v_and_b32 v33, 0xffff0000, v50
    v_cvt_pk_bf16_f32 v50, v34, v35
    v_lshlrev_b32 v34, 16, v50
    v_and_b32 v35, 0xffff0000, v50
    v_mul_f32 v36, v32, v24
    v_mul_f32 v37, v33, v25
    v_mul_f32 v38, v34, v26
    v_mul_f32 v39, v35, v27
    v_fma_f32 v32, -v36, v20, v32
    v_fma_f32 v33, -v37, v21, v33
    v_fma_f32 v34, -v38, v22, v34
    v_fma_f32 v35, -v39, v23, v35
    v_fmac_f32 v36, v32, v24
    v_fmac_f32 v37, v33, v25
    v_fmac_f32 v38, v34, v26
    v_fmac_f32 v39, v35, v27
    v_cvt_pk_bf16_f32 v6, v36, v37
    v_lshlrev_b32 v36, 16, v6
    v_and_b32 v37, 0xffff0000, v6
    v_cvt_pk_bf16_f32 v7, v38, v39
    v_lshlrev_b32 v38, 16, v7
    v_and_b32 v39, 0xffff0000, v7
    ds_write_b64 v57, v[6:7] offset:19200
    s_waitcnt lgkmcnt(0)
    s_barrier
    s_cmp_ge_u32 s46, 4
    s_cbranch_scc1 conv1_kernel_skipmain
    ds_read_b64 v[96:97], v48 offset:2496
    ds_read_b64 v[98:99], v48 offset:2504
    ds_read_b128 v[108:111], v49 offset:3120
    ds_read_b128 v[104:107], v49 offset:560
    ds_read_b64 v[100:101], v48 offset:448
    ds_read_b64 v[102:103], v48 offset:456
    s_waitcnt lgkmcnt(3)
    v_mfma_f32_32x32x16_bf16 v[80:95], v[96:99], v[108:111], v[80:95]
    ds_read_b64 v[112:113], v48 offset:2528
    ds_read_b64 v[114:115], v48 offset:2536
    ds_read_b128 v[124:127], v49 offset:3152
    s_waitcnt lgkmcnt(5)
    v_mfma_f32_32x32x16_bf16 v[64:79], v[96:99], v[104:107], v[64:79]
    ds_read_b128 v[120:123], v49 offset:592
    s_waitcnt lgkmcnt(4)
    v_mfma_f32_32x32x16_bf16 v[80:95], v[100:103], v[104:107], v[80:95]
    ds_read_b64 v[116:117], v48 offset:480
    ds_read_b64 v[118:119], v48 offset:488
    s_waitcnt lgkmcnt(3)
    v_mfma_f32_32x32x16_bf16 v[80:95], v[112:115], v[124:127], v[80:95]
    ds_read_b64 v[96:97], v48 offset:2432
    ds_read_b64 v[98:99], v48 offset:2440
    ds_read_b128 v[108:111], v49 offset:3040
    s_waitcnt lgkmcnt(5)
    v_mfma_f32_32x32x16_bf16 v[64:79], v[112:115], v[120:123], v[64:79]
    ds_read_b128 v[104:107], v49 offset:480
    s_waitcnt lgkmcnt(4)
    v_mfma_f32_32x32x16_bf16 v[80:95], v[116:119], v[120:123], v[80:95]
    ds_read_b64 v[100:101], v48 offset:384
    ds_read_b64 v[102:103], v48 offset:392
    s_waitcnt lgkmcnt(3)
    v_mfma_f32_32x32x16_bf16 v[80:95], v[96:99], v[108:111], v[80:95]
    ds_read_b64 v[112:113], v48 offset:2464
    ds_read_b64 v[114:115], v48 offset:2472
    ds_read_b128 v[124:127], v49 offset:3072
    s_waitcnt lgkmcnt(5)
    v_mfma_f32_32x32x16_bf16 v[64:79], v[96:99], v[104:107], v[64:79]
    ds_read_b128 v[120:123], v49 offset:512
    s_waitcnt lgkmcnt(4)
    v_mfma_f32_32x32x16_bf16 v[80:95], v[100:103], v[104:107], v[80:95]
    ds_read_b64 v[116:117], v48 offset:416
    ds_read_b64 v[118:119], v48 offset:424
    s_waitcnt lgkmcnt(3)
    v_mfma_f32_32x32x16_bf16 v[80:95], v[112:115], v[124:127], v[80:95]
    ds_read_b64 v[96:97], v48 offset:2368
    ds_read_b64 v[98:99], v48 offset:2376
    ds_read_b128 v[108:111], v49 offset:2960
    s_waitcnt lgkmcnt(5)
    v_mfma_f32_32x32x16_bf16 v[64:79], v[112:115], v[120:123], v[64:79]
    ds_read_b128 v[104:107], v49 offset:400
    s_waitcnt lgkmcnt(4)
    v_mfma_f32_32x32x16_bf16 v[80:95], v[116:119], v[120:123], v[80:95]
    ds_read_b64 v[100:101], v48 offset:320
    ds_read_b64 v[102:103], v48 offset:328
    s_waitcnt lgkmcnt(3)
    v_mfma_f32_32x32x16_bf16 v[80:95], v[96:99], v[108:111], v[80:95]
    ds_read_b64 v[112:113], v48 offset:2400
    ds_read_b64 v[114:115], v48 offset:2408
    ds_read_b128 v[124:127], v49 offset:2992
    s_waitcnt lgkmcnt(5)
    v_mfma_f32_32x32x16_bf16 v[64:79], v[96:99], v[104:107], v[64:79]
    ds_read_b128 v[120:123], v49 offset:432
    s_waitcnt lgkmcnt(4)
    v_mfma_f32_32x32x16_bf16 v[80:95], v[100:103], v[104:107], v[80:95]
    ds_read_b64 v[116:117], v48 offset:352
    ds_read_b64 v[118:119], v48 offset:360
    s_waitcnt lgkmcnt(3)
    v_mfma_f32_32x32x16_bf16 v[80:95], v[112:115], v[124:127], v[80:95]
    ds_read_b64 v[96:97], v48 offset:2304
    ds_read_b64 v[98:99], v48 offset:2312
    ds_read_b128 v[108:111], v49 offset:2880
    s_waitcnt lgkmcnt(5)
    v_mfma_f32_32x32x16_bf16 v[64:79], v[112:115], v[120:123], v[64:79]
    ds_read_b128 v[104:107], v49 offset:320
    s_waitcnt lgkmcnt(4)
    v_mfma_f32_32x32x16_bf16 v[80:95], v[116:119], v[120:123], v[80:95]
    ds_read_b64 v[100:101], v48 offset:256
    ds_read_b64 v[102:103], v48 offset:264
    s_waitcnt lgkmcnt(3)
    v_mfma_f32_32x32x16_bf16 v[80:95], v[96:99], v[108:111], v[80:95]
    ds_read_b64 v[112:113], v48 offset:2336
    ds_read_b64 v[114:115], v48 offset:2344
    ds_read_b128 v[124:127], v49 offset:2912
    s_waitcnt lgkmcnt(5)
    v_mfma_f32_32x32x16_bf16 v[64:79], v[96:99], v[104:107], v[64:79]
    ds_read_b128 v[120:123], v49 offset:352
    s_waitcnt lgkmcnt(4)
    v_mfma_f32_32x32x16_bf16 v[80:95], v[100:103], v[104:107], v[80:95]
    ds_read_b64 v[116:117], v48 offset:288
    ds_read_b64 v[118:119], v48 offset:296
    s_waitcnt lgkmcnt(3)
    v_mfma_f32_32x32x16_bf16 v[80:95], v[112:115], v[124:127], v[80:95]
    ds_read_b64 v[96:97], v48 offset:2240
    ds_read_b64 v[98:99], v48 offset:2248
    ds_read_b128 v[108:111], v49 offset:2800
    s_waitcnt lgkmcnt(5)
    v_mfma_f32_32x32x16_bf16 v[64:79], v[112:115], v[120:123], v[64:79]
    ds_read_b128 v[104:107], v49 offset:240
    s_waitcnt lgkmcnt(4)
    v_mfma_f32_32x32x16_bf16 v[80:95], v[116:119], v[120:123], v[80:95]
    ds_read_b64 v[100:101], v48 offset:192
    ds_read_b64 v[102:103], v48 offset:200
    s_waitcnt lgkmcnt(3)
    v_mfma_f32_32x32x16_bf16 v[80:95], v[96:99], v[108:111], v[80:95]
    ds_read_b64 v[112:113], v48 offset:2272
    ds_read_b64 v[114:115], v48 offset:2280
    ds_read_b128 v[124:127], v49 offset:2832
    s_waitcnt lgkmcnt(5)
    v_mfma_f32_32x32x16_bf16 v[64:79], v[96:99], v[104:107], v[64:79]
    ds_read_b128 v[120:123], v49 offset:272
    s_waitcnt lgkmcnt(4)
    v_mfma_f32_32x32x16_bf16 v[80:95], v[100:103], v[104:107], v[80:95]
    ds_read_b64 v[116:117], v48 offset:224
    ds_read_b64 v[118:119], v48 offset:232
    s_waitcnt lgkmcnt(3)
    v_mfma_f32_32x32x16_bf16 v[80:95], v[112:115], v[124:127], v[80:95]
    ds_read_b64 v[96:97], v48 offset:2176
    ds_read_b64 v[98:99], v48 offset:2184
    ds_read_b128 v[108:111], v49 offset:2720
    s_waitcnt lgkmcnt(5)
    v_mfma_f32_32x32x16_bf16 v[64:79], v[112:115], v[120:123], v[64:79]
    ds_read_b128 v[104:107], v49 offset:160
    s_waitcnt lgkmcnt(4)
    v_mfma_f32_32x32x16_bf16 v[80:95], v[116:119], v[120:123], v[80:95]
    ds_read_b64 v[100:101], v48 offset:128
    ds_read_b64 v[102:103], v48 offset:136
    s_waitcnt lgkmcnt(3)
    v_mfma_f32_32x32x16_bf16 v[80:95], v[96:99], v[108:111], v[80:95]
    ds_read_b64 v[112:113], v48 offset:2208
    ds_read_b64 v[114:115], v48 offset:2216
    ds_read_b128 v[124:127], v49 offset:2752
    s_waitcnt lgkmcnt(5)
    v_mfma_f32_32x32x16_bf16 v[64:79], v[96:99], v[104:107], v[64:79]
    ds_read_b128 v[120:123], v49 offset:192
    s_waitcnt lgkmcnt(4)
    v_mfma_f32_32x32x16_bf16 v[80:95], v[100:103], v[104:107], v[80:95]
    ds_read_b64 v[116:117], v48 offset:160
    ds_read_b64 v[118:119], v48 offset:168
    s_waitcnt lgkmcnt(3)
    v_mfma_f32_32x32x16_bf16 v[80:95], v[112:115], v[124:127], v[80:95]
    ds_read_b64 v[96:97], v48 offset:2112
    ds_read_b64 v[98:99], v48 offset:2120
    ds_read_b128 v[108:111], v49 offset:2640
    s_waitcnt lgkmcnt(5)
    v_mfma_f32_32x32x16_bf16 v[64:79], v[112:115], v[120:123], v[64:79]
    ds_read_b128 v[104:107], v49 offset:80
    s_waitcnt lgkmcnt(4)
    v_mfma_f32_32x32x16_bf16 v[80:95], v[116:119], v[120:123], v[80:95]
    ds_read_b64 v[100:101], v48 offset:64
    ds_read_b64 v[102:103], v48 offset:72
    s_waitcnt lgkmcnt(3)
    v_mfma_f32_32x32x16_bf16 v[80:95], v[96:99], v[108:111], v[80:95]
    ds_read_b64 v[112:113], v48 offset:2144
    ds_read_b64 v[114:115], v48 offset:2152
    ds_read_b128 v[124:127], v49 offset:2672
    s_waitcnt lgkmcnt(5)
    v_mfma_f32_32x32x16_bf16 v[64:79], v[96:99], v[104:107], v[64:79]
    ds_read_b128 v[120:123], v49 offset:112
    s_waitcnt lgkmcnt(4)
    v_mfma_f32_32x32x16_bf16 v[80:95], v[100:103], v[104:107], v[80:95]
    ds_read_b64 v[116:117], v48 offset:96
    ds_read_b64 v[118:119], v48 offset:104
    s_waitcnt lgkmcnt(3)
    v_mfma_f32_32x32x16_bf16 v[80:95], v[112:115], v[124:127], v[80:95]
    ds_read_b64 v[96:97], v48 offset:2048
    ds_read_b64 v[98:99], v48 offset:2056
    ds_read_b128 v[108:111], v49 offset:2560
    s_waitcnt lgkmcnt(5)
    v_mfma_f32_32x32x16_bf16 v[64:79], v[112:115], v[120:123], v[64:79]
    ds_read_b128 v[104:107], v49 offset:0
    s_waitcnt lgkmcnt(4)
    v_mfma_f32_32x32x16_bf16 v[80:95], v[116:119], v[120:123], v[80:95]
    ds_read_b64 v[100:101], v48 offset:0
    ds_read_b64 v[102:103], v48 offset:8
    s_waitcnt lgkmcnt(3)
    v_mfma_f32_32x32x16_bf16 v[80:95], v[96:99], v[108:111], v[80:95]
    ds_read_b64 v[112:113], v48 offset:2080
    ds_read_b64 v[114:115], v48 offset:2088
    ds_read_b128 v[124:127], v49 offset:2592
    s_waitcnt lgkmcnt(5)
    v_mfma_f32_32x32x16_bf16 v[64:79], v[96:99], v[104:107], v[64:79]
    ds_read_b128 v[120:123], v49 offset:32
    s_waitcnt lgkmcnt(4)
    v_mfma_f32_32x32x16_bf16 v[80:95], v[100:103], v[104:107], v[80:95]
    ds_read_b64 v[116:117], v48 offset:32
    ds_read_b64 v[118:119], v48 offset:40
    s_waitcnt lgkmcnt(3)
    v_mfma_f32_32x32x16_bf16 v[80:95], v[112:115], v[124:127], v[80:95]
    s_waitcnt lgkmcnt(2)
    v_mfma_f32_32x32x16_bf16 v[64:79], v[112:115], v[120:123], v[64:79]
    s_waitcnt lgkmcnt(0)
    v_mfma_f32_32x32x16_bf16 v[80:95], v[116:119], v[120:123], v[80:95]
conv1_kernel_skipmain:
    s_and_b32 s43, s2, 1
    s_lshl_b32 s43, s43, 4
    s_lshr_b32 s42, s42, s43
    s_lshl_b32 s42, s42, 16
    v_mul_f32 v32, s42, v36
    v_mul_f32 v33, s42, v37
    v_mul_f32 v34, s42, v38
    v_mul_f32 v35, s42, v39
    v_cvt_pk_bf16_f32 v50, v32, v33
    v_lshlrev_b32 v32, 16, v50
    v_and_b32 v33, 0xffff0000, v50
    v_cvt_pk_bf16_f32 v50, v34, v35
    v_lshlrev_b32 v34, 16, v50
    v_and_b32 v35, 0xffff0000, v50
    s_barrier
    s_cmp_ge_u32 s46, 4
    s_cbranch_scc1 conv1_kernel_skipw
    s_nop 3
    ds_write_b128 v59, v[64:67] offset:0
    ds_write_b128 v59, v[68:71] offset:32
    ds_write_b128 v59, v[72:75] offset:64
    ds_write_b128 v59, v[76:79] offset:96
    ds_write_b128 v59, v[80:83] offset:4608
    ds_write_b128 v59, v[84:87] offset:4640
    ds_write_b128 v59, v[88:91] offset:4672
    ds_write_b128 v59, v[92:95] offset:4704
    s_waitcnt lgkmcnt(0)
conv1_kernel_skipw:
    s_barrier
    ds_read_b128 v[96:99], v58 offset:0
    ds_read_b128 v[100:103], v58 offset:9216
    ds_read_b128 v[104:107], v58 offset:18432
    ds_read_b128 v[108:111], v58 offset:27648
    s_waitcnt lgkmcnt(2)
    v_add_f32 v96, v96, v100
    v_add_f32 v97, v97, v101
    v_add_f32 v98, v98, v102
    v_add_f32 v99, v99, v103
    s_waitcnt lgkmcnt(0)
    v_add_f32 v104, v104, v108
    v_add_f32 v105, v105, v109
    v_add_f32 v106, v106, v110
    v_add_f32 v107, v107, v111
    v_add_f32 v96, v96, v104
    v_add_f32 v97, v97, v105
    v_add_f32 v98, v98, v106
    v_add_f32 v99, v99, v107
    v_cvt_pk_bf16_f32 v50, v96, v97
    v_lshlrev_b32 v96, 16, v50
    v_and_b32 v97, 0xffff0000, v50
    v_cvt_pk_bf16_f32 v50, v98, v99
    v_lshlrev_b32 v98, 16, v50
    v_and_b32 v99, 0xffff0000, v50
    v_add_f32 v96, v96, v32
    v_add_f32 v97, v97, v33
    v_add_f32 v98, v98, v34
    v_add_f32 v99, v99, v35
    v_cvt_pk_bf16_f32 v50, v96, v97
    v_lshlrev_b32 v96, 16, v50
    v_and_b32 v97, 0xffff0000, v50
    v_cvt_pk_bf16_f32 v50, v98, v99
    v_lshlrev_b32 v98, 16, v50
    v_and_b32 v99, 0xffff0000, v50
    v_add_f32 v96, v96, v28
    v_add_f32 v97, v97, v29
    v_add_f32 v98, v98, v30
    v_add_f32 v99, v99, v31
    v_cvt_pk_bf16_f32 v100, v96, v97
    v_cvt_pk_bf16_f32 v101, v98, v99
    buffer_store_dwordx2 v[100:101], v2, s[32:35], s37 offen sc0 sc1
conv1_kernel_end:
    s_endpgm
.text
.globl gemm1a_kernel
.p2align 8
.type gemm1a_kernel,@function
gemm1a_kernel:
    s_load_dwordx16 s[4:19], s[0:1], 0
    s_load_dwordx8 s[20:27], s[0:1], 64
    s_load_dwordx2 s[28:29], s[0:1], 96
    s_cmp_ge_u32 s2, 224
    s_cbranch_scc1 gemm1a_kernel_end
    v_and_b32 v1, 63, v0
    v_lshrrev_b32 v2, 6, v0
    v_lshrrev_b32 v3, 4, v1
    v_and_b32 v4, 15, v1
    v_readfirstlane_b32 s42, v2
    v_and_b32 v2, 3, v2
    s_and_b32 s3, s2, 6
    s_lshl_b32 s3, s3, 1
    s_lshr_b32 s40, s2, 3
    s_and_b32 s40, s40, 3
    s_add_u32 s40, s3, s40
    s_and_b32 s3, s2, 1
    s_mul_i32 s3, s3, 7
    s_lshr_b32 s41, s2, 5
    s_add_u32 s41, s41, s3
    v_lshrrev_b32 v12, 2, v1
    v_and_b32 v12, 3, v12
    v_and_b32 v13, 3, v1
    v_lshrrev_b32 v14, 1, v3
    v_lshl_add_u32 v14, v14, 3, v12
    v_lshlrev_b32 v14, 8, v14
    v_and_b32 v15, 1, v3
    v_lshl_add_u32 v14, v15, 5, v14
    v_lshrrev_b32 v15, 1, v13
    v_lshl_add_u32 v14, v15, 4, v14
    v_and_b32 v15, 1, v13
    v_lshl_add_u32 v14, v15, 3, v14
    s_waitcnt lgkmcnt(0)
    s_mov_b32 s32, s28
    s_mov_b32 s33, s29
    s_mov_b32 s34, 268435456
    s_mov_b32 s35, 0x00020000
    s_cmp_lt_u32 s42, 4
    s_cbranch_scc1 gemm1a_kernel_compute
    s_cmp_ge_u32 s42, 8
    s_cbranch_scc1 gemm1a_kernel_stats
    s_mov_b32 s36, s20
    s_mov_b32 s37, s21
    s_mov_b32 s38, 1835008
    s_mov_b32 s39, 0x00020000
    s_and_b32 s42, s42, 3
    v_lshlrev_b32 v5, 2, v3
    v_xor_b32 v4, v4, v5
    v_lshl_add_u32 v5, v2, 4, v3
    v_mul_u32_u24 v6, 3584, v5
    v_lshl_add_u32 v6, v4, 4, v6
    v_lshlrev_b32 v7, 12, v5
    v_lshl_add_u32 v7, v4, 4, v7
    s_lshl_b32 s43, s41, 8
    s_lshl_b32 s44, s40, 8
    s_add_u32 s44, s44, 2097152
    s_lshl_b32 s45, s42, 12
    s_add_u32 s46, s44, 0
    s_add_u32 m0, s45, 16384
    s_nop 0
    buffer_load_dwordx4 v7, s[32:35], s46 offen lds
    s_add_u32 s46, s44, 16384
    s_add_u32 m0, s45, 17408
    s_nop 0
    buffer_load_dwordx4 v7, s[32:35], s46 offen lds
    s_add_u32 s46, s44, 32768
    s_add_u32 m0, s45, 18432
    s_nop 0
    buffer_load_dwordx4 v7, s[32:35], s46 offen lds
    s_add_u32 s46, s44, 49152
    s_add_u32 m0, s45, 19456
    s_nop 0
    buffer_load_dwordx4 v7, s[32:35], s46 offen lds
    s_add_u32 s46, s43, 0
    s_add_u32 m0, s45, 0
    s_nop 0
    buffer_load_dwordx4 v6, s[36:39], s46 offen lds
    s_add_u32 s46, s43, 14336
    s_add_u32 m0, s45, 1024
    s_nop 0
    buffer_load_dwordx4 v6, s[36:39], s46 offen lds
    s_add_u32 s46, s43, 28672
    s_add_u32 m0, s45, 2048
    s_nop 0
    buffer_load_dwordx4 v6, s[36:39], s46 offen lds
    s_add_u32 s46, s43, 43008
    s_add_u32 m0, s45, 3072
    s_nop 0
    buffer_load_dwordx4 v6, s[36:39], s46 offen lds
    s_add_u32 s46, s44, 262144
    s_add_u32 m0, s45, 49152
    s_nop 0
    buffer_load_dwordx4 v7, s[32:35], s46 offen lds
    s_add_u32 s46, s44, 278528
    s_add_u32 m0, s45, 50176
    s_nop 0
    buffer_load_dwordx4 v7, s[32:35], s46 offen lds
    s_add_u32 s46, s44, 294912
    s_add_u32 m0, s45, 51200
    s_nop 0
    buffer_load_dwordx4 v7, s[32:35], s46 offen lds
    s_add_u32 s46, s44, 311296
    s_add_u32 m0, s45, 52224
    s_nop 0
    buffer_load_dwordx4 v7, s[32:35], s46 offen lds
    s_add_u32 s46, s43, 229376
    s_add_u32 m0, s45, 32768
    s_nop 0
    buffer_load_dwordx4 v6, s[36:39], s46 offen lds
    s_add_u32 s46, s43, 243712
    s_add_u32 m0, s45, 33792
    s_nop 0
    buffer_load_dwordx4 v6, s[36:39], s46 offen lds
    s_add_u32 s46, s43, 258048
    s_add_u32 m0, s45, 34816
    s_nop 0
    buffer_load_dwordx4 v6, s[36:39], s46 offen lds
    s_add_u32 s46, s43, 272384
    s_add_u32 m0, s45, 35840
    s_nop 0
    buffer_load_dwordx4 v6, s[36:39], s46 offen lds
    s_waitcnt vmcnt(8)
    s_barrier
    s_add_u32 s46, s44, 524288
    s_add_u32 m0, s45, 81920
    s_nop 0
    buffer_load_dwordx4 v7, s[32:35], s46 offen lds
    s_add_u32 s46, s44, 540672
    s_add_u32 m0, s45, 82944
    s_nop 0
    buffer_load_dwordx4 v7, s[32:35], s46 offen lds
    s_add_u32 s46, s44, 557056
    s_add_u32 m0, s45, 83968
    s_nop 0
    buffer_load_dwordx4 v7, s[32:35], s46 offen lds
    s_add_u32 s46, s44, 573440
    s_add_u32 m0, s45, 84992
    s_nop 0
    buffer_load_dwordx4 v7, s[32:35], s46 offen lds
    s_add_u32 s46, s43, 458752
    s_add_u32 m0, s45, 65536
    s_nop 0
    buffer_load_dwordx4 v6, s[36:39], s46 offen lds
    s_add_u32 s46, s43, 473088
    s_add_u32 m0, s45, 66560
    s_nop 0
    buffer_load_dwordx4 v6, s[36:39], s46 offen lds
    s_add_u32 s46, s43, 487424
    s_add_u32 m0, s45, 67584
    s_nop 0
    buffer_load_dwordx4 v6, s[36:39], s46 offen lds
    s_add_u32 s46, s43, 501760
    s_add_u32 m0, s45, 68608
    s_nop 0
    buffer_load_dwordx4 v6, s[36:39], s46 offen lds
    s_add_u32 s46, s44, 786432
    s_add_u32 m0, s45, 114688
    s_nop 0
    buffer_load_dwordx4 v7, s[32:35], s46 offen lds
    s_add_u32 s46, s44, 802816
    s_add_u32 m0, s45, 115712
    s_nop 0
    buffer_load_dwordx4 v7, s[32:35], s46 offen lds
    s_add_u32 s46, s44, 819200
    s_add_u32 m0, s45, 116736
    s_nop 0
    buffer_load_dwordx4 v7, s[32:35], s46 offen lds
    s_add_u32 s46, s44, 835584
    s_add_u32 m0, s45, 117760
    s_nop 0
    buffer_load_dwordx4 v7, s[32:35], s46 offen lds
    s_add_u32 s46, s43, 688128
    s_add_u32 m0, s45, 98304
    s_nop 0
    buffer_load_dwordx4 v6, s[36:39], s46 offen lds
    s_add_u32 s46, s43, 702464
    s_add_u32 m0, s45, 99328
    s_nop 0
    buffer_load_dwordx4 v6, s[36:39], s46 offen lds
    s_add_u32 s46, s43, 716800
    s_add_u32 m0, s45, 100352
    s_nop 0
    buffer_load_dwordx4 v6, s[36:39], s46 offen lds
    s_add_u32 s46, s43, 731136
    s_add_u32 m0, s45, 101376
    s_nop 0
    buffer_load_dwordx4 v6, s[36:39], s46 offen lds
    s_waitcnt vmcnt(16)
    s_barrier
    s_add_u32 s46, s44, 1048576
    s_add_u32 m0, s45, 16384
    s_nop 0
    buffer_load_dwordx4 v7, s[32:35], s46 offen lds
    s_add_u32 s46, s44, 1064960
    s_add_u32 m0, s45, 17408
    s_nop 0
    buffer_load_dwordx4 v7, s[32:35], s46 offen lds
    s_add_u32 s46, s44, 1081344
    s_add_u32 m0, s45, 18432
    s_nop 0
    buffer_load_dwordx4 v7, s[32:35], s46 offen lds
    s_add_u32 s46, s44, 1097728
    s_add_u32 m0, s45, 19456
    s_nop 0
    buffer_load_dwordx4 v7, s[32:35], s46 offen lds
    s_add_u32 s46, s43, 917504
    s_add_u32 m0, s45, 0
    s_nop 0
    buffer_load_dwordx4 v6, s[36:39], s46 offen lds
    s_add_u32 s46, s43, 931840
    s_add_u32 m0, s45, 1024
    s_nop 0
    buffer_load_dwordx4 v6, s[36:39], s46 offen lds
    s_add_u32 s46, s43, 946176
    s_add_u32 m0, s45, 2048
    s_nop 0
    buffer_load_dwordx4 v6, s[36:39], s46 offen lds
    s_add_u32 s46, s43, 960512
    s_add_u32 m0, s45, 3072
    s_nop 0
    buffer_load_dwordx4 v6, s[36:39], s46 offen lds
    s_waitcnt vmcnt(16)
    s_barrier
    s_add_u32 s46, s44, 1310720
    s_add_u32 m0, s45, 49152
    s_nop 0
    buffer_load_dwordx4 v7, s[32:35], s46 offen lds
    s_add_u32 s46, s44, 1327104
    s_add_u32 m0, s45, 50176
    s_nop 0
    buffer_load_dwordx4 v7, s[32:35], s46 offen lds
    s_add_u32 s46, s44, 1343488
    s_add_u32 m0, s45, 51200
    s_nop 0
    buffer_load_dwordx4 v7, s[32:35], s46 offen lds
    s_add_u32 s46, s44, 1359872
    s_add_u32 m0, s45, 52224
    s_nop 0
    buffer_load_dwordx4 v7, s[32:35], s46 offen lds
    s_add_u32 s46, s43, 1146880
    s_add_u32 m0, s45, 32768
    s_nop 0
    buffer_load_dwordx4 v6, s[36:39], s46 offen lds
    s_add_u32 s46, s43, 1161216
    s_add_u32 m0, s45, 33792
    s_nop 0
    buffer_load_dwordx4 v6, s[36:39], s46 offen lds
    s_add_u32 s46, s43, 1175552
    s_add_u32 m0, s45, 34816
    s_nop 0
    buffer_load_dwordx4 v6, s[36:39], s46 offen lds
    s_add_u32 s46, s43, 1189888
    s_add_u32 m0, s45, 35840
    s_nop 0
    buffer_load_dwordx4 v6, s[36:39], s46 offen lds
    s_waitcnt vmcnt(16)
    s_barrier
    s_add_u32 s46, s44, 1572864
    s_add_u32 m0, s45, 81920
    s_nop 0
    buffer_load_dwordx4 v7, s[32:35], s46 offen lds
    s_add_u32 s46, s44, 1589248
    s_add_u32 m0, s45, 82944
    s_nop 0
    buffer_load_dwordx4 v7, s[32:35], s46 offen lds
    s_add_u32 s46, s44, 1605632
    s_add_u32 m0, s45, 83968
    s_nop 0
    buffer_load_dwordx4 v7, s[32:35], s46 offen lds
    s_add_u32 s46, s44, 1622016
    s_add_u32 m0, s45, 84992
    s_nop 0
    buffer_load_dwordx4 v7, s[32:35], s46 offen lds
    s_add_u32 s46, s43, 1376256
    s_add_u32 m0, s45, 65536
    s_nop 0
    buffer_load_dwordx4 v6, s[36:39], s46 offen lds
    s_add_u32 s46, s43, 1390592
    s_add_u32 m0, s45, 66560
    s_nop 0
    buffer_load_dwordx4 v6, s[36:39], s46 offen lds
    s_add_u32 s46, s43, 1404928
    s_add_u32 m0, s45, 67584
    s_nop 0
    buffer_load_dwordx4 v6, s[36:39], s46 offen lds
    s_add_u32 s46, s43, 1419264
    s_add_u32 m0, s45, 68608
    s_nop 0
    buffer_load_dwordx4 v6, s[36:39], s46 offen lds
    s_waitcnt vmcnt(16)
    s_barrier
    s_add_u32 s46, s44, 1835008
    s_add_u32 m0, s45, 114688
    s_nop 0
    buffer_load_dwordx4 v7, s[32:35], s46 offen lds
    s_add_u32 s46, s44, 1851392
    s_add_u32 m0, s45, 115712
    s_nop 0
    buffer_load_dwordx4 v7, s[32:35], s46 offen lds
    s_add_u32 s46, s44, 1867776
    s_add_u32 m0, s45, 116736
    s_nop 0
    buffer_load_dwordx4 v7, s[32:35], s46 offen lds
    s_add_u32 s46, s44, 1884160
    s_add_u32 m0, s45, 117760
    s_nop 0
    buffer_load_dwordx4 v7, s[32:35], s46 offen lds
    s_add_u32 s46, s43, 1605632
    s_add_u32 m0, s45, 98304
    s_nop 0
    buffer_load_dwordx4 v6, s[36:39], s46 offen lds
    s_add_u32 s46, s43, 1619968
    s_add_u32 m0, s45, 99328
    s_nop 0
    buffer_load_dwordx4 v6, s[36:39], s46 offen lds
    s_add_u32 s46, s43, 1634304
    s_add_u32 m0, s45, 100352
    s_nop 0
    buffer_load_dwordx4 v6, s[36:39], s46 offen lds
    s_add_u32 s46, s43, 1648640
    s_add_u32 m0, s45, 101376
    s_nop 0
    buffer_load_dwordx4 v6, s[36:39], s46 offen lds
    s_waitcnt vmcnt(16)
    s_barrier
    s_waitcnt vmcnt(8)
    s_barrier
    s_waitcnt vmcnt(0)
    s_barrier
    s_endpgm
gemm1a_kernel_stats:
    v_and_b32 v36, 31, v1
    v_lshl_add_u32 v36, v2, 5, v36
    v_lshlrev_b32 v37, 2, v36
    s_lshl_b32 s47, s41, 9
    s_add_u32 s47, s47, 20054016
    buffer_load_dword v30, v37, s[32:35], s47 offen
    v_add_u32 v31, 132096, v37
    v_xor_b32 v15, v2, v12
    v_lshl_add_u32 v18, v15, 6, v14
    v_add_u32 v18, 0x4000, v18
    v_add_u32 v22, 0x10000, v18
    v_mov_b32 v28, 0x3f803f80
    v_mov_b32 v32, 0
    v_mov_b32 v33, 0
    v_mov_b32 v34, 0
    v_mov_b32 v35, 0
    v_mov_b32 v36, 0
    v_mov_b32 v37, 0
    v_mov_b32 v38, 0
    v_mov_b32 v39, 0
    s_barrier
    ds_read_b64_tr_b16 v[64:65], v18 offset:0
    ds_read_b64_tr_b16 v[66:67], v18 offset:1024
    ds_read_b64_tr_b16 v[68:69], v18 offset:4096
    ds_read_b64_tr_b16 v[70:71], v18 offset:5120
    ds_read_b64_tr_b16 v[72:73], v18 offset:8192
    ds_read_b64_tr_b16 v[74:75], v18 offset:9216
    ds_read_b64_tr_b16 v[76:77], v18 offset:12288
    ds_read_b64_tr_b16 v[78:79], v18 offset:13312
    s_waitcnt lgkmcnt(6)
    v_lshlrev_b32 v80, 16, v64
    v_and_b32 v81, 0xffff0000, v64
    v_add_f32 v32, v32, v80
    v_add_f32 v33, v33, v81
    v_fmac_f32 v36, v80, v80
    v_fmac_f32 v37, v81, v81
    v_lshlrev_b32 v82, 16, v65
    v_and_b32 v83, 0xffff0000, v65
    v_add_f32 v34, v34, v82
    v_add_f32 v35, v35, v83
    v_fmac_f32 v38, v82, v82
    v_fmac_f32 v39, v83, v83
    v_lshlrev_b32 v80, 16, v66
    v_and_b32 v81, 0xffff0000, v66
    v_add_f32 v32, v32, v80
    v_add_f32 v33, v33, v81
    v_fmac_f32 v36, v80, v80
    v_fmac_f32 v37, v81, v81
    v_lshlrev_b32 v82, 16, v67
    v_and_b32 v83, 0xffff0000, v67
    v_add_f32 v34, v34, v82
    v_add_f32 v35, v35, v83
    v_fmac_f32 v38, v82, v82
    v_fmac_f32 v39, v83, v83
    s_waitcnt lgkmcnt(4)
    v_lshlrev_b32 v80, 16, v68
    v_and_b32 v81, 0xffff0000, v68
    v_add_f32 v32, v32, v80
    v_add_f32 v33, v33, v81
    v_fmac_f32 v36, v80, v80
    v_fmac_f32 v37, v81, v81
    v_lshlrev_b32 v82, 16, v69
    v_and_b32 v83, 0xffff0000, v69
    v_add_f32 v34, v34, v82
    v_add_f32 v35, v35, v83
    v_fmac_f32 v38, v82, v82
    v_fmac_f32 v39, v83, v83
    v_lshlrev_b32 v80, 16, v70
    v_and_b32 v81, 0xffff0000, v70
    v_add_f32 v32, v32, v80
    v_add_f32 v33, v33, v81
    v_fmac_f32 v36, v80, v80
    v_fmac_f32 v37, v81, v81
    v_lshlrev_b32 v82, 16, v71
    v_and_b32 v83, 0xffff0000, v71
    v_add_f32 v34, v34, v82
    v_add_f32 v35, v35, v83
    v_fmac_f32 v38, v82, v82
    v_fmac_f32 v39, v83, v83
    s_waitcnt lgkmcnt(2)
    v_lshlrev_b32 v80, 16, v72
    v_and_b32 v81, 0xffff0000, v72
    v_add_f32 v32, v32, v80
    v_add_f32 v33, v33, v81
    v_fmac_f32 v36, v80, v80
    v_fmac_f32 v37, v81, v81
    v_lshlrev_b32 v82, 16, v73
    v_and_b32 v83, 0xffff0000, v73
    v_add_f32 v34, v34, v82
    v_add_f32 v35, v35, v83
    v_fmac_f32 v38, v82, v82
    v_fmac_f32 v39, v83, v83
    v_lshlrev_b32 v80, 16, v74
    v_and_b32 v81, 0xffff0000, v74
    v_add_f32 v32, v32, v80
    v_add_f32 v33, v33, v81
    v_fmac_f32 v36, v80, v80
    v_fmac_f32 v37, v81, v81
    v_lshlrev_b32 v82, 16, v75
    v_and_b32 v83, 0xffff0000, v75
    v_add_f32 v34, v34, v82
    v_add_f32 v35, v35, v83
    v_fmac_f32 v38, v82, v82
    v_fmac_f32 v39, v83, v83
    s_waitcnt lgkmcnt(0)
    v_lshlrev_b32 v80, 16, v76
    v_and_b32 v81, 0xffff0000, v76
    v_add_f32 v32, v32, v80
    v_add_f32 v33, v33, v81
    v_fmac_f32 v36, v80, v80
    v_fmac_f32 v37, v81, v81
    v_lshlrev_b32 v82, 16, v77
    v_and_b32 v83, 0xffff0000, v77
    v_add_f32 v34, v34, v82
    v_add_f32 v35, v35, v83
    v_fmac_f32 v38, v82, v82
    v_fmac_f32 v39, v83, v83
    v_lshlrev_b32 v80, 16, v78
    v_and_b32 v81, 0xffff0000, v78
    v_add_f32 v32, v32, v80
    v_add_f32 v33, v33, v81
    v_fmac_f32 v36, v80, v80
    v_fmac_f32 v37, v81, v81
    v_lshlrev_b32 v82, 16, v79
    v_and_b32 v83, 0xffff0000, v79
    v_add_f32 v34, v34, v82
    v_add_f32 v35, v35, v83
    v_fmac_f32 v38, v82, v82
    v_fmac_f32 v39, v83, v83
    s_barrier
    ds_read_b64_tr_b16 v[64:65], v18 offset:32768
    ds_read_b64_tr_b16 v[66:67], v18 offset:33792
    ds_read_b64_tr_b16 v[68:69], v18 offset:36864
    ds_read_b64_tr_b16 v[70:71], v18 offset:37888
    ds_read_b64_tr_b16 v[72:73], v18 offset:40960
    ds_read_b64_tr_b16 v[74:75], v18 offset:41984
    ds_read_b64_tr_b16 v[76:77], v18 offset:45056
    ds_read_b64_tr_b16 v[78:79], v18 offset:46080
    s_waitcnt lgkmcnt(6)
    v_lshlrev_b32 v80, 16, v64
    v_and_b32 v81, 0xffff0000, v64
    v_add_f32 v32, v32, v80
    v_add_f32 v33, v33, v81
    v_fmac_f32 v36, v80, v80
    v_fmac_f32 v37, v81, v81
    v_lshlrev_b32 v82, 16, v65
    v_and_b32 v83, 0xffff0000, v65
    v_add_f32 v34, v34, v82
    v_add_f32 v35, v35, v83
    v_fmac_f32 v38, v82, v82
    v_fmac_f32 v39, v83, v83
    v_lshlrev_b32 v80, 16, v66
    v_and_b32 v81, 0xffff0000, v66
    v_add_f32 v32, v32, v80
    v_add_f32 v33, v33, v81
    v_fmac_f32 v36, v80, v80
    v_fmac_f32 v37, v81, v81
    v_lshlrev_b32 v82, 16, v67
    v_and_b32 v83, 0xffff0000, v67
    v_add_f32 v34, v34, v82
    v_add_f32 v35, v35, v83
    v_fmac_f32 v38, v82, v82
    v_fmac_f32 v39, v83, v83
    s_waitcnt lgkmcnt(4)
    v_lshlrev_b32 v80, 16, v68
    v_and_b32 v81, 0xffff0000, v68
    v_add_f32 v32, v32, v80
    v_add_f32 v33, v33, v81
    v_fmac_f32 v36, v80, v80
    v_fmac_f32 v37, v81, v81
    v_lshlrev_b32 v82, 16, v69
    v_and_b32 v83, 0xffff0000, v69
    v_add_f32 v34, v34, v82
    v_add_f32 v35, v35, v83
    v_fmac_f32 v38, v82, v82
    v_fmac_f32 v39, v83, v83
    v_lshlrev_b32 v80, 16, v70
    v_and_b32 v81, 0xffff0000, v70
    v_add_f32 v32, v32, v80
    v_add_f32 v33, v33, v81
    v_fmac_f32 v36, v80, v80
    v_fmac_f32 v37, v81, v81
    v_lshlrev_b32 v82, 16, v71
    v_and_b32 v83, 0xffff0000, v71
    v_add_f32 v34, v34, v82
    v_add_f32 v35, v35, v83
    v_fmac_f32 v38, v82, v82
    v_fmac_f32 v39, v83, v83
    s_waitcnt lgkmcnt(2)
    v_lshlrev_b32 v80, 16, v72
    v_and_b32 v81, 0xffff0000, v72
    v_add_f32 v32, v32, v80
    v_add_f32 v33, v33, v81
    v_fmac_f32 v36, v80, v80
    v_fmac_f32 v37, v81, v81
    v_lshlrev_b32 v82, 16, v73
    v_and_b32 v83, 0xffff0000, v73
    v_add_f32 v34, v34, v82
    v_add_f32 v35, v35, v83
    v_fmac_f32 v38, v82, v82
    v_fmac_f32 v39, v83, v83
    v_lshlrev_b32 v80, 16, v74
    v_and_b32 v81, 0xffff0000, v74
    v_add_f32 v32, v32, v80
    v_add_f32 v33, v33, v81
    v_fmac_f32 v36, v80, v80
    v_fmac_f32 v37, v81, v81
    v_lshlrev_b32 v82, 16, v75
    v_and_b32 v83, 0xffff0000, v75
    v_add_f32 v34, v34, v82
    v_add_f32 v35, v35, v83
    v_fmac_f32 v38, v82, v82
    v_fmac_f32 v39, v83, v83
    s_waitcnt lgkmcnt(0)
    v_lshlrev_b32 v80, 16, v76
    v_and_b32 v81, 0xffff0000, v76
    v_add_f32 v32, v32, v80
    v_add_f32 v33, v33, v81
    v_fmac_f32 v36, v80, v80
    v_fmac_f32 v37, v81, v81
    v_lshlrev_b32 v82, 16, v77
    v_and_b32 v83, 0xffff0000, v77
    v_add_f32 v34, v34, v82
    v_add_f32 v35, v35, v83
    v_fmac_f32 v38, v82, v82
    v_fmac_f32 v39, v83, v83
    v_lshlrev_b32 v80, 16, v78
    v_and_b32 v81, 0xffff0000, v78
    v_add_f32 v32, v32, v80
    v_add_f32 v33, v33, v81
    v_fmac_f32 v36, v80, v80
    v_fmac_f32 v37, v81, v81
    v_lshlrev_b32 v82, 16, v79
    v_and_b32 v83, 0xffff0000, v79
    v_add_f32 v34, v34, v82
    v_add_f32 v35, v35, v83
    v_fmac_f32 v38, v82, v82
    v_fmac_f32 v39, v83, v83
    s_barrier
    ds_read_b64_tr_b16 v[64:65], v22 offset:0
    ds_read_b64_tr_b16 v[66:67], v22 offset:1024
    ds_read_b64_tr_b16 v[68:69], v22 offset:4096
    ds_read_b64_tr_b16 v[70:71], v22 offset:5120
    ds_read_b64_tr_b16 v[72:73], v22 offset:8192
    ds_read_b64_tr_b16 v[74:75], v22 offset:9216
    ds_read_b64_tr_b16 v[76:77], v22 offset:12288
    ds_read_b64_tr_b16 v[78:79], v22 offset:13312
    s_waitcnt lgkmcnt(6)
    v_lshlrev_b32 v80, 16, v64
    v_and_b32 v81, 0xffff0000, v64
    v_add_f32 v32, v32, v80
    v_add_f32 v33, v33, v81
    v_fmac_f32 v36, v80, v80
    v_fmac_f32 v37, v81, v81
    v_lshlrev_b32 v82, 16, v65
    v_and_b32 v83, 0xffff0000, v65
    v_add_f32 v34, v34, v82
    v_add_f32 v35, v35, v83
    v_fmac_f32 v38, v82, v82
    v_fmac_f32 v39, v83, v83
    v_lshlrev_b32 v80, 16, v66
    v_and_b32 v81, 0xffff0000, v66
    v_add_f32 v32, v32, v80
    v_add_f32 v33, v33, v81
    v_fmac_f32 v36, v80, v80
    v_fmac_f32 v37, v81, v81
    v_lshlrev_b32 v82, 16, v67
    v_and_b32 v83, 0xffff0000, v67
    v_add_f32 v34, v34, v82
    v_add_f32 v35, v35, v83
    v_fmac_f32 v38, v82, v82
    v_fmac_f32 v39, v83, v83
    s_waitcnt lgkmcnt(4)
    v_lshlrev_b32 v80, 16, v68
    v_and_b32 v81, 0xffff0000, v68
    v_add_f32 v32, v32, v80
    v_add_f32 v33, v33, v81
    v_fmac_f32 v36, v80, v80
    v_fmac_f32 v37, v81, v81
    v_lshlrev_b32 v82, 16, v69
    v_and_b32 v83, 0xffff0000, v69
    v_add_f32 v34, v34, v82
    v_add_f32 v35, v35, v83
    v_fmac_f32 v38, v82, v82
    v_fmac_f32 v39, v83, v83
    v_lshlrev_b32 v80, 16, v70
    v_and_b32 v81, 0xffff0000, v70
    v_add_f32 v32, v32, v80
    v_add_f32 v33, v33, v81
    v_fmac_f32 v36, v80, v80
    v_fmac_f32 v37, v81, v81
    v_lshlrev_b32 v82, 16, v71
    v_and_b32 v83, 0xffff0000, v71
    v_add_f32 v34, v34, v82
    v_add_f32 v35, v35, v83
    v_fmac_f32 v38, v82, v82
    v_fmac_f32 v39, v83, v83
    s_waitcnt lgkmcnt(2)
    v_lshlrev_b32 v80, 16, v72
    v_and_b32 v81, 0xffff0000, v72
    v_add_f32 v32, v32, v80
    v_add_f32 v33, v33, v81
    v_fmac_f32 v36, v80, v80
    v_fmac_f32 v37, v81, v81
    v_lshlrev_b32 v82, 16, v73
    v_and_b32 v83, 0xffff0000, v73
    v_add_f32 v34, v34, v82
    v_add_f32 v35, v35, v83
    v_fmac_f32 v38, v82, v82
    v_fmac_f32 v39, v83, v83
    v_lshlrev_b32 v80, 16, v74
    v_and_b32 v81, 0xffff0000, v74
    v_add_f32 v32, v32, v80
    v_add_f32 v33, v33, v81
    v_fmac_f32 v36, v80, v80
    v_fmac_f32 v37, v81, v81
    v_lshlrev_b32 v82, 16, v75
    v_and_b32 v83, 0xffff0000, v75
    v_add_f32 v34, v34, v82
    v_add_f32 v35, v35, v83
    v_fmac_f32 v38, v82, v82
    v_fmac_f32 v39, v83, v83
    s_waitcnt lgkmcnt(0)
    v_lshlrev_b32 v80, 16, v76
    v_and_b32 v81, 0xffff0000, v76
    v_add_f32 v32, v32, v80
    v_add_f32 v33, v33, v81
    v_fmac_f32 v36, v80, v80
    v_fmac_f32 v37, v81, v81
    v_lshlrev_b32 v82, 16, v77
    v_and_b32 v83, 0xffff0000, v77
    v_add_f32 v34, v34, v82
    v_add_f32 v35, v35, v83
    v_fmac_f32 v38, v82, v82
    v_fmac_f32 v39, v83, v83
    v_lshlrev_b32 v80, 16, v78
    v_and_b32 v81, 0xffff0000, v78
    v_add_f32 v32, v32, v80
    v_add_f32 v33, v33, v81
    v_fmac_f32 v36, v80, v80
    v_fmac_f32 v37, v81, v81
    v_lshlrev_b32 v82, 16, v79
    v_and_b32 v83, 0xffff0000, v79
    v_add_f32 v34, v34, v82
    v_add_f32 v35, v35, v83
    v_fmac_f32 v38, v82, v82
    v_fmac_f32 v39, v83, v83
    s_barrier
    ds_read_b64_tr_b16 v[64:65], v22 offset:32768
    ds_read_b64_tr_b16 v[66:67], v22 offset:33792
    ds_read_b64_tr_b16 v[68:69], v22 offset:36864
    ds_read_b64_tr_b16 v[70:71], v22 offset:37888
    ds_read_b64_tr_b16 v[72:73], v22 offset:40960
    ds_read_b64_tr_b16 v[74:75], v22 offset:41984
    ds_read_b64_tr_b16 v[76:77], v22 offset:45056
    ds_read_b64_tr_b16 v[78:79], v22 offset:46080
    s_waitcnt lgkmcnt(6)
    v_lshlrev_b32 v80, 16, v64
    v_and_b32 v81, 0xffff0000, v64
    v_add_f32 v32, v32, v80
    v_add_f32 v33, v33, v81
    v_fmac_f32 v36, v80, v80
    v_fmac_f32 v37, v81, v81
    v_lshlrev_b32 v82, 16, v65
    v_and_b32 v83, 0xffff0000, v65
    v_add_f32 v34, v34, v82
    v_add_f32 v35, v35, v83
    v_fmac_f32 v38, v82, v82
    v_fmac_f32 v39, v83, v83
    v_lshlrev_b32 v80, 16, v66
    v_and_b32 v81, 0xffff0000, v66
    v_add_f32 v32, v32, v80
    v_add_f32 v33, v33, v81
    v_fmac_f32 v36, v80, v80
    v_fmac_f32 v37, v81, v81
    v_lshlrev_b32 v82, 16, v67
    v_and_b32 v83, 0xffff0000, v67
    v_add_f32 v34, v34, v82
    v_add_f32 v35, v35, v83
    v_fmac_f32 v38, v82, v82
    v_fmac_f32 v39, v83, v83
    s_waitcnt lgkmcnt(4)
    v_lshlrev_b32 v80, 16, v68
    v_and_b32 v81, 0xffff0000, v68
    v_add_f32 v32, v32, v80
    v_add_f32 v33, v33, v81
    v_fmac_f32 v36, v80, v80
    v_fmac_f32 v37, v81, v81
    v_lshlrev_b32 v82, 16, v69
    v_and_b32 v83, 0xffff0000, v69
    v_add_f32 v34, v34, v82
    v_add_f32 v35, v35, v83
    v_fmac_f32 v38, v82, v82
    v_fmac_f32 v39, v83, v83
    v_lshlrev_b32 v80, 16, v70
    v_and_b32 v81, 0xffff0000, v70
    v_add_f32 v32, v32, v80
    v_add_f32 v33, v33, v81
    v_fmac_f32 v36, v80, v80
    v_fmac_f32 v37, v81, v81
    v_lshlrev_b32 v82, 16, v71
    v_and_b32 v83, 0xffff0000, v71
    v_add_f32 v34, v34, v82
    v_add_f32 v35, v35, v83
    v_fmac_f32 v38, v82, v82
    v_fmac_f32 v39, v83, v83
    s_waitcnt lgkmcnt(2)
    v_lshlrev_b32 v80, 16, v72
    v_and_b32 v81, 0xffff0000, v72
    v_add_f32 v32, v32, v80
    v_add_f32 v33, v33, v81
    v_fmac_f32 v36, v80, v80
    v_fmac_f32 v37, v81, v81
    v_lshlrev_b32 v82, 16, v73
    v_and_b32 v83, 0xffff0000, v73
    v_add_f32 v34, v34, v82
    v_add_f32 v35, v35, v83
    v_fmac_f32 v38, v82, v82
    v_fmac_f32 v39, v83, v83
    v_lshlrev_b32 v80, 16, v74
    v_and_b32 v81, 0xffff0000, v74
    v_add_f32 v32, v32, v80
    v_add_f32 v33, v33, v81
    v_fmac_f32 v36, v80, v80
    v_fmac_f32 v37, v81, v81
    v_lshlrev_b32 v82, 16, v75
    v_and_b32 v83, 0xffff0000, v75
    v_add_f32 v34, v34, v82
    v_add_f32 v35, v35, v83
    v_fmac_f32 v38, v82, v82
    v_fmac_f32 v39, v83, v83
    s_waitcnt lgkmcnt(0)
    v_lshlrev_b32 v80, 16, v76
    v_and_b32 v81, 0xffff0000, v76
    v_add_f32 v32, v32, v80
    v_add_f32 v33, v33, v81
    v_fmac_f32 v36, v80, v80
    v_fmac_f32 v37, v81, v81
    v_lshlrev_b32 v82, 16, v77
    v_and_b32 v83, 0xffff0000, v77
    v_add_f32 v34, v34, v82
    v_add_f32 v35, v35, v83
    v_fmac_f32 v38, v82, v82
    v_fmac_f32 v39, v83, v83
    v_lshlrev_b32 v80, 16, v78
    v_and_b32 v81, 0xffff0000, v78
    v_add_f32 v32, v32, v80
    v_add_f32 v33, v33, v81
    v_fmac_f32 v36, v80, v80
    v_fmac_f32 v37, v81, v81
    v_lshlrev_b32 v82, 16, v79
    v_and_b32 v83, 0xffff0000, v79
    v_add_f32 v34, v34, v82
    v_add_f32 v35, v35, v83
    v_fmac_f32 v38, v82, v82
    v_fmac_f32 v39, v83, v83
    s_barrier
    ds_read_b64_tr_b16 v[64:65], v18 offset:0
    ds_read_b64_tr_b16 v[66:67], v18 offset:1024
    ds_read_b64_tr_b16 v[68:69], v18 offset:4096
    ds_read_b64_tr_b16 v[70:71], v18 offset:5120
    ds_read_b64_tr_b16 v[72:73], v18 offset:8192
    ds_read_b64_tr_b16 v[74:75], v18 offset:9216
    ds_read_b64_tr_b16 v[76:77], v18 offset:12288
    ds_read_b64_tr_b16 v[78:79], v18 offset:13312
    s_waitcnt lgkmcnt(6)
    v_lshlrev_b32 v80, 16, v64
    v_and_b32 v81, 0xffff0000, v64
    v_add_f32 v32, v32, v80
    v_add_f32 v33, v33, v81
    v_fmac_f32 v36, v80, v80
    v_fmac_f32 v37, v81, v81
    v_lshlrev_b32 v82, 16, v65
    v_and_b32 v83, 0xffff0000, v65
    v_add_f32 v34, v34, v82
    v_add_f32 v35, v35, v83
    v_fmac_f32 v38, v82, v82
    v_fmac_f32 v39, v83, v83
    v_lshlrev_b32 v80, 16, v66
    v_and_b32 v81, 0xffff0000, v66
    v_add_f32 v32, v32, v80
    v_add_f32 v33, v33, v81
    v_fmac_f32 v36, v80, v80
    v_fmac_f32 v37, v81, v81
    v_lshlrev_b32 v82, 16, v67
    v_and_b32 v83, 0xffff0000, v67
    v_add_f32 v34, v34, v82
    v_add_f32 v35, v35, v83
    v_fmac_f32 v38, v82, v82
    v_fmac_f32 v39, v83, v83
    s_waitcnt lgkmcnt(4)
    v_lshlrev_b32 v80, 16, v68
    v_and_b32 v81, 0xffff0000, v68
    v_add_f32 v32, v32, v80
    v_add_f32 v33, v33, v81
    v_fmac_f32 v36, v80, v80
    v_fmac_f32 v37, v81, v81
    v_lshlrev_b32 v82, 16, v69
    v_and_b32 v83, 0xffff0000, v69
    v_add_f32 v34, v34, v82
    v_add_f32 v35, v35, v83
    v_fmac_f32 v38, v82, v82
    v_fmac_f32 v39, v83, v83
    v_lshlrev_b32 v80, 16, v70
    v_and_b32 v81, 0xffff0000, v70
    v_add_f32 v32, v32, v80
    v_add_f32 v33, v33, v81
    v_fmac_f32 v36, v80, v80
    v_fmac_f32 v37, v81, v81
    v_lshlrev_b32 v82, 16, v71
    v_and_b32 v83, 0xffff0000, v71
    v_add_f32 v34, v34, v82
    v_add_f32 v35, v35, v83
    v_fmac_f32 v38, v82, v82
    v_fmac_f32 v39, v83, v83
    s_waitcnt lgkmcnt(2)
    v_lshlrev_b32 v80, 16, v72
    v_and_b32 v81, 0xffff0000, v72
    v_add_f32 v32, v32, v80
    v_add_f32 v33, v33, v81
    v_fmac_f32 v36, v80, v80
    v_fmac_f32 v37, v81, v81
    v_lshlrev_b32 v82, 16, v73
    v_and_b32 v83, 0xffff0000, v73
    v_add_f32 v34, v34, v82
    v_add_f32 v35, v35, v83
    v_fmac_f32 v38, v82, v82
    v_fmac_f32 v39, v83, v83
    v_lshlrev_b32 v80, 16, v74
    v_and_b32 v81, 0xffff0000, v74
    v_add_f32 v32, v32, v80
    v_add_f32 v33, v33, v81
    v_fmac_f32 v36, v80, v80
    v_fmac_f32 v37, v81, v81
    v_lshlrev_b32 v82, 16, v75
    v_and_b32 v83, 0xffff0000, v75
    v_add_f32 v34, v34, v82
    v_add_f32 v35, v35, v83
    v_fmac_f32 v38, v82, v82
    v_fmac_f32 v39, v83, v83
    s_waitcnt lgkmcnt(0)
    v_lshlrev_b32 v80, 16, v76
    v_and_b32 v81, 0xffff0000, v76
    v_add_f32 v32, v32, v80
    v_add_f32 v33, v33, v81
    v_fmac_f32 v36, v80, v80
    v_fmac_f32 v37, v81, v81
    v_lshlrev_b32 v82, 16, v77
    v_and_b32 v83, 0xffff0000, v77
    v_add_f32 v34, v34, v82
    v_add_f32 v35, v35, v83
    v_fmac_f32 v38, v82, v82
    v_fmac_f32 v39, v83, v83
    v_lshlrev_b32 v80, 16, v78
    v_and_b32 v81, 0xffff0000, v78
    v_add_f32 v32, v32, v80
    v_add_f32 v33, v33, v81
    v_fmac_f32 v36, v80, v80
    v_fmac_f32 v37, v81, v81
    v_lshlrev_b32 v82, 16, v79
    v_and_b32 v83, 0xffff0000, v79
    v_add_f32 v34, v34, v82
    v_add_f32 v35, v35, v83
    v_fmac_f32 v38, v82, v82
    v_fmac_f32 v39, v83, v83
    s_barrier
    ds_read_b64_tr_b16 v[64:65], v18 offset:32768
    ds_read_b64_tr_b16 v[66:67], v18 offset:33792
    ds_read_b64_tr_b16 v[68:69], v18 offset:36864
    ds_read_b64_tr_b16 v[70:71], v18 offset:37888
    ds_read_b64_tr_b16 v[72:73], v18 offset:40960
    ds_read_b64_tr_b16 v[74:75], v18 offset:41984
    ds_read_b64_tr_b16 v[76:77], v18 offset:45056
    ds_read_b64_tr_b16 v[78:79], v18 offset:46080
    s_waitcnt lgkmcnt(6)
    v_lshlrev_b32 v80, 16, v64
    v_and_b32 v81, 0xffff0000, v64
    v_add_f32 v32, v32, v80
    v_add_f32 v33, v33, v81
    v_fmac_f32 v36, v80, v80
    v_fmac_f32 v37, v81, v81
    v_lshlrev_b32 v82, 16, v65
    v_and_b32 v83, 0xffff0000, v65
    v_add_f32 v34, v34, v82
    v_add_f32 v35, v35, v83
    v_fmac_f32 v38, v82, v82
    v_fmac_f32 v39, v83, v83
    v_lshlrev_b32 v80, 16, v66
    v_and_b32 v81, 0xffff0000, v66
    v_add_f32 v32, v32, v80
    v_add_f32 v33, v33, v81
    v_fmac_f32 v36, v80, v80
    v_fmac_f32 v37, v81, v81
    v_lshlrev_b32 v82, 16, v67
    v_and_b32 v83, 0xffff0000, v67
    v_add_f32 v34, v34, v82
    v_add_f32 v35, v35, v83
    v_fmac_f32 v38, v82, v82
    v_fmac_f32 v39, v83, v83
    s_waitcnt lgkmcnt(4)
    v_lshlrev_b32 v80, 16, v68
    v_and_b32 v81, 0xffff0000, v68
    v_add_f32 v32, v32, v80
    v_add_f32 v33, v33, v81
    v_fmac_f32 v36, v80, v80
    v_fmac_f32 v37, v81, v81
    v_lshlrev_b32 v82, 16, v69
    v_and_b32 v83, 0xffff0000, v69
    v_add_f32 v34, v34, v82
    v_add_f32 v35, v35, v83
    v_fmac_f32 v38, v82, v82
    v_fmac_f32 v39, v83, v83
    v_lshlrev_b32 v80, 16, v70
    v_and_b32 v81, 0xffff0000, v70
    v_add_f32 v32, v32, v80
    v_add_f32 v33, v33, v81
    v_fmac_f32 v36, v80, v80
    v_fmac_f32 v37, v81, v81
    v_lshlrev_b32 v82, 16, v71
    v_and_b32 v83, 0xffff0000, v71
    v_add_f32 v34, v34, v82
    v_add_f32 v35, v35, v83
    v_fmac_f32 v38, v82, v82
    v_fmac_f32 v39, v83, v83
    s_waitcnt lgkmcnt(2)
    v_lshlrev_b32 v80, 16, v72
    v_and_b32 v81, 0xffff0000, v72
    v_add_f32 v32, v32, v80
    v_add_f32 v33, v33, v81
    v_fmac_f32 v36, v80, v80
    v_fmac_f32 v37, v81, v81
    v_lshlrev_b32 v82, 16, v73
    v_and_b32 v83, 0xffff0000, v73
    v_add_f32 v34, v34, v82
    v_add_f32 v35, v35, v83
    v_fmac_f32 v38, v82, v82
    v_fmac_f32 v39, v83, v83
    v_lshlrev_b32 v80, 16, v74
    v_and_b32 v81, 0xffff0000, v74
    v_add_f32 v32, v32, v80
    v_add_f32 v33, v33, v81
    v_fmac_f32 v36, v80, v80
    v_fmac_f32 v37, v81, v81
    v_lshlrev_b32 v82, 16, v75
    v_and_b32 v83, 0xffff0000, v75
    v_add_f32 v34, v34, v82
    v_add_f32 v35, v35, v83
    v_fmac_f32 v38, v82, v82
    v_fmac_f32 v39, v83, v83
    s_waitcnt lgkmcnt(0)
    v_lshlrev_b32 v80, 16, v76
    v_and_b32 v81, 0xffff0000, v76
    v_add_f32 v32, v32, v80
    v_add_f32 v33, v33, v81
    v_fmac_f32 v36, v80, v80
    v_fmac_f32 v37, v81, v81
    v_lshlrev_b32 v82, 16, v77
    v_and_b32 v83, 0xffff0000, v77
    v_add_f32 v34, v34, v82
    v_add_f32 v35, v35, v83
    v_fmac_f32 v38, v82, v82
    v_fmac_f32 v39, v83, v83
    v_lshlrev_b32 v80, 16, v78
    v_and_b32 v81, 0xffff0000, v78
    v_add_f32 v32, v32, v80
    v_add_f32 v33, v33, v81
    v_fmac_f32 v36, v80, v80
    v_fmac_f32 v37, v81, v81
    v_lshlrev_b32 v82, 16, v79
    v_and_b32 v83, 0xffff0000, v79
    v_add_f32 v34, v34, v82
    v_add_f32 v35, v35, v83
    v_fmac_f32 v38, v82, v82
    v_fmac_f32 v39, v83, v83
    s_barrier
    ds_read_b64_tr_b16 v[64:65], v22 offset:0
    ds_read_b64_tr_b16 v[66:67], v22 offset:1024
    ds_read_b64_tr_b16 v[68:69], v22 offset:4096
    ds_read_b64_tr_b16 v[70:71], v22 offset:5120
    ds_read_b64_tr_b16 v[72:73], v22 offset:8192
    ds_read_b64_tr_b16 v[74:75], v22 offset:9216
    ds_read_b64_tr_b16 v[76:77], v22 offset:12288
    ds_read_b64_tr_b16 v[78:79], v22 offset:13312
    s_waitcnt lgkmcnt(6)
    v_lshlrev_b32 v80, 16, v64
    v_and_b32 v81, 0xffff0000, v64
    v_add_f32 v32, v32, v80
    v_add_f32 v33, v33, v81
    v_fmac_f32 v36, v80, v80
    v_fmac_f32 v37, v81, v81
    v_lshlrev_b32 v82, 16, v65
    v_and_b32 v83, 0xffff0000, v65
    v_add_f32 v34, v34, v82
    v_add_f32 v35, v35, v83
    v_fmac_f32 v38, v82, v82
    v_fmac_f32 v39, v83, v83
    v_lshlrev_b32 v80, 16, v66
    v_and_b32 v81, 0xffff0000, v66
    v_add_f32 v32, v32, v80
    v_add_f32 v33, v33, v81
    v_fmac_f32 v36, v80, v80
    v_fmac_f32 v37, v81, v81
    v_lshlrev_b32 v82, 16, v67
    v_and_b32 v83, 0xffff0000, v67
    v_add_f32 v34, v34, v82
    v_add_f32 v35, v35, v83
    v_fmac_f32 v38, v82, v82
    v_fmac_f32 v39, v83, v83
    s_waitcnt lgkmcnt(4)
    v_lshlrev_b32 v80, 16, v68
    v_and_b32 v81, 0xffff0000, v68
    v_add_f32 v32, v32, v80
    v_add_f32 v33, v33, v81
    v_fmac_f32 v36, v80, v80
    v_fmac_f32 v37, v81, v81
    v_lshlrev_b32 v82, 16, v69
    v_and_b32 v83, 0xffff0000, v69
    v_add_f32 v34, v34, v82
    v_add_f32 v35, v35, v83
    v_fmac_f32 v38, v82, v82
    v_fmac_f32 v39, v83, v83
    v_lshlrev_b32 v80, 16, v70
    v_and_b32 v81, 0xffff0000, v70
    v_add_f32 v32, v32, v80
    v_add_f32 v33, v33, v81
    v_fmac_f32 v36, v80, v80
    v_fmac_f32 v37, v81, v81
    v_lshlrev_b32 v82, 16, v71
    v_and_b32 v83, 0xffff0000, v71
    v_add_f32 v34, v34, v82
    v_add_f32 v35, v35, v83
    v_fmac_f32 v38, v82, v82
    v_fmac_f32 v39, v83, v83
    s_waitcnt lgkmcnt(2)
    v_lshlrev_b32 v80, 16, v72
    v_and_b32 v81, 0xffff0000, v72
    v_add_f32 v32, v32, v80
    v_add_f32 v33, v33, v81
    v_fmac_f32 v36, v80, v80
    v_fmac_f32 v37, v81, v81
    v_lshlrev_b32 v82, 16, v73
    v_and_b32 v83, 0xffff0000, v73
    v_add_f32 v34, v34, v82
    v_add_f32 v35, v35, v83
    v_fmac_f32 v38, v82, v82
    v_fmac_f32 v39, v83, v83
    v_lshlrev_b32 v80, 16, v74
    v_and_b32 v81, 0xffff0000, v74
    v_add_f32 v32, v32, v80
    v_add_f32 v33, v33, v81
    v_fmac_f32 v36, v80, v80
    v_fmac_f32 v37, v81, v81
    v_lshlrev_b32 v82, 16, v75
    v_and_b32 v83, 0xffff0000, v75
    v_add_f32 v34, v34, v82
    v_add_f32 v35, v35, v83
    v_fmac_f32 v38, v82, v82
    v_fmac_f32 v39, v83, v83
    s_waitcnt lgkmcnt(0)
    v_lshlrev_b32 v80, 16, v76
    v_and_b32 v81, 0xffff0000, v76
    v_add_f32 v32, v32, v80
    v_add_f32 v33, v33, v81
    v_fmac_f32 v36, v80, v80
    v_fmac_f32 v37, v81, v81
    v_lshlrev_b32 v82, 16, v77
    v_and_b32 v83, 0xffff0000, v77
    v_add_f32 v34, v34, v82
    v_add_f32 v35, v35, v83
    v_fmac_f32 v38, v82, v82
    v_fmac_f32 v39, v83, v83
    v_lshlrev_b32 v80, 16, v78
    v_and_b32 v81, 0xffff0000, v78
    v_add_f32 v32, v32, v80
    v_add_f32 v33, v33, v81
    v_fmac_f32 v36, v80, v80
    v_fmac_f32 v37, v81, v81
    v_lshlrev_b32 v82, 16, v79
    v_and_b32 v83, 0xffff0000, v79
    v_add_f32 v34, v34, v82
    v_add_f32 v35, v35, v83
    v_fmac_f32 v38, v82, v82
    v_fmac_f32 v39, v83, v83
    s_barrier
    ds_read_b64_tr_b16 v[64:65], v22 offset:32768
    ds_read_b64_tr_b16 v[66:67], v22 offset:33792
    ds_read_b64_tr_b16 v[68:69], v22 offset:36864
    ds_read_b64_tr_b16 v[70:71], v22 offset:37888
    ds_read_b64_tr_b16 v[72:73], v22 offset:40960
    ds_read_b64_tr_b16 v[74:75], v22 offset:41984
    ds_read_b64_tr_b16 v[76:77], v22 offset:45056
    ds_read_b64_tr_b16 v[78:79], v22 offset:46080
    s_waitcnt lgkmcnt(6)
    v_lshlrev_b32 v80, 16, v64
    v_and_b32 v81, 0xffff0000, v64
    v_add_f32 v32, v32, v80
    v_add_f32 v33, v33, v81
    v_fmac_f32 v36, v80, v80
    v_fmac_f32 v37, v81, v81
    v_lshlrev_b32 v82, 16, v65
    v_and_b32 v83, 0xffff0000, v65
    v_add_f32 v34, v34, v82
    v_add_f32 v35, v35, v83
    v_fmac_f32 v38, v82, v82
    v_fmac_f32 v39, v83, v83
    v_lshlrev_b32 v80, 16, v66
    v_and_b32 v81, 0xffff0000, v66
    v_add_f32 v32, v32, v80
    v_add_f32 v33, v33, v81
    v_fmac_f32 v36, v80, v80
    v_fmac_f32 v37, v81, v81
    v_lshlrev_b32 v82, 16, v67
    v_and_b32 v83, 0xffff0000, v67
    v_add_f32 v34, v34, v82
    v_add_f32 v35, v35, v83
    v_fmac_f32 v38, v82, v82
    v_fmac_f32 v39, v83, v83
    s_waitcnt lgkmcnt(4)
    v_lshlrev_b32 v80, 16, v68
    v_and_b32 v81, 0xffff0000, v68
    v_add_f32 v32, v32, v80
    v_add_f32 v33, v33, v81
    v_fmac_f32 v36, v80, v80
    v_fmac_f32 v37, v81, v81
    v_lshlrev_b32 v82, 16, v69
    v_and_b32 v83, 0xffff0000, v69
    v_add_f32 v34, v34, v82
    v_add_f32 v35, v35, v83
    v_fmac_f32 v38, v82, v82
    v_fmac_f32 v39, v83, v83
    v_lshlrev_b32 v80, 16, v70
    v_and_b32 v81, 0xffff0000, v70
    v_add_f32 v32, v32, v80
    v_add_f32 v33, v33, v81
    v_fmac_f32 v36, v80, v80
    v_fmac_f32 v37, v81, v81
    v_lshlrev_b32 v82, 16, v71
    v_and_b32 v83, 0xffff0000, v71
    v_add_f32 v34, v34, v82
    v_add_f32 v35, v35, v83
    v_fmac_f32 v38, v82, v82
    v_fmac_f32 v39, v83, v83
    s_waitcnt lgkmcnt(2)
    v_lshlrev_b32 v80, 16, v72
    v_and_b32 v81, 0xffff0000, v72
    v_add_f32 v32, v32, v80
    v_add_f32 v33, v33, v81
    v_fmac_f32 v36, v80, v80
    v_fmac_f32 v37, v81, v81
    v_lshlrev_b32 v82, 16, v73
    v_and_b32 v83, 0xffff0000, v73
    v_add_f32 v34, v34, v82
    v_add_f32 v35, v35, v83
    v_fmac_f32 v38, v82, v82
    v_fmac_f32 v39, v83, v83
    v_lshlrev_b32 v80, 16, v74
    v_and_b32 v81, 0xffff0000, v74
    v_add_f32 v32, v32, v80
    v_add_f32 v33, v33, v81
    v_fmac_f32 v36, v80, v80
    v_fmac_f32 v37, v81, v81
    v_lshlrev_b32 v82, 16, v75
    v_and_b32 v83, 0xffff0000, v75
    v_add_f32 v34, v34, v82
    v_add_f32 v35, v35, v83
    v_fmac_f32 v38, v82, v82
    v_fmac_f32 v39, v83, v83
    s_waitcnt lgkmcnt(0)
    v_lshlrev_b32 v80, 16, v76
    v_and_b32 v81, 0xffff0000, v76
    v_add_f32 v32, v32, v80
    v_add_f32 v33, v33, v81
    v_fmac_f32 v36, v80, v80
    v_fmac_f32 v37, v81, v81
    v_lshlrev_b32 v82, 16, v77
    v_and_b32 v83, 0xffff0000, v77
    v_add_f32 v34, v34, v82
    v_add_f32 v35, v35, v83
    v_fmac_f32 v38, v82, v82
    v_fmac_f32 v39, v83, v83
    v_lshlrev_b32 v80, 16, v78
    v_and_b32 v81, 0xffff0000, v78
    v_add_f32 v32, v32, v80
    v_add_f32 v33, v33, v81
    v_fmac_f32 v36, v80, v80
    v_fmac_f32 v37, v81, v81
    v_lshlrev_b32 v82, 16, v79
    v_and_b32 v83, 0xffff0000, v79
    v_add_f32 v34, v34, v82
    v_add_f32 v35, v35, v83
    v_fmac_f32 v38, v82, v82
    v_fmac_f32 v39, v83, v83
    s_nop 3
    v_add_f32 v32, v32, v33
    v_add_f32 v34, v34, v35
    v_add_f32 v36, v36, v37
    v_add_f32 v38, v38, v39
    v_add_f32 v24, v32, v34
    v_add_f32 v26, v36, v38
    v_mov_b32 v32, v24
    v_mov_b32 v33, v26
    s_nop 1
    v_permlane32_swap_b32 v32, v24
    v_permlane32_swap_b32 v33, v26
    s_nop 1
    v_add_f32 v24, v24, v32
    v_add_f32 v26, v26, v33
    v_mul_f32 v24, 0x3b000000, v24
    v_mul_f32 v26, 0x3b000000, v26
    v_fma_f32 v26, -v24, v24, v26
    v_max_f32 v26, 0, v26
    v_and_b32 v36, 31, v1
    v_lshl_add_u32 v36, v2, 5, v36
    s_cmp_lg_u32 s41, 0
    s_cbranch_scc1 gemm1a_kernel_nopiv
    v_lshlrev_b32 v37, 2, v36
    s_lshl_b32 s48, s40, 9
    s_add_u32 s48, s48, 19988480
    s_add_u32 s49, s48, 8192
    s_add_u32 s50, s48, 16384
    v_mov_b32 v38, 0
    v_cmp_gt_u32 vcc, 32, v1
    s_and_saveexec_b64 s[52:53], vcc
    buffer_store_dword v24, v37, s[32:35], s48 offen
    buffer_store_dword v38, v37, s[32:35], s49 offen
    buffer_store_dword v38, v37, s[32:35], s50 offen
    s_mov_b64 exec, s[52:53]
gemm1a_kernel_nopiv:
    v_cvt_pk_bf16_f32 v39, v24, v26
    v_lshlrev_b32 v40, 16, v39
    v_and_b32 v42, 0xffff0000, v39
    v_add_f32 v42, 0x3727c5ac, v42
    v_cvt_pk_bf16_f32 v39, v42, v42
    v_lshlrev_b32 v42, 16, v39
    v_and_b32 v43, 0xffff0000, v39
    v_sqrt_f32 v42, v42
    s_nop 0
    v_cvt_pk_bf16_f32 v39, v42, v42
    v_lshlrev_b32 v42, 16, v39
    v_and_b32 v43, 0xffff0000, v39
    v_rcp_f32 v41, v42
    v_lshlrev_b32 v37, 3, v36
    v_add_u32 v37, 131072, v37
    ds_write_b64 v37, v[40:41]
    s_waitcnt vmcnt(0)
    ds_write_b32 v31, v30
    s_waitcnt lgkmcnt(0)
    s_barrier
    s_endpgm
gemm1a_kernel_compute:
    v_and_b32 v8, 1, v2
    v_lshrrev_b32 v9, 1, v2
    v_lshrrev_b32 v10, 5, v1
    v_lshl_add_u32 v15, v8, 1, 0
    v_xor_b32 v15, v15, v12
    v_lshl_add_u32 v16, v15, 6, v14
    v_add_u32 v20, 0x10000, v16
    v_lshl_add_u32 v15, v9, 1, 0
    v_xor_b32 v15, v15, v12
    v_lshl_add_u32 v18, v15, 6, v14
    v_add_u32 v18, 0x4000, v18
    v_add_u32 v22, 0x10000, v18
    v_lshl_add_u32 v15, v8, 1, 1
    v_xor_b32 v15, v15, v12
    v_lshl_add_u32 v17, v15, 6, v14
    v_add_u32 v21, 0x10000, v17
    v_lshl_add_u32 v15, v9, 1, 1
    v_xor_b32 v15, v15, v12
    v_lshl_add_u32 v19, v15, 6, v14
    v_add_u32 v19, 0x4000, v19
    v_add_u32 v23, 0x10000, v19
    v_mov_b32 v32, 0
    v_mov_b32 v33, 0
    v_mov_b32 v34, 0
    v_mov_b32 v35, 0
    v_mov_b32 v36, 0
    v_mov_b32 v37, 0
    v_mov_b32 v38, 0
    v_mov_b32 v39, 0
    v_mov_b32 v40, 0
    v_mov_b32 v41, 0
    v_mov_b32 v42, 0
    v_mov_b32 v43, 0
    v_mov_b32 v44, 0
    v_mov_b32 v45, 0
    v_mov_b32 v46, 0
    v_mov_b32 v47, 0
    v_mov_b32 v48, 0
    v_mov_b32 v49, 0
    v_mov_b32 v50, 0
    v_mov_b32 v51, 0
    v_mov_b32 v52, 0
    v_mov_b32 v53, 0
    v_mov_b32 v54, 0
    v_mov_b32 v55, 0
    v_mov_b32 v56, 0
    v_mov_b32 v57, 0
    v_mov_b32 v58, 0
    v_mov_b32 v59, 0
    v_mov_b32 v60, 0
    v_mov_b32 v61, 0
    v_mov_b32 v62, 0
    v_mov_b32 v63, 0
    v_mov_b32 v64, 0
    v_mov_b32 v65, 0
    v_mov_b32 v66, 0
    v_mov_b32 v67, 0
    v_mov_b32 v68, 0
    v_mov_b32 v69, 0
    v_mov_b32 v70, 0
    v_mov_b32 v71, 0
    v_mov_b32 v72, 0
    v_mov_b32 v73, 0
    v_mov_b32 v74, 0
    v_mov_b32 v75, 0
    v_mov_b32 v76, 0
    v_mov_b32 v77, 0
    v_mov_b32 v78, 0
    v_mov_b32 v79, 0
    v_mov_b32 v80, 0
    v_mov_b32 v81, 0
    v_mov_b32 v82, 0
    v_mov_b32 v83, 0
    v_mov_b32 v84, 0
    v_mov_b32 v85, 0
    v_mov_b32 v86, 0
    v_mov_b32 v87, 0
    v_mov_b32 v88, 0
    v_mov_b32 v89, 0
    v_mov_b32 v90, 0
    v_mov_b32 v91, 0
    v_mov_b32 v92, 0
    v_mov_b32 v93, 0
    v_mov_b32 v94, 0
    v_mov_b32 v95, 0
    v_and_b32 v24, 31, v1
    v_lshl_add_u32 v24, v9, 6, v24
    v_lshlrev_b32 v25, 3, v24
    v_add_u32 v25, 131072, v25
    v_mul_u32_u24 v26, 272, v24
    v_lshl_add_u32 v26, v8, 7, v26
    v_lshl_add_u32 v26, v10, 3, v26
    v_lshrrev_b32 v27, 4, v0
    v_and_b32 v30, 15, v0
    v_mul_u32_u24 v31, 272, v27
    v_lshl_add_u32 v31, v30, 4, v31
    v_mul_u32_u24 v27, 3584, v27
    v_lshl_add_u32 v27, v30, 4, v27
    v_lshlrev_b32 v28, 8, v8
    v_lshl_add_u32 v28, v10, 4, v28
    v_add_u32 v28, 132096, v28
    v_mov_b32 v29, 0
    s_mul_i32 s48, s40, 458752
    s_lshl_b32 s49, s41, 8
    s_add_u32 s48, s48, s49
    s_add_u32 s48, s48, 8388608
    s_barrier
    ds_read_b64_tr_b16 v[96:97], v16 offset:0
    ds_read_b64_tr_b16 v[98:99], v16 offset:1024
    ds_read_b64_tr_b16 v[104:105], v18 offset:0
    ds_read_b64_tr_b16 v[106:107], v18 offset:1024
    ds_read_b64_tr_b16 v[100:101], v17 offset:0
    ds_read_b64_tr_b16 v[102:103], v17 offset:1024
    ds_read_b64_tr_b16 v[108:109], v19 offset:0
    ds_read_b64_tr_b16 v[110:111], v19 offset:1024
    ds_read_b64_tr_b16 v[112:113], v16 offset:4096
    ds_read_b64_tr_b16 v[114:115], v16 offset:5120
    ds_read_b64_tr_b16 v[120:121], v18 offset:4096
    ds_read_b64_tr_b16 v[122:123], v18 offset:5120
    ds_read_b64_tr_b16 v[116:117], v17 offset:4096
    ds_read_b64_tr_b16 v[118:119], v17 offset:5120
    ds_read_b64_tr_b16 v[124:125], v19 offset:4096
    ds_read_b64_tr_b16 v[126:127], v19 offset:5120
    s_waitcnt lgkmcnt(8)
    v_mfma_f32_32x32x16_bf16 v[32:47], v[96:99], v[104:107], v[32:47]
    ds_read_b64_tr_b16 v[128:129], v16 offset:8192
    ds_read_b64_tr_b16 v[130:131], v16 offset:9216
    v_mfma_f32_32x32x16_bf16 v[64:79], v[100:103], v[104:107], v[64:79]
    ds_read_b64_tr_b16 v[136:137], v18 offset:8192
    ds_read_b64_tr_b16 v[138:139], v18 offset:9216
    v_mfma_f32_32x32x16_bf16 v[48:63], v[96:99], v[108:111], v[48:63]
    ds_read_b64_tr_b16 v[132:133], v17 offset:8192
    ds_read_b64_tr_b16 v[134:135], v17 offset:9216
    v_mfma_f32_32x32x16_bf16 v[80:95], v[100:103], v[108:111], v[80:95]
    ds_read_b64_tr_b16 v[140:141], v19 offset:8192
    ds_read_b64_tr_b16 v[142:143], v19 offset:9216
    s_waitcnt lgkmcnt(8)
    v_mfma_f32_32x32x16_bf16 v[32:47], v[112:115], v[120:123], v[32:47]
    ds_read_b64_tr_b16 v[96:97], v16 offset:12288
    ds_read_b64_tr_b16 v[98:99], v16 offset:13312
    v_mfma_f32_32x32x16_bf16 v[64:79], v[116:119], v[120:123], v[64:79]
    ds_read_b64_tr_b16 v[104:105], v18 offset:12288
    ds_read_b64_tr_b16 v[106:107], v18 offset:13312
    v_mfma_f32_32x32x16_bf16 v[48:63], v[112:115], v[124:127], v[48:63]
    ds_read_b64_tr_b16 v[100:101], v17 offset:12288
    ds_read_b64_tr_b16 v[102:103], v17 offset:13312
    v_mfma_f32_32x32x16_bf16 v[80:95], v[116:119], v[124:127], v[80:95]
    ds_read_b64_tr_b16 v[108:109], v19 offset:12288
    ds_read_b64_tr_b16 v[110:111], v19 offset:13312
    s_waitcnt lgkmcnt(0)
    v_mfma_f32_32x32x16_bf16 v[32:47], v[128:131], v[136:139], v[32:47]
    s_barrier
    ds_read_b64_tr_b16 v[112:113], v16 offset:32768
    ds_read_b64_tr_b16 v[114:115], v16 offset:33792
    v_mfma_f32_32x32x16_bf16 v[64:79], v[132:135], v[136:139], v[64:79]
    ds_read_b64_tr_b16 v[120:121], v18 offset:32768
    ds_read_b64_tr_b16 v[122:123], v18 offset:33792
    v_mfma_f32_32x32x16_bf16 v[48:63], v[128:131], v[140:143], v[48:63]
    ds_read_b64_tr_b16 v[116:117], v17 offset:32768
    ds_read_b64_tr_b16 v[118:119], v17 offset:33792
    v_mfma_f32_32x32x16_bf16 v[80:95], v[132:135], v[140:143], v[80:95]
    ds_read_b64_tr_b16 v[124:125], v19 offset:32768
    ds_read_b64_tr_b16 v[126:127], v19 offset:33792
    s_waitcnt lgkmcnt(8)
    v_mfma_f32_32x32x16_bf16 v[32:47], v[96:99], v[104:107], v[32:47]
    ds_read_b64_tr_b16 v[128:129], v16 offset:36864
    ds_read_b64_tr_b16 v[130:131], v16 offset:37888
    v_mfma_f32_32x32x16_bf16 v[64:79], v[100:103], v[104:107], v[64:79]
    ds_read_b64_tr_b16 v[136:137], v18 offset:36864
    ds_read_b64_tr_b16 v[138:139], v18 offset:37888
    v_mfma_f32_32x32x16_bf16 v[48:63], v[96:99], v[108:111], v[48:63]
    ds_read_b64_tr_b16 v[132:133], v17 offset:36864
    ds_read_b64_tr_b16 v[134:135], v17 offset:37888
    v_mfma_f32_32x32x16_bf16 v[80:95], v[100:103], v[108:111], v[80:95]
    ds_read_b64_tr_b16 v[140:141], v19 offset:36864
    ds_read_b64_tr_b16 v[142:143], v19 offset:37888
    s_waitcnt lgkmcnt(8)
    v_mfma_f32_32x32x16_bf16 v[32:47], v[112:115], v[120:123], v[32:47]
    ds_read_b64_tr_b16 v[96:97], v16 offset:40960
    ds_read_b64_tr_b16 v[98:99], v16 offset:41984
    v_mfma_f32_32x32x16_bf16 v[64:79], v[116:119], v[120:123], v[64:79]
    ds_read_b64_tr_b16 v[104:105], v18 offset:40960
    ds_read_b64_tr_b16 v[106:107], v18 offset:41984
    v_mfma_f32_32x32x16_bf16 v[48:63], v[112:115], v[124:127], v[48:63]
    ds_read_b64_tr_b16 v[100:101], v17 offset:40960
    ds_read_b64_tr_b16 v[102:103], v17 offset:41984
    v_mfma_f32_32x32x16_bf16 v[80:95], v[116:119], v[124:127], v[80:95]
    ds_read_b64_tr_b16 v[108:109], v19 offset:40960
    ds_read_b64_tr_b16 v[110:111], v19 offset:41984
    s_waitcnt lgkmcnt(8)
    v_mfma_f32_32x32x16_bf16 v[32:47], v[128:131], v[136:139], v[32:47]
    ds_read_b64_tr_b16 v[112:113], v16 offset:45056
    ds_read_b64_tr_b16 v[114:115], v16 offset:46080
    v_mfma_f32_32x32x16_bf16 v[64:79], v[132:135], v[136:139], v[64:79]
    ds_read_b64_tr_b16 v[120:121], v18 offset:45056
    ds_read_b64_tr_b16 v[122:123], v18 offset:46080
    v_mfma_f32_32x32x16_bf16 v[48:63], v[128:131], v[140:143], v[48:63]
    ds_read_b64_tr_b16 v[116:117], v17 offset:45056
    ds_read_b64_tr_b16 v[118:119], v17 offset:46080
    v_mfma_f32_32x32x16_bf16 v[80:95], v[132:135], v[140:143], v[80:95]
    ds_read_b64_tr_b16 v[124:125], v19 offset:45056
    ds_read_b64_tr_b16 v[126:127], v19 offset:46080
    s_waitcnt lgkmcnt(0)
    v_mfma_f32_32x32x16_bf16 v[32:47], v[96:99], v[104:107], v[32:47]
    s_barrier
    ds_read_b64_tr_b16 v[128:129], v20 offset:0
    ds_read_b64_tr_b16 v[130:131], v20 offset:1024
    v_mfma_f32_32x32x16_bf16 v[64:79], v[100:103], v[104:107], v[64:79]
    ds_read_b64_tr_b16 v[136:137], v22 offset:0
    ds_read_b64_tr_b16 v[138:139], v22 offset:1024
    v_mfma_f32_32x32x16_bf16 v[48:63], v[96:99], v[108:111], v[48:63]
    ds_read_b64_tr_b16 v[132:133], v21 offset:0
    ds_read_b64_tr_b16 v[134:135], v21 offset:1024
    v_mfma_f32_32x32x16_bf16 v[80:95], v[100:103], v[108:111], v[80:95]
    ds_read_b64_tr_b16 v[140:141], v23 offset:0
    ds_read_b64_tr_b16 v[142:143], v23 offset:1024
    s_waitcnt lgkmcnt(8)
    v_mfma_f32_32x32x16_bf16 v[32:47], v[112:115], v[120:123], v[32:47]
    ds_read_b64_tr_b16 v[96:97], v20 offset:4096
    ds_read_b64_tr_b16 v[98:99], v20 offset:5120
    v_mfma_f32_32x32x16_bf16 v[64:79], v[116:119], v[120:123], v[64:79]
    ds_read_b64_tr_b16 v[104:105], v22 offset:4096
    ds_read_b64_tr_b16 v[106:107], v22 offset:5120
    v_mfma_f32_32x32x16_bf16 v[48:63], v[112:115], v[124:127], v[48:63]
    ds_read_b64_tr_b16 v[100:101], v21 offset:4096
    ds_read_b64_tr_b16 v[102:103], v21 offset:5120
    v_mfma_f32_32x32x16_bf16 v[80:95], v[116:119], v[124:127], v[80:95]
    ds_read_b64_tr_b16 v[108:109], v23 offset:4096
    ds_read_b64_tr_b16 v[110:111], v23 offset:5120
    s_waitcnt lgkmcnt(8)
    v_mfma_f32_32x32x16_bf16 v[32:47], v[128:131], v[136:139], v[32:47]
    ds_read_b64_tr_b16 v[112:113], v20 offset:8192
    ds_read_b64_tr_b16 v[114:115], v20 offset:9216
    v_mfma_f32_32x32x16_bf16 v[64:79], v[132:135], v[136:139], v[64:79]
    ds_read_b64_tr_b16 v[120:121], v22 offset:8192
    ds_read_b64_tr_b16 v[122:123], v22 offset:9216
    v_mfma_f32_32x32x16_bf16 v[48:63], v[128:131], v[140:143], v[48:63]
    ds_read_b64_tr_b16 v[116:117], v21 offset:8192
    ds_read_b64_tr_b16 v[118:119], v21 offset:9216
    v_mfma_f32_32x32x16_bf16 v[80:95], v[132:135], v[140:143], v[80:95]
    ds_read_b64_tr_b16 v[124:125], v23 offset:8192
    ds_read_b64_tr_b16 v[126:127], v23 offset:9216
    s_waitcnt lgkmcnt(8)
    v_mfma_f32_32x32x16_bf16 v[32:47], v[96:99], v[104:107], v[32:47]
    ds_read_b64_tr_b16 v[128:129], v20 offset:12288
    ds_read_b64_tr_b16 v[130:131], v20 offset:13312
    v_mfma_f32_32x32x16_bf16 v[64:79], v[100:103], v[104:107], v[64:79]
    ds_read_b64_tr_b16 v[136:137], v22 offset:12288
    ds_read_b64_tr_b16 v[138:139], v22 offset:13312
    v_mfma_f32_32x32x16_bf16 v[48:63], v[96:99], v[108:111], v[48:63]
    ds_read_b64_tr_b16 v[132:133], v21 offset:12288
    ds_read_b64_tr_b16 v[134:135], v21 offset:13312
    v_mfma_f32_32x32x16_bf16 v[80:95], v[100:103], v[108:111], v[80:95]
    ds_read_b64_tr_b16 v[140:141], v23 offset:12288
    ds_read_b64_tr_b16 v[142:143], v23 offset:13312
    s_waitcnt lgkmcnt(0)
    v_mfma_f32_32x32x16_bf16 v[32:47], v[112:115], v[120:123], v[32:47]
    s_barrier
    ds_read_b64_tr_b16 v[96:97], v20 offset:32768
    ds_read_b64_tr_b16 v[98:99], v20 offset:33792
    v_mfma_f32_32x32x16_bf16 v[64:79], v[116:119], v[120:123], v[64:79]
    ds_read_b64_tr_b16 v[104:105], v22 offset:32768
    ds_read_b64_tr_b16 v[106:107], v22 offset:33792
    v_mfma_f32_32x32x16_bf16 v[48:63], v[112:115], v[124:127], v[48:63]
    ds_read_b64_tr_b16 v[100:101], v21 offset:32768
    ds_read_b64_tr_b16 v[102:103], v21 offset:33792
    v_mfma_f32_32x32x16_bf16 v[80:95], v[116:119], v[124:127], v[80:95]
    ds_read_b64_tr_b16 v[108:109], v23 offset:32768
    ds_read_b64_tr_b16 v[110:111], v23 offset:33792
    s_waitcnt lgkmcnt(8)
    v_mfma_f32_32x32x16_bf16 v[32:47], v[128:131], v[136:139], v[32:47]
    ds_read_b64_tr_b16 v[112:113], v20 offset:36864
    ds_read_b64_tr_b16 v[114:115], v20 offset:37888
    v_mfma_f32_32x32x16_bf16 v[64:79], v[132:135], v[136:139], v[64:79]
    ds_read_b64_tr_b16 v[120:121], v22 offset:36864
    ds_read_b64_tr_b16 v[122:123], v22 offset:37888
    v_mfma_f32_32x32x16_bf16 v[48:63], v[128:131], v[140:143], v[48:63]
    ds_read_b64_tr_b16 v[116:117], v21 offset:36864
    ds_read_b64_tr_b16 v[118:119], v21 offset:37888
    v_mfma_f32_32x32x16_bf16 v[80:95], v[132:135], v[140:143], v[80:95]
    ds_read_b64_tr_b16 v[124:125], v23 offset:36864
    ds_read_b64_tr_b16 v[126:127], v23 offset:37888
    s_waitcnt lgkmcnt(8)
    v_mfma_f32_32x32x16_bf16 v[32:47], v[96:99], v[104:107], v[32:47]
    ds_read_b64_tr_b16 v[128:129], v20 offset:40960
    ds_read_b64_tr_b16 v[130:131], v20 offset:41984
    v_mfma_f32_32x32x16_bf16 v[64:79], v[100:103], v[104:107], v[64:79]
    ds_read_b64_tr_b16 v[136:137], v22 offset:40960
    ds_read_b64_tr_b16 v[138:139], v22 offset:41984
    v_mfma_f32_32x32x16_bf16 v[48:63], v[96:99], v[108:111], v[48:63]
    ds_read_b64_tr_b16 v[132:133], v21 offset:40960
    ds_read_b64_tr_b16 v[134:135], v21 offset:41984
    v_mfma_f32_32x32x16_bf16 v[80:95], v[100:103], v[108:111], v[80:95]
    ds_read_b64_tr_b16 v[140:141], v23 offset:40960
    ds_read_b64_tr_b16 v[142:143], v23 offset:41984
    s_waitcnt lgkmcnt(8)
    v_mfma_f32_32x32x16_bf16 v[32:47], v[112:115], v[120:123], v[32:47]
    ds_read_b64_tr_b16 v[96:97], v20 offset:45056
    ds_read_b64_tr_b16 v[98:99], v20 offset:46080
    v_mfma_f32_32x32x16_bf16 v[64:79], v[116:119], v[120:123], v[64:79]
    ds_read_b64_tr_b16 v[104:105], v22 offset:45056
    ds_read_b64_tr_b16 v[106:107], v22 offset:46080
    v_mfma_f32_32x32x16_bf16 v[48:63], v[112:115], v[124:127], v[48:63]
    ds_read_b64_tr_b16 v[100:101], v21 offset:45056
    ds_read_b64_tr_b16 v[102:103], v21 offset:46080
    v_mfma_f32_32x32x16_bf16 v[80:95], v[116:119], v[124:127], v[80:95]
    ds_read_b64_tr_b16 v[108:109], v23 offset:45056
    ds_read_b64_tr_b16 v[110:111], v23 offset:46080
    s_waitcnt lgkmcnt(0)
    v_mfma_f32_32x32x16_bf16 v[32:47], v[128:131], v[136:139], v[32:47]
    s_barrier
    ds_read_b64_tr_b16 v[112:113], v16 offset:0
    ds_read_b64_tr_b16 v[114:115], v16 offset:1024
    v_mfma_f32_32x32x16_bf16 v[64:79], v[132:135], v[136:139], v[64:79]
    ds_read_b64_tr_b16 v[120:121], v18 offset:0
    ds_read_b64_tr_b16 v[122:123], v18 offset:1024
    v_mfma_f32_32x32x16_bf16 v[48:63], v[128:131], v[140:143], v[48:63]
    ds_read_b64_tr_b16 v[116:117], v17 offset:0
    ds_read_b64_tr_b16 v[118:119], v17 offset:1024
    v_mfma_f32_32x32x16_bf16 v[80:95], v[132:135], v[140:143], v[80:95]
    ds_read_b64_tr_b16 v[124:125], v19 offset:0
    ds_read_b64_tr_b16 v[126:127], v19 offset:1024
    s_waitcnt lgkmcnt(8)
    v_mfma_f32_32x32x16_bf16 v[32:47], v[96:99], v[104:107], v[32:47]
    ds_read_b64_tr_b16 v[128:129], v16 offset:4096
    ds_read_b64_tr_b16 v[130:131], v16 offset:5120
    v_mfma_f32_32x32x16_bf16 v[64:79], v[100:103], v[104:107], v[64:79]
    ds_read_b64_tr_b16 v[136:137], v18 offset:4096
    ds_read_b64_tr_b16 v[138:139], v18 offset:5120
    v_mfma_f32_32x32x16_bf16 v[48:63], v[96:99], v[108:111], v[48:63]
    ds_read_b64_tr_b16 v[132:133], v17 offset:4096
    ds_read_b64_tr_b16 v[134:135], v17 offset:5120
    v_mfma_f32_32x32x16_bf16 v[80:95], v[100:103], v[108:111], v[80:95]
    ds_read_b64_tr_b16 v[140:141], v19 offset:4096
    ds_read_b64_tr_b16 v[142:143], v19 offset:5120
    s_waitcnt lgkmcnt(8)
    v_mfma_f32_32x32x16_bf16 v[32:47], v[112:115], v[120:123], v[32:47]
    ds_read_b64_tr_b16 v[96:97], v16 offset:8192
    ds_read_b64_tr_b16 v[98:99], v16 offset:9216
    v_mfma_f32_32x32x16_bf16 v[64:79], v[116:119], v[120:123], v[64:79]
    ds_read_b64_tr_b16 v[104:105], v18 offset:8192
    ds_read_b64_tr_b16 v[106:107], v18 offset:9216
    v_mfma_f32_32x32x16_bf16 v[48:63], v[112:115], v[124:127], v[48:63]
    ds_read_b64_tr_b16 v[100:101], v17 offset:8192
    ds_read_b64_tr_b16 v[102:103], v17 offset:9216
    v_mfma_f32_32x32x16_bf16 v[80:95], v[116:119], v[124:127], v[80:95]
    ds_read_b64_tr_b16 v[108:109], v19 offset:8192
    ds_read_b64_tr_b16 v[110:111], v19 offset:9216
    s_waitcnt lgkmcnt(8)
    v_mfma_f32_32x32x16_bf16 v[32:47], v[128:131], v[136:139], v[32:47]
    ds_read_b64_tr_b16 v[112:113], v16 offset:12288
    ds_read_b64_tr_b16 v[114:115], v16 offset:13312
    v_mfma_f32_32x32x16_bf16 v[64:79], v[132:135], v[136:139], v[64:79]
    ds_read_b64_tr_b16 v[120:121], v18 offset:12288
    ds_read_b64_tr_b16 v[122:123], v18 offset:13312
    v_mfma_f32_32x32x16_bf16 v[48:63], v[128:131], v[140:143], v[48:63]
    ds_read_b64_tr_b16 v[116:117], v17 offset:12288
    ds_read_b64_tr_b16 v[118:119], v17 offset:13312
    v_mfma_f32_32x32x16_bf16 v[80:95], v[132:135], v[140:143], v[80:95]
    ds_read_b64_tr_b16 v[124:125], v19 offset:12288
    ds_read_b64_tr_b16 v[126:127], v19 offset:13312
    s_waitcnt lgkmcnt(0)
    v_mfma_f32_32x32x16_bf16 v[32:47], v[96:99], v[104:107], v[32:47]
    s_barrier
    ds_read_b64_tr_b16 v[128:129], v16 offset:32768
    ds_read_b64_tr_b16 v[130:131], v16 offset:33792
    v_mfma_f32_32x32x16_bf16 v[64:79], v[100:103], v[104:107], v[64:79]
    ds_read_b64_tr_b16 v[136:137], v18 offset:32768
    ds_read_b64_tr_b16 v[138:139], v18 offset:33792
    v_mfma_f32_32x32x16_bf16 v[48:63], v[96:99], v[108:111], v[48:63]
    ds_read_b64_tr_b16 v[132:133], v17 offset:32768
    ds_read_b64_tr_b16 v[134:135], v17 offset:33792
    v_mfma_f32_32x32x16_bf16 v[80:95], v[100:103], v[108:111], v[80:95]
    ds_read_b64_tr_b16 v[140:141], v19 offset:32768
    ds_read_b64_tr_b16 v[142:143], v19 offset:33792
    s_waitcnt lgkmcnt(8)
    v_mfma_f32_32x32x16_bf16 v[32:47], v[112:115], v[120:123], v[32:47]
    ds_read_b64_tr_b16 v[96:97], v16 offset:36864
    ds_read_b64_tr_b16 v[98:99], v16 offset:37888
    v_mfma_f32_32x32x16_bf16 v[64:79], v[116:119], v[120:123], v[64:79]
    ds_read_b64_tr_b16 v[104:105], v18 offset:36864
    ds_read_b64_tr_b16 v[106:107], v18 offset:37888
    v_mfma_f32_32x32x16_bf16 v[48:63], v[112:115], v[124:127], v[48:63]
    ds_read_b64_tr_b16 v[100:101], v17 offset:36864
    ds_read_b64_tr_b16 v[102:103], v17 offset:37888
    v_mfma_f32_32x32x16_bf16 v[80:95], v[116:119], v[124:127], v[80:95]
    ds_read_b64_tr_b16 v[108:109], v19 offset:36864
    ds_read_b64_tr_b16 v[110:111], v19 offset:37888
    s_waitcnt lgkmcnt(8)
    v_mfma_f32_32x32x16_bf16 v[32:47], v[128:131], v[136:139], v[32:47]
    ds_read_b64_tr_b16 v[112:113], v16 offset:40960
    ds_read_b64_tr_b16 v[114:115], v16 offset:41984
    v_mfma_f32_32x32x16_bf16 v[64:79], v[132:135], v[136:139], v[64:79]
    ds_read_b64_tr_b16 v[120:121], v18 offset:40960
    ds_read_b64_tr_b16 v[122:123], v18 offset:41984
    v_mfma_f32_32x32x16_bf16 v[48:63], v[128:131], v[140:143], v[48:63]
    ds_read_b64_tr_b16 v[116:117], v17 offset:40960
    ds_read_b64_tr_b16 v[118:119], v17 offset:41984
    v_mfma_f32_32x32x16_bf16 v[80:95], v[132:135], v[140:143], v[80:95]
    ds_read_b64_tr_b16 v[124:125], v19 offset:40960
    ds_read_b64_tr_b16 v[126:127], v19 offset:41984
    s_waitcnt lgkmcnt(8)
    v_mfma_f32_32x32x16_bf16 v[32:47], v[96:99], v[104:107], v[32:47]
    ds_read_b64_tr_b16 v[128:129], v16 offset:45056
    ds_read_b64_tr_b16 v[130:131], v16 offset:46080
    v_mfma_f32_32x32x16_bf16 v[64:79], v[100:103], v[104:107], v[64:79]
    ds_read_b64_tr_b16 v[136:137], v18 offset:45056
    ds_read_b64_tr_b16 v[138:139], v18 offset:46080
    v_mfma_f32_32x32x16_bf16 v[48:63], v[96:99], v[108:111], v[48:63]
    ds_read_b64_tr_b16 v[132:133], v17 offset:45056
    ds_read_b64_tr_b16 v[134:135], v17 offset:46080
    v_mfma_f32_32x32x16_bf16 v[80:95], v[100:103], v[108:111], v[80:95]
    ds_read_b64_tr_b16 v[140:141], v19 offset:45056
    ds_read_b64_tr_b16 v[142:143], v19 offset:46080
    s_waitcnt lgkmcnt(0)
    v_mfma_f32_32x32x16_bf16 v[32:47], v[112:115], v[120:123], v[32:47]
    s_barrier
    ds_read_b64_tr_b16 v[96:97], v20 offset:0
    ds_read_b64_tr_b16 v[98:99], v20 offset:1024
    v_mfma_f32_32x32x16_bf16 v[64:79], v[116:119], v[120:123], v[64:79]
    ds_read_b64_tr_b16 v[104:105], v22 offset:0
    ds_read_b64_tr_b16 v[106:107], v22 offset:1024
    v_mfma_f32_32x32x16_bf16 v[48:63], v[112:115], v[124:127], v[48:63]
    ds_read_b64_tr_b16 v[100:101], v21 offset:0
    ds_read_b64_tr_b16 v[102:103], v21 offset:1024
    v_mfma_f32_32x32x16_bf16 v[80:95], v[116:119], v[124:127], v[80:95]
    ds_read_b64_tr_b16 v[108:109], v23 offset:0
    ds_read_b64_tr_b16 v[110:111], v23 offset:1024
    s_waitcnt lgkmcnt(8)
    v_mfma_f32_32x32x16_bf16 v[32:47], v[128:131], v[136:139], v[32:47]
    ds_read_b64_tr_b16 v[112:113], v20 offset:4096
    ds_read_b64_tr_b16 v[114:115], v20 offset:5120
    v_mfma_f32_32x32x16_bf16 v[64:79], v[132:135], v[136:139], v[64:79]
    ds_read_b64_tr_b16 v[120:121], v22 offset:4096
    ds_read_b64_tr_b16 v[122:123], v22 offset:5120
    v_mfma_f32_32x32x16_bf16 v[48:63], v[128:131], v[140:143], v[48:63]
    ds_read_b64_tr_b16 v[116:117], v21 offset:4096
    ds_read_b64_tr_b16 v[118:119], v21 offset:5120
    v_mfma_f32_32x32x16_bf16 v[80:95], v[132:135], v[140:143], v[80:95]
    ds_read_b64_tr_b16 v[124:125], v23 offset:4096
    ds_read_b64_tr_b16 v[126:127], v23 offset:5120
    s_waitcnt lgkmcnt(8)
    v_mfma_f32_32x32x16_bf16 v[32:47], v[96:99], v[104:107], v[32:47]
    ds_read_b64_tr_b16 v[128:129], v20 offset:8192
    ds_read_b64_tr_b16 v[130:131], v20 offset:9216
    v_mfma_f32_32x32x16_bf16 v[64:79], v[100:103], v[104:107], v[64:79]
    ds_read_b64_tr_b16 v[136:137], v22 offset:8192
    ds_read_b64_tr_b16 v[138:139], v22 offset:9216
    v_mfma_f32_32x32x16_bf16 v[48:63], v[96:99], v[108:111], v[48:63]
    ds_read_b64_tr_b16 v[132:133], v21 offset:8192
    ds_read_b64_tr_b16 v[134:135], v21 offset:9216
    v_mfma_f32_32x32x16_bf16 v[80:95], v[100:103], v[108:111], v[80:95]
    ds_read_b64_tr_b16 v[140:141], v23 offset:8192
    ds_read_b64_tr_b16 v[142:143], v23 offset:9216
    s_waitcnt lgkmcnt(8)
    v_mfma_f32_32x32x16_bf16 v[32:47], v[112:115], v[120:123], v[32:47]
    ds_read_b64_tr_b16 v[96:97], v20 offset:12288
    ds_read_b64_tr_b16 v[98:99], v20 offset:13312
    v_mfma_f32_32x32x16_bf16 v[64:79], v[116:119], v[120:123], v[64:79]
    ds_read_b64_tr_b16 v[104:105], v22 offset:12288
    ds_read_b64_tr_b16 v[106:107], v22 offset:13312
    v_mfma_f32_32x32x16_bf16 v[48:63], v[112:115], v[124:127], v[48:63]
    ds_read_b64_tr_b16 v[100:101], v21 offset:12288
    ds_read_b64_tr_b16 v[102:103], v21 offset:13312
    v_mfma_f32_32x32x16_bf16 v[80:95], v[116:119], v[124:127], v[80:95]
    ds_read_b64_tr_b16 v[108:109], v23 offset:12288
    ds_read_b64_tr_b16 v[110:111], v23 offset:13312
    s_waitcnt lgkmcnt(0)
    v_mfma_f32_32x32x16_bf16 v[32:47], v[128:131], v[136:139], v[32:47]
    s_barrier
    ds_read_b64_tr_b16 v[112:113], v20 offset:32768
    ds_read_b64_tr_b16 v[114:115], v20 offset:33792
    v_mfma_f32_32x32x16_bf16 v[64:79], v[132:135], v[136:139], v[64:79]
    ds_read_b64_tr_b16 v[120:121], v22 offset:32768
    ds_read_b64_tr_b16 v[122:123], v22 offset:33792
    v_mfma_f32_32x32x16_bf16 v[48:63], v[128:131], v[140:143], v[48:63]
    ds_read_b64_tr_b16 v[116:117], v21 offset:32768
    ds_read_b64_tr_b16 v[118:119], v21 offset:33792
    v_mfma_f32_32x32x16_bf16 v[80:95], v[132:135], v[140:143], v[80:95]
    ds_read_b64_tr_b16 v[124:125], v23 offset:32768
    ds_read_b64_tr_b16 v[126:127], v23 offset:33792
    s_waitcnt lgkmcnt(8)
    v_mfma_f32_32x32x16_bf16 v[32:47], v[96:99], v[104:107], v[32:47]
    ds_read_b64_tr_b16 v[128:129], v20 offset:36864
    ds_read_b64_tr_b16 v[130:131], v20 offset:37888
    v_mfma_f32_32x32x16_bf16 v[64:79], v[100:103], v[104:107], v[64:79]
    ds_read_b64_tr_b16 v[136:137], v22 offset:36864
    ds_read_b64_tr_b16 v[138:139], v22 offset:37888
    v_mfma_f32_32x32x16_bf16 v[48:63], v[96:99], v[108:111], v[48:63]
    ds_read_b64_tr_b16 v[132:133], v21 offset:36864
    ds_read_b64_tr_b16 v[134:135], v21 offset:37888
    v_mfma_f32_32x32x16_bf16 v[80:95], v[100:103], v[108:111], v[80:95]
    ds_read_b64_tr_b16 v[140:141], v23 offset:36864
    ds_read_b64_tr_b16 v[142:143], v23 offset:37888
    s_waitcnt lgkmcnt(8)
    v_mfma_f32_32x32x16_bf16 v[32:47], v[112:115], v[120:123], v[32:47]
    ds_read_b64_tr_b16 v[96:97], v20 offset:40960
    ds_read_b64_tr_b16 v[98:99], v20 offset:41984
    v_mfma_f32_32x32x16_bf16 v[64:79], v[116:119], v[120:123], v[64:79]
    ds_read_b64_tr_b16 v[104:105], v22 offset:40960
    ds_read_b64_tr_b16 v[106:107], v22 offset:41984
    v_mfma_f32_32x32x16_bf16 v[48:63], v[112:115], v[124:127], v[48:63]
    ds_read_b64_tr_b16 v[100:101], v21 offset:40960
    ds_read_b64_tr_b16 v[102:103], v21 offset:41984
    v_mfma_f32_32x32x16_bf16 v[80:95], v[116:119], v[124:127], v[80:95]
    ds_read_b64_tr_b16 v[108:109], v23 offset:40960
    ds_read_b64_tr_b16 v[110:111], v23 offset:41984
    s_waitcnt lgkmcnt(8)
    v_mfma_f32_32x32x16_bf16 v[32:47], v[128:131], v[136:139], v[32:47]
    ds_read_b64_tr_b16 v[112:113], v20 offset:45056
    ds_read_b64_tr_b16 v[114:115], v20 offset:46080
    v_mfma_f32_32x32x16_bf16 v[64:79], v[132:135], v[136:139], v[64:79]
    ds_read_b64_tr_b16 v[120:121], v22 offset:45056
    ds_read_b64_tr_b16 v[122:123], v22 offset:46080
    v_mfma_f32_32x32x16_bf16 v[48:63], v[128:131], v[140:143], v[48:63]
    ds_read_b64_tr_b16 v[116:117], v21 offset:45056
    ds_read_b64_tr_b16 v[118:119], v21 offset:46080
    v_mfma_f32_32x32x16_bf16 v[80:95], v[132:135], v[140:143], v[80:95]
    ds_read_b64_tr_b16 v[124:125], v23 offset:45056
    ds_read_b64_tr_b16 v[126:127], v23 offset:46080
    s_waitcnt lgkmcnt(8)
    v_mfma_f32_32x32x16_bf16 v[32:47], v[96:99], v[104:107], v[32:47]
    v_mfma_f32_32x32x16_bf16 v[64:79], v[100:103], v[104:107], v[64:79]
    v_mfma_f32_32x32x16_bf16 v[48:63], v[96:99], v[108:111], v[48:63]
    v_mfma_f32_32x32x16_bf16 v[80:95], v[100:103], v[108:111], v[80:95]
    s_waitcnt lgkmcnt(0)
    v_mfma_f32_32x32x16_bf16 v[32:47], v[112:115], v[120:123], v[32:47]
    v_mfma_f32_32x32x16_bf16 v[64:79], v[116:119], v[120:123], v[64:79]
    v_mfma_f32_32x32x16_bf16 v[48:63], v[112:115], v[124:127], v[48:63]
    v_mfma_f32_32x32x16_bf16 v[80:95], v[116:119], v[124:127], v[80:95]
    s_barrier
    ds_read_b64 v[144:145], v25
    ds_read_b64 v[148:149], v25 offset:256
    ds_read_b128 v[96:99], v28 offset:0
    ds_read_b128 v[100:103], v28 offset:32
    ds_read_b128 v[104:107], v28 offset:64
    ds_read_b128 v[108:111], v28 offset:96
    ds_read_b128 v[112:115], v28 offset:128
    ds_read_b128 v[116:119], v28 offset:160
    ds_read_b128 v[120:123], v28 offset:192
    ds_read_b128 v[124:127], v28 offset:224
    s_waitcnt lgkmcnt(8)
    v_mov_b32 v146, v145
    v_mov_b32 v147, v145
    v_mov_b32 v145, v144
    v_mov_b32 v150, v149
    v_mov_b32 v151, v149
    v_mov_b32 v149, v148
    s_waitcnt lgkmcnt(0)
    v_pk_fma_f32 v[32:33], v[144:145], v[96:97], v[32:33] neg_lo:[1,0,0] neg_hi:[1,0,0]
    v_pk_fma_f32 v[34:35], v[144:145], v[98:99], v[34:35] neg_lo:[1,0,0] neg_hi:[1,0,0]
    v_pk_fma_f32 v[36:37], v[144:145], v[100:101], v[36:37] neg_lo:[1,0,0] neg_hi:[1,0,0]
    v_pk_fma_f32 v[38:39], v[144:145], v[102:103], v[38:39] neg_lo:[1,0,0] neg_hi:[1,0,0]
    v_pk_fma_f32 v[40:41], v[144:145], v[104:105], v[40:41] neg_lo:[1,0,0] neg_hi:[1,0,0]
    v_pk_fma_f32 v[42:43], v[144:145], v[106:107], v[42:43] neg_lo:[1,0,0] neg_hi:[1,0,0]
    v_pk_fma_f32 v[44:45], v[144:145], v[108:109], v[44:45] neg_lo:[1,0,0] neg_hi:[1,0,0]
    v_pk_fma_f32 v[46:47], v[144:145], v[110:111], v[46:47] neg_lo:[1,0,0] neg_hi:[1,0,0]
    v_pk_mul_f32 v[32:33], v[32:33], v[146:147]
    v_pk_mul_f32 v[34:35], v[34:35], v[146:147]
    v_pk_mul_f32 v[36:37], v[36:37], v[146:147]
    v_pk_mul_f32 v[38:39], v[38:39], v[146:147]
    v_pk_mul_f32 v[40:41], v[40:41], v[146:147]
    v_pk_mul_f32 v[42:43], v[42:43], v[146:147]
    v_pk_mul_f32 v[44:45], v[44:45], v[146:147]
    v_pk_mul_f32 v[46:47], v[46:47], v[146:147]
    v_cvt_pk_bf16_f32 v128, v32, v33
    v_cvt_pk_bf16_f32 v129, v34, v35
    v_cvt_pk_bf16_f32 v130, v36, v37
    v_cvt_pk_bf16_f32 v131, v38, v39
    v_cvt_pk_bf16_f32 v132, v40, v41
    v_cvt_pk_bf16_f32 v133, v42, v43
    v_cvt_pk_bf16_f32 v134, v44, v45
    v_cvt_pk_bf16_f32 v135, v46, v47
    v_pk_max_i16 v128, v128, v29
    v_pk_max_i16 v129, v129, v29
    v_pk_max_i16 v130, v130, v29
    v_pk_max_i16 v131, v131, v29
    v_pk_max_i16 v132, v132, v29
    v_pk_max_i16 v133, v133, v29
    v_pk_max_i16 v134, v134, v29
    v_pk_max_i16 v135, v135, v29
    ds_write_b64 v26, v[128:129] offset:0
    ds_write_b64 v26, v[130:131] offset:16
    ds_write_b64 v26, v[132:133] offset:32
    ds_write_b64 v26, v[134:135] offset:48
    v_pk_fma_f32 v[48:49], v[148:149], v[96:97], v[48:49] neg_lo:[1,0,0] neg_hi:[1,0,0]
    v_pk_fma_f32 v[50:51], v[148:149], v[98:99], v[50:51] neg_lo:[1,0,0] neg_hi:[1,0,0]
    v_pk_fma_f32 v[52:53], v[148:149], v[100:101], v[52:53] neg_lo:[1,0,0] neg_hi:[1,0,0]
    v_pk_fma_f32 v[54:55], v[148:149], v[102:103], v[54:55] neg_lo:[1,0,0] neg_hi:[1,0,0]
    v_pk_fma_f32 v[56:57], v[148:149], v[104:105], v[56:57] neg_lo:[1,0,0] neg_hi:[1,0,0]
    v_pk_fma_f32 v[58:59], v[148:149], v[106:107], v[58:59] neg_lo:[1,0,0] neg_hi:[1,0,0]
    v_pk_fma_f32 v[60:61], v[148:149], v[108:109], v[60:61] neg_lo:[1,0,0] neg_hi:[1,0,0]
    v_pk_fma_f32 v[62:63], v[148:149], v[110:111], v[62:63] neg_lo:[1,0,0] neg_hi:[1,0,0]
    v_pk_mul_f32 v[48:49], v[48:49], v[150:151]
    v_pk_mul_f32 v[50:51], v[50:51], v[150:151]
    v_pk_mul_f32 v[52:53], v[52:53], v[150:151]
    v_pk_mul_f32 v[54:55], v[54:55], v[150:151]
    v_pk_mul_f32 v[56:57], v[56:57], v[150:151]
    v_pk_mul_f32 v[58:59], v[58:59], v[150:151]
    v_pk_mul_f32 v[60:61], v[60:61], v[150:151]
    v_pk_mul_f32 v[62:63], v[62:63], v[150:151]
    v_cvt_pk_bf16_f32 v136, v48, v49
    v_cvt_pk_bf16_f32 v137, v50, v51
    v_cvt_pk_bf16_f32 v138, v52, v53
    v_cvt_pk_bf16_f32 v139, v54, v55
    v_cvt_pk_bf16_f32 v140, v56, v57
    v_cvt_pk_bf16_f32 v141, v58, v59
    v_cvt_pk_bf16_f32 v142, v60, v61
    v_cvt_pk_bf16_f32 v143, v62, v63
    v_pk_max_i16 v136, v136, v29
    v_pk_max_i16 v137, v137, v29
    v_pk_max_i16 v138, v138, v29
    v_pk_max_i16 v139, v139, v29
    v_pk_max_i16 v140, v140, v29
    v_pk_max_i16 v141, v141, v29
    v_pk_max_i16 v142, v142, v29
    v_pk_max_i16 v143, v143, v29
    ds_write_b64 v26, v[136:137] offset:8704
    ds_write_b64 v26, v[138:139] offset:8720
    ds_write_b64 v26, v[140:141] offset:8736
    ds_write_b64 v26, v[142:143] offset:8752
    v_pk_fma_f32 v[64:65], v[144:145], v[112:113], v[64:65] neg_lo:[1,0,0] neg_hi:[1,0,0]
    v_pk_fma_f32 v[66:67], v[144:145], v[114:115], v[66:67] neg_lo:[1,0,0] neg_hi:[1,0,0]
    v_pk_fma_f32 v[68:69], v[144:145], v[116:117], v[68:69] neg_lo:[1,0,0] neg_hi:[1,0,0]
    v_pk_fma_f32 v[70:71], v[144:145], v[118:119], v[70:71] neg_lo:[1,0,0] neg_hi:[1,0,0]
    v_pk_fma_f32 v[72:73], v[144:145], v[120:121], v[72:73] neg_lo:[1,0,0] neg_hi:[1,0,0]
    v_pk_fma_f32 v[74:75], v[144:145], v[122:123], v[74:75] neg_lo:[1,0,0] neg_hi:[1,0,0]
    v_pk_fma_f32 v[76:77], v[144:145], v[124:125], v[76:77] neg_lo:[1,0,0] neg_hi:[1,0,0]
    v_pk_fma_f32 v[78:79], v[144:145], v[126:127], v[78:79] neg_lo:[1,0,0] neg_hi:[1,0,0]
    v_pk_mul_f32 v[64:65], v[64:65], v[146:147]
    v_pk_mul_f32 v[66:67], v[66:67], v[146:147]
    v_pk_mul_f32 v[68:69], v[68:69], v[146:147]
    v_pk_mul_f32 v[70:71], v[70:71], v[146:147]
    v_pk_mul_f32 v[72:73], v[72:73], v[146:147]
    v_pk_mul_f32 v[74:75], v[74:75], v[146:147]
    v_pk_mul_f32 v[76:77], v[76:77], v[146:147]
    v_pk_mul_f32 v[78:79], v[78:79], v[146:147]
    v_cvt_pk_bf16_f32 v128, v64, v65
    v_cvt_pk_bf16_f32 v129, v66, v67
    v_cvt_pk_bf16_f32 v130, v68, v69
    v_cvt_pk_bf16_f32 v131, v70, v71
    v_cvt_pk_bf16_f32 v132, v72, v73
    v_cvt_pk_bf16_f32 v133, v74, v75
    v_cvt_pk_bf16_f32 v134, v76, v77
    v_cvt_pk_bf16_f32 v135, v78, v79
    v_pk_max_i16 v128, v128, v29
    v_pk_max_i16 v129, v129, v29
    v_pk_max_i16 v130, v130, v29
    v_pk_max_i16 v131, v131, v29
    v_pk_max_i16 v132, v132, v29
    v_pk_max_i16 v133, v133, v29
    v_pk_max_i16 v134, v134, v29
    v_pk_max_i16 v135, v135, v29
    ds_write_b64 v26, v[128:129] offset:64
    ds_write_b64 v26, v[130:131] offset:80
    ds_write_b64 v26, v[132:133] offset:96
    ds_write_b64 v26, v[134:135] offset:112
    v_pk_fma_f32 v[80:81], v[148:149], v[112:113], v[80:81] neg_lo:[1,0,0] neg_hi:[1,0,0]
    v_pk_fma_f32 v[82:83], v[148:149], v[114:115], v[82:83] neg_lo:[1,0,0] neg_hi:[1,0,0]
    v_pk_fma_f32 v[84:85], v[148:149], v[116:117], v[84:85] neg_lo:[1,0,0] neg_hi:[1,0,0]
    v_pk_fma_f32 v[86:87], v[148:149], v[118:119], v[86:87] neg_lo:[1,0,0] neg_hi:[1,0,0]
    v_pk_fma_f32 v[88:89], v[148:149], v[120:121], v[88:89] neg_lo:[1,0,0] neg_hi:[1,0,0]
    v_pk_fma_f32 v[90:91], v[148:149], v[122:123], v[90:91] neg_lo:[1,0,0] neg_hi:[1,0,0]
    v_pk_fma_f32 v[92:93], v[148:149], v[124:125], v[92:93] neg_lo:[1,0,0] neg_hi:[1,0,0]
    v_pk_fma_f32 v[94:95], v[148:149], v[126:127], v[94:95] neg_lo:[1,0,0] neg_hi:[1,0,0]
    v_pk_mul_f32 v[80:81], v[80:81], v[150:151]
    v_pk_mul_f32 v[82:83], v[82:83], v[150:151]
    v_pk_mul_f32 v[84:85], v[84:85], v[150:151]
    v_pk_mul_f32 v[86:87], v[86:87], v[150:151]
    v_pk_mul_f32 v[88:89], v[88:89], v[150:151]
    v_pk_mul_f32 v[90:91], v[90:91], v[150:151]
    v_pk_mul_f32 v[92:93], v[92:93], v[150:151]
    v_pk_mul_f32 v[94:95], v[94:95], v[150:151]
    v_cvt_pk_bf16_f32 v136, v80, v81
    v_cvt_pk_bf16_f32 v137, v82, v83
    v_cvt_pk_bf16_f32 v138, v84, v85
    v_cvt_pk_bf16_f32 v139, v86, v87
    v_cvt_pk_bf16_f32 v140, v88, v89
    v_cvt_pk_bf16_f32 v141, v90, v91
    v_cvt_pk_bf16_f32 v142, v92, v93
    v_cvt_pk_bf16_f32 v143, v94, v95
    v_pk_max_i16 v136, v136, v29
    v_pk_max_i16 v137, v137, v29
    v_pk_max_i16 v138, v138, v29
    v_pk_max_i16 v139, v139, v29
    v_pk_max_i16 v140, v140, v29
    v_pk_max_i16 v141, v141, v29
    v_pk_max_i16 v142, v142, v29
    v_pk_max_i16 v143, v143, v29
    ds_write_b64 v26, v[136:137] offset:8768
    ds_write_b64 v26, v[138:139] offset:8784
    ds_write_b64 v26, v[140:141] offset:8800
    ds_write_b64 v26, v[142:143] offset:8816
    s_waitcnt lgkmcnt(0)
    s_barrier
    ds_read_b128 v[32:35], v31 offset:0
    ds_read_b128 v[36:39], v31 offset:4352
    ds_read_b128 v[40:43], v31 offset:8704
    ds_read_b128 v[44:47], v31 offset:13056
    ds_read_b128 v[48:51], v31 offset:17408
    ds_read_b128 v[52:55], v31 offset:21760
    ds_read_b128 v[56:59], v31 offset:26112
    ds_read_b128 v[60:63], v31 offset:30464
    s_waitcnt lgkmcnt(7)
    buffer_store_dwordx4 v[32:35], v27, s[32:35], s48 offen sc0 sc1
    s_add_u32 s48, s48, 57344
    s_waitcnt lgkmcnt(6)
    buffer_store_dwordx4 v[36:39], v27, s[32:35], s48 offen sc0 sc1
    s_add_u32 s48, s48, 57344
    s_waitcnt lgkmcnt(5)
    buffer_store_dwordx4 v[40:43], v27, s[32:35], s48 offen sc0 sc1
    s_add_u32 s48, s48, 57344
    s_waitcnt lgkmcnt(4)
    buffer_store_dwordx4 v[44:47], v27, s[32:35], s48 offen sc0 sc1
    s_add_u32 s48, s48, 57344
    s_waitcnt lgkmcnt(3)
    buffer_store_dwordx4 v[48:51], v27, s[32:35], s48 offen sc0 sc1
    s_add_u32 s48, s48, 57344
    s_waitcnt lgkmcnt(2)
    buffer_store_dwordx4 v[52:55], v27, s[32:35], s48 offen sc0 sc1
    s_add_u32 s48, s48, 57344
    s_waitcnt lgkmcnt(1)
    buffer_store_dwordx4 v[56:59], v27, s[32:35], s48 offen sc0 sc1
    s_add_u32 s48, s48, 57344
    s_waitcnt lgkmcnt(0)
    buffer_store_dwordx4 v[60:63], v27, s[32:35], s48 offen sc0 sc1
gemm1a_kernel_end:
    s_endpgm
.text
.globl gemm2a_kernel
.p2align 8
.type gemm2a_kernel,@function
gemm2a_kernel:
    s_load_dwordx16 s[4:19], s[0:1], 0
    s_load_dwordx8 s[20:27], s[0:1], 64
    s_load_dwordx2 s[28:29], s[0:1], 96
    s_cmp_ge_u32 s2, 256
    s_cbranch_scc1 gemm2a_kernel_end
    v_and_b32 v1, 63, v0
    v_lshrrev_b32 v2, 6, v0
    v_lshrrev_b32 v3, 4, v1
    v_lshrrev_b32 v4, 3, v1
    v_readfirstlane_b32 s42, v2
    v_and_b32 v2, 3, v2
    s_and_b32 s3, s2, 7
    s_lshl_b32 s3, s3, 2
    s_lshr_b32 s40, s2, 3
    s_and_b32 s41, s40, 3
    s_add_u32 s40, s3, s41
    s_lshr_b32 s41, s2, 5
    s_lshl_b32 s47, s41, 18
    s_lshl_b32 s48, s40, 7
    s_add_u32 s47, s47, s48
    s_waitcnt lgkmcnt(0)
    s_mov_b32 s32, s28
    s_mov_b32 s33, s29
    s_mov_b32 s34, 268435456
    s_mov_b32 s35, 0x00020000
    s_cmp_lt_u32 s42, 4
    s_cbranch_scc1 gemm2a_kernel_compute
    s_mov_b32 s36, s22
    s_mov_b32 s37, s23
    s_mov_b32 s38, 1835008
    s_mov_b32 s39, 0x00020000
    s_and_b32 s42, s42, 3
    v_and_b32 v5, 7, v1
    v_lshrrev_b32 v6, 1, v4
    v_and_b32 v6, 1, v6
    v_lshlrev_b32 v6, 2, v6
    v_xor_b32 v5, v5, v6
    v_lshl_add_u32 v6, v2, 5, v4
    v_lshlrev_b32 v6, 10, v6
    v_lshl_add_u32 v6, v5, 4, v6
    v_lshl_add_u32 v7, v2, 2, v3
    v_and_b32 v5, 15, v1
    v_xor_b32 v5, v5, v7
    v_mul_u32_u24 v7, 3584, v7
    v_lshl_add_u32 v7, v5, 4, v7
    s_lshl_b32 s43, s41, 7
    s_mul_i32 s44, s40, 229376
    s_add_u32 s44, s44, 8388608
    s_lshl_b32 s45, s42, 12
    s_lshl_b32 s46, s42, 10
    s_add_u32 s50, s44, 0
    s_add_u32 m0, s46, 16384
    s_nop 0
    buffer_load_dwordx4 v7, s[32:35], s50 offen lds
    s_add_u32 s50, s44, 57344
    s_add_u32 m0, s46, 20480
    s_nop 0
    buffer_load_dwordx4 v7, s[32:35], s50 offen lds
    s_add_u32 s50, s44, 114688
    s_add_u32 m0, s46, 24576
    s_nop 0
    buffer_load_dwordx4 v7, s[32:35], s50 offen lds
    s_add_u32 s50, s44, 172032
    s_add_u32 m0, s46, 28672
    s_nop 0
    buffer_load_dwordx4 v7, s[32:35], s50 offen lds
    s_add_u32 s50, s43, 0
    s_add_u32 m0, s45, 0
    s_nop 0
    buffer_load_dwordx4 v6, s[36:39], s50 offen lds
    s_add_u32 s50, s43, 8192
    s_add_u32 m0, s45, 1024
    s_nop 0
    buffer_load_dwordx4 v6, s[36:39], s50 offen lds
    s_add_u32 s50, s43, 16384
    s_add_u32 m0, s45, 2048
    s_nop 0
    buffer_load_dwordx4 v6, s[36:39], s50 offen lds
    s_add_u32 s50, s43, 24576
    s_add_u32 m0, s45, 3072
    s_nop 0
    buffer_load_dwordx4 v6, s[36:39], s50 offen lds
    s_add_u32 s50, s44, 256
    s_add_u32 m0, s46, 49152
    s_nop 0
    buffer_load_dwordx4 v7, s[32:35], s50 offen lds
    s_add_u32 s50, s44, 57600
    s_add_u32 m0, s46, 53248
    s_nop 0
    buffer_load_dwordx4 v7, s[32:35], s50 offen lds
    s_add_u32 s50, s44, 114944
    s_add_u32 m0, s46, 57344
    s_nop 0
    buffer_load_dwordx4 v7, s[32:35], s50 offen lds
    s_add_u32 s50, s44, 172288
    s_add_u32 m0, s46, 61440
    s_nop 0
    buffer_load_dwordx4 v7, s[32:35], s50 offen lds
    s_add_u32 s50, s43, 131072
    s_add_u32 m0, s45, 32768
    s_nop 0
    buffer_load_dwordx4 v6, s[36:39], s50 offen lds
    s_add_u32 s50, s43, 139264
    s_add_u32 m0, s45, 33792
    s_nop 0
    buffer_load_dwordx4 v6, s[36:39], s50 offen lds
    s_add_u32 s50, s43, 147456
    s_add_u32 m0, s45, 34816
    s_nop 0
    buffer_load_dwordx4 v6, s[36:39], s50 offen lds
    s_add_u32 s50, s43, 155648
    s_add_u32 m0, s45, 35840
    s_nop 0
    buffer_load_dwordx4 v6, s[36:39], s50 offen lds
    s_add_u32 s50, s44, 512
    s_add_u32 m0, s46, 81920
    s_nop 0
    buffer_load_dwordx4 v7, s[32:35], s50 offen lds
    s_add_u32 s50, s44, 57856
    s_add_u32 m0, s46, 86016
    s_nop 0
    buffer_load_dwordx4 v7, s[32:35], s50 offen lds
    s_add_u32 s50, s44, 115200
    s_add_u32 m0, s46, 90112
    s_nop 0
    buffer_load_dwordx4 v7, s[32:35], s50 offen lds
    s_add_u32 s50, s44, 172544
    s_add_u32 m0, s46, 94208
    s_nop 0
    buffer_load_dwordx4 v7, s[32:35], s50 offen lds
    s_add_u32 s50, s43, 262144
    s_add_u32 m0, s45, 65536
    s_nop 0
    buffer_load_dwordx4 v6, s[36:39], s50 offen lds
    s_add_u32 s50, s43, 270336
    s_add_u32 m0, s45, 66560
    s_nop 0
    buffer_load_dwordx4 v6, s[36:39], s50 offen lds
    s_add_u32 s50, s43, 278528
    s_add_u32 m0, s45, 67584
    s_nop 0
    buffer_load_dwordx4 v6, s[36:39], s50 offen lds
    s_add_u32 s50, s43, 286720
    s_add_u32 m0, s45, 68608
    s_nop 0
    buffer_load_dwordx4 v6, s[36:39], s50 offen lds
    v_lshl_add_u32 v8, v2, 4, v4
    v_lshlrev_b32 v8, 12, v8
    v_and_b32 v5, 7, v1
    v_lshl_add_u32 v8, v5, 4, v8
    s_add_u32 s48, s47, 2097152
    s_lshl_b32 s49, s42, 11
    s_add_u32 m0, s49, 131072
    s_nop 0
    buffer_load_dwordx4 v8, s[32:35], s48 offen lds
    s_add_u32 s48, s48, 32768
    s_add_u32 m0, s49, 132096
    s_nop 0
    buffer_load_dwordx4 v8, s[32:35], s48 offen lds
    s_waitcnt vmcnt(18)
    s_barrier
    s_add_u32 s50, s44, 768
    s_add_u32 m0, s46, 114688
    s_nop 0
    buffer_load_dwordx4 v7, s[32:35], s50 offen lds
    s_add_u32 s50, s44, 58112
    s_add_u32 m0, s46, 118784
    s_nop 0
    buffer_load_dwordx4 v7, s[32:35], s50 offen lds
    s_add_u32 s50, s44, 115456
    s_add_u32 m0, s46, 122880
    s_nop 0
    buffer_load_dwordx4 v7, s[32:35], s50 offen lds
    s_add_u32 s50, s44, 172800
    s_add_u32 m0, s46, 126976
    s_nop 0
    buffer_load_dwordx4 v7, s[32:35], s50 offen lds
    s_add_u32 s50, s43, 393216
    s_add_u32 m0, s45, 98304
    s_nop 0
    buffer_load_dwordx4 v6, s[36:39], s50 offen lds
    s_add_u32 s50, s43, 401408
    s_add_u32 m0, s45, 99328
    s_nop 0
    buffer_load_dwordx4 v6, s[36:39], s50 offen lds
    s_add_u32 s50, s43, 409600
    s_add_u32 m0, s45, 100352
    s_nop 0
    buffer_load_dwordx4 v6, s[36:39], s50 offen lds
    s_add_u32 s50, s43, 417792
    s_add_u32 m0, s45, 101376
    s_nop 0
    buffer_load_dwordx4 v6, s[36:39], s50 offen lds
    s_waitcnt vmcnt(18)
    s_barrier
    s_add_u32 s50, s44, 1024
    s_add_u32 m0, s46, 16384
    s_nop 0
    buffer_load_dwordx4 v7, s[32:35], s50 offen lds
    s_add_u32 s50, s44, 58368
    s_add_u32 m0, s46, 20480
    s_nop 0
    buffer_load_dwordx4 v7, s[32:35], s50 offen lds
    s_add_u32 s50, s44, 115712
    s_add_u32 m0, s46, 24576
    s_nop 0
    buffer_load_dwordx4 v7, s[32:35], s50 offen lds
    s_add_u32 s50, s44, 173056
    s_add_u32 m0, s46, 28672
    s_nop 0
    buffer_load_dwordx4 v7, s[32:35], s50 offen lds
    s_add_u32 s50, s43, 524288
    s_add_u32 m0, s45, 0
    s_nop 0
    buffer_load_dwordx4 v6, s[36:39], s50 offen lds
    s_add_u32 s50, s43, 532480
    s_add_u32 m0, s45, 1024
    s_nop 0
    buffer_load_dwordx4 v6, s[36:39], s50 offen lds
    s_add_u32 s50, s43, 540672
    s_add_u32 m0, s45, 2048
    s_nop 0
    buffer_load_dwordx4 v6, s[36:39], s50 offen lds
    s_add_u32 s50, s43, 548864
    s_add_u32 m0, s45, 3072
    s_nop 0
    buffer_load_dwordx4 v6, s[36:39], s50 offen lds
    s_waitcnt vmcnt(18)
    s_barrier
    s_add_u32 s50, s44, 1280
    s_add_u32 m0, s46, 49152
    s_nop 0
    buffer_load_dwordx4 v7, s[32:35], s50 offen lds
    s_add_u32 s50, s44, 58624
    s_add_u32 m0, s46, 53248
    s_nop 0
    buffer_load_dwordx4 v7, s[32:35], s50 offen lds
    s_add_u32 s50, s44, 115968
    s_add_u32 m0, s46, 57344
    s_nop 0
    buffer_load_dwordx4 v7, s[32:35], s50 offen lds
    s_add_u32 s50, s44, 173312
    s_add_u32 m0, s46, 61440
    s_nop 0
    buffer_load_dwordx4 v7, s[32:35], s50 offen lds
    s_add_u32 s50, s43, 655360
    s_add_u32 m0, s45, 32768
    s_nop 0
    buffer_load_dwordx4 v6, s[36:39], s50 offen lds
    s_add_u32 s50, s43, 663552
    s_add_u32 m0, s45, 33792
    s_nop 0
    buffer_load_dwordx4 v6, s[36:39], s50 offen lds
    s_add_u32 s50, s43, 671744
    s_add_u32 m0, s45, 34816
    s_nop 0
    buffer_load_dwordx4 v6, s[36:39], s50 offen lds
    s_add_u32 s50, s43, 679936
    s_add_u32 m0, s45, 35840
    s_nop 0
    buffer_load_dwordx4 v6, s[36:39], s50 offen lds
    s_waitcnt vmcnt(16)
    s_barrier
    s_add_u32 s50, s44, 1536
    s_add_u32 m0, s46, 81920
    s_nop 0
    buffer_load_dwordx4 v7, s[32:35], s50 offen lds
    s_add_u32 s50, s44, 58880
    s_add_u32 m0, s46, 86016
    s_nop 0
    buffer_load_dwordx4 v7, s[32:35], s50 offen lds
    s_add_u32 s50, s44, 116224
    s_add_u32 m0, s46, 90112
    s_nop 0
    buffer_load_dwordx4 v7, s[32:35], s50 offen lds
    s_add_u32 s50, s44, 173568
    s_add_u32 m0, s46, 94208
    s_nop 0
    buffer_load_dwordx4 v7, s[32:35], s50 offen lds
    s_add_u32 s50, s43, 786432
    s_add_u32 m0, s45, 65536
    s_nop 0
    buffer_load_dwordx4 v6, s[36:39], s50 offen lds
    s_add_u32 s50, s43, 794624
    s_add_u32 m0, s45, 66560
    s_nop 0
    buffer_load_dwordx4 v6, s[36:39], s50 offen lds
    s_add_u32 s50, s43, 802816
    s_add_u32 m0, s45, 67584
    s_nop 0
    buffer_load_dwordx4 v6, s[36:39], s50 offen lds
    s_add_u32 s50, s43, 811008
    s_add_u32 m0, s45, 68608
    s_nop 0
    buffer_load_dwordx4 v6, s[36:39], s50 offen lds
    s_waitcnt vmcnt(16)
    s_barrier
    s_add_u32 s50, s44, 1792
    s_add_u32 m0, s46, 114688
    s_nop 0
    buffer_load_dwordx4 v7, s[32:35], s50 offen lds
    s_add_u32 s50, s44, 59136
    s_add_u32 m0, s46, 118784
    s_nop 0
    buffer_load_dwordx4 v7, s[32:35], s50 offen lds
    s_add_u32 s50, s44, 116480
    s_add_u32 m0, s46, 122880
    s_nop 0
    buffer_load_dwordx4 v7, s[32:35], s50 offen lds
    s_add_u32 s50, s44, 173824
    s_add_u32 m0, s46, 126976
    s_nop 0
    buffer_load_dwordx4 v7, s[32:35], s50 offen lds
    s_add_u32 s50, s43, 917504
    s_add_u32 m0, s45, 98304
    s_nop 0
    buffer_load_dwordx4 v6, s[36:39], s50 offen lds
    s_add_u32 s50, s43, 925696
    s_add_u32 m0, s45, 99328
    s_nop 0
    buffer_load_dwordx4 v6, s[36:39], s50 offen lds
    s_add_u32 s50, s43, 933888
    s_add_u32 m0, s45, 100352
    s_nop 0
    buffer_load_dwordx4 v6, s[36:39], s50 offen lds
    s_add_u32 s50, s43, 942080
    s_add_u32 m0, s45, 101376
    s_nop 0
    buffer_load_dwordx4 v6, s[36:39], s50 offen lds
    s_waitcnt vmcnt(16)
    s_barrier
    s_add_u32 s50, s44, 2048
    s_add_u32 m0, s46, 16384
    s_nop 0
    buffer_load_dwordx4 v7, s[32:35], s50 offen lds
    s_add_u32 s50, s44, 59392
    s_add_u32 m0, s46, 20480
    s_nop 0
    buffer_load_dwordx4 v7, s[32:35], s50 offen lds
    s_add_u32 s50, s44, 116736
    s_add_u32 m0, s46, 24576
    s_nop 0
    buffer_load_dwordx4 v7, s[32:35], s50 offen lds
    s_add_u32 s50, s44, 174080
    s_add_u32 m0, s46, 28672
    s_nop 0
    buffer_load_dwordx4 v7, s[32:35], s50 offen lds
    s_add_u32 s50, s43, 1048576
    s_add_u32 m0, s45, 0
    s_nop 0
    buffer_load_dwordx4 v6, s[36:39], s50 offen lds
    s_add_u32 s50, s43, 1056768
    s_add_u32 m0, s45, 1024
    s_nop 0
    buffer_load_dwordx4 v6, s[36:39], s50 offen lds
    s_add_u32 s50, s43, 1064960
    s_add_u32 m0, s45, 2048
    s_nop 0
    buffer_load_dwordx4 v6, s[36:39], s50 offen lds
    s_add_u32 s50, s43, 1073152
    s_add_u32 m0, s45, 3072
    s_nop 0
    buffer_load_dwordx4 v6, s[36:39], s50 offen lds
    s_waitcnt vmcnt(16)
    s_barrier
    s_add_u32 s50, s44, 2304
    s_add_u32 m0, s46, 49152
    s_nop 0
    buffer_load_dwordx4 v7, s[32:35], s50 offen lds
    s_add_u32 s50, s44, 59648
    s_add_u32 m0, s46, 53248
    s_nop 0
    buffer_load_dwordx4 v7, s[32:35], s50 offen lds
    s_add_u32 s50, s44, 116992
    s_add_u32 m0, s46, 57344
    s_nop 0
    buffer_load_dwordx4 v7, s[32:35], s50 offen lds
    s_add_u32 s50, s44, 174336
    s_add_u32 m0, s46, 61440
    s_nop 0
    buffer_load_dwordx4 v7, s[32:35], s50 offen lds
    s_add_u32 s50, s43, 1179648
    s_add_u32 m0, s45, 32768
    s_nop 0
    buffer_load_dwordx4 v6, s[36:39], s50 offen lds
    s_add_u32 s50, s43, 1187840
    s_add_u32 m0, s45, 33792
    s_nop 0
    buffer_load_dwordx4 v6, s[36:39], s50 offen lds
    s_add_u32 s50, s43, 1196032
    s_add_u32 m0, s45, 34816
    s_nop 0
    buffer_load_dwordx4 v6, s[36:39], s50 offen lds
    s_add_u32 s50, s43, 1204224
    s_add_u32 m0, s45, 35840
    s_nop 0
    buffer_load_dwordx4 v6, s[36:39], s50 offen lds
    s_waitcnt vmcnt(16)
    s_barrier
    s_add_u32 s50, s44, 2560
    s_add_u32 m0, s46, 81920
    s_nop 0
    buffer_load_dwordx4 v7, s[32:35], s50 offen lds
    s_add_u32 s50, s44, 59904
    s_add_u32 m0, s46, 86016
    s_nop 0
    buffer_load_dwordx4 v7, s[32:35], s50 offen lds
    s_add_u32 s50, s44, 117248
    s_add_u32 m0, s46, 90112
    s_nop 0
    buffer_load_dwordx4 v7, s[32:35], s50 offen lds
    s_add_u32 s50, s44, 174592
    s_add_u32 m0, s46, 94208
    s_nop 0
    buffer_load_dwordx4 v7, s[32:35], s50 offen lds
    s_add_u32 s50, s43, 1310720
    s_add_u32 m0, s45, 65536
    s_nop 0
    buffer_load_dwordx4 v6, s[36:39], s50 offen lds
    s_add_u32 s50, s43, 1318912
    s_add_u32 m0, s45, 66560
    s_nop 0
    buffer_load_dwordx4 v6, s[36:39], s50 offen lds
    s_add_u32 s50, s43, 1327104
    s_add_u32 m0, s45, 67584
    s_nop 0
    buffer_load_dwordx4 v6, s[36:39], s50 offen lds
    s_add_u32 s50, s43, 1335296
    s_add_u32 m0, s45, 68608
    s_nop 0
    buffer_load_dwordx4 v6, s[36:39], s50 offen lds
    s_waitcnt vmcnt(16)
    s_barrier
    s_add_u32 s50, s44, 2816
    s_add_u32 m0, s46, 114688
    s_nop 0
    buffer_load_dwordx4 v7, s[32:35], s50 offen lds
    s_add_u32 s50, s44, 60160
    s_add_u32 m0, s46, 118784
    s_nop 0
    buffer_load_dwordx4 v7, s[32:35], s50 offen lds
    s_add_u32 s50, s44, 117504
    s_add_u32 m0, s46, 122880
    s_nop 0
    buffer_load_dwordx4 v7, s[32:35], s50 offen lds
    s_add_u32 s50, s44, 174848
    s_add_u32 m0, s46, 126976
    s_nop 0
    buffer_load_dwordx4 v7, s[32:35], s50 offen lds
    s_add_u32 s50, s43, 1441792
    s_add_u32 m0, s45, 98304
    s_nop 0
    buffer_load_dwordx4 v6, s[36:39], s50 offen lds
    s_add_u32 s50, s43, 1449984
    s_add_u32 m0, s45, 99328
    s_nop 0
    buffer_load_dwordx4 v6, s[36:39], s50 offen lds
    s_add_u32 s50, s43, 1458176
    s_add_u32 m0, s45, 100352
    s_nop 0
    buffer_load_dwordx4 v6, s[36:39], s50 offen lds
    s_add_u32 s50, s43, 1466368
    s_add_u32 m0, s45, 101376
    s_nop 0
    buffer_load_dwordx4 v6, s[36:39], s50 offen lds
    s_waitcnt vmcnt(16)
    s_barrier
    s_add_u32 s50, s44, 3072
    s_add_u32 m0, s46, 16384
    s_nop 0
    buffer_load_dwordx4 v7, s[32:35], s50 offen lds
    s_add_u32 s50, s44, 60416
    s_add_u32 m0, s46, 20480
    s_nop 0
    buffer_load_dwordx4 v7, s[32:35], s50 offen lds
    s_add_u32 s50, s44, 117760
    s_add_u32 m0, s46, 24576
    s_nop 0
    buffer_load_dwordx4 v7, s[32:35], s50 offen lds
    s_add_u32 s50, s44, 175104
    s_add_u32 m0, s46, 28672
    s_nop 0
    buffer_load_dwordx4 v7, s[32:35], s50 offen lds
    s_add_u32 s50, s43, 1572864
    s_add_u32 m0, s45, 0
    s_nop 0
    buffer_load_dwordx4 v6, s[36:39], s50 offen lds
    s_add_u32 s50, s43, 1581056
    s_add_u32 m0, s45, 1024
    s_nop 0
    buffer_load_dwordx4 v6, s[36:39], s50 offen lds
    s_add_u32 s50, s43, 1589248
    s_add_u32 m0, s45, 2048
    s_nop 0
    buffer_load_dwordx4 v6, s[36:39], s50 offen lds
    s_add_u32 s50, s43, 1597440
    s_add_u32 m0, s45, 3072
    s_nop 0
    buffer_load_dwordx4 v6, s[36:39], s50 offen lds
    s_waitcnt vmcnt(16)
    s_barrier
    s_add_u32 s50, s44, 3328
    s_add_u32 m0, s46, 49152
    s_nop 0
    buffer_load_dwordx4 v7, s[32:35], s50 offen lds
    s_add_u32 s50, s44, 60672
    s_add_u32 m0, s46, 53248
    s_nop 0
    buffer_load_dwordx4 v7, s[32:35], s50 offen lds
    s_add_u32 s50, s44, 118016
    s_add_u32 m0, s46, 57344
    s_nop 0
    buffer_load_dwordx4 v7, s[32:35], s50 offen lds
    s_add_u32 s50, s44, 175360
    s_add_u32 m0, s46, 61440
    s_nop 0
    buffer_load_dwordx4 v7, s[32:35], s50 offen lds
    s_add_u32 s50, s43, 1703936
    s_add_u32 m0, s45, 32768
    s_nop 0
    buffer_load_dwordx4 v6, s[36:39], s50 offen lds
    s_add_u32 s50, s43, 1712128
    s_add_u32 m0, s45, 33792
    s_nop 0
    buffer_load_dwordx4 v6, s[36:39], s50 offen lds
    s_add_u32 s50, s43, 1720320
    s_add_u32 m0, s45, 34816
    s_nop 0
    buffer_load_dwordx4 v6, s[36:39], s50 offen lds
    s_add_u32 s50, s43, 1728512
    s_add_u32 m0, s45, 35840
    s_nop 0
    buffer_load_dwordx4 v6, s[36:39], s50 offen lds
    s_waitcnt vmcnt(16)
    s_barrier
    s_waitcnt vmcnt(8)
    s_barrier
    s_waitcnt vmcnt(0)
    s_barrier
    s_endpgm
gemm2a_kernel_compute:
    v_and_b32 v9, 1, v2
    v_lshrrev_b32 v10, 1, v2
    v_lshrrev_b32 v11, 5, v1
    v_lshrrev_b32 v12, 2, v1
    v_and_b32 v12, 3, v12
    v_and_b32 v13, 3, v1
    v_lshrrev_b32 v14, 1, v3
    v_lshl_add_u32 v14, v14, 3, v12
    v_lshlrev_b32 v14, 7, v14
    v_lshrrev_b32 v15, 1, v12
    v_xor_b32 v15, v15, v9
    v_lshl_add_u32 v14, v15, 6, v14
    v_and_b32 v15, 1, v3
    v_lshl_add_u32 v14, v15, 5, v14
    v_lshrrev_b32 v15, 1, v13
    v_lshl_add_u32 v14, v15, 4, v14
    v_and_b32 v15, 1, v13
    v_lshl_add_u32 v16, v15, 3, v14
    v_add_u32 v17, 0x10000, v16
    v_and_b32 v18, 31, v1
    v_lshl_add_u32 v14, v10, 5, v18
    v_lshlrev_b32 v14, 8, v14
    v_and_b32 v15, 15, v18
    v_xor_b32 v15, v15, v11
    v_lshl_add_u32 v14, v15, 4, v14
    v_add_u32 v14, 0x4000, v14
    v_xor_b32 v20, 0, v14
    v_add_u32 v28, 0x10000, v20
    v_xor_b32 v21, 32, v14
    v_add_u32 v29, 0x10000, v21
    v_xor_b32 v22, 64, v14
    v_add_u32 v30, 0x10000, v22
    v_xor_b32 v23, 96, v14
    v_add_u32 v31, 0x10000, v23
    v_xor_b32 v24, 128, v14
    v_add_u32 v32, 0x10000, v24
    v_xor_b32 v25, 160, v14
    v_add_u32 v33, 0x10000, v25
    v_xor_b32 v26, 192, v14
    v_add_u32 v34, 0x10000, v26
    v_xor_b32 v27, 224, v14
    v_add_u32 v35, 0x10000, v27
    v_mov_b32 v64, 0
    v_mov_b32 v65, 0
    v_mov_b32 v66, 0
    v_mov_b32 v67, 0
    v_mov_b32 v68, 0
    v_mov_b32 v69, 0
    v_mov_b32 v70, 0
    v_mov_b32 v71, 0
    v_mov_b32 v72, 0
    v_mov_b32 v73, 0
    v_mov_b32 v74, 0
    v_mov_b32 v75, 0
    v_mov_b32 v76, 0
    v_mov_b32 v77, 0
    v_mov_b32 v78, 0
    v_mov_b32 v79, 0
    v_lshl_add_u32 v19, v10, 5, v18
    v_lshlrev_b32 v19, 2, v19
    s_lshl_b32 s51, s40, 8
    s_add_u32 s51, s51, 19988480
    buffer_load_dword v40, v19, s[32:35], s51 offen
    s_barrier
    ds_read_b64_tr_b16 v[96:97], v16 offset:0
    ds_read_b64_tr_b16 v[98:99], v16 offset:512
    ds_read_b128 v[100:103], v20 offset:0
    ds_read_b64_tr_b16 v[104:105], v16 offset:2048
    ds_read_b64_tr_b16 v[106:107], v16 offset:2560
    ds_read_b128 v[108:111], v21 offset:0
    ds_read_b64_tr_b16 v[112:113], v16 offset:4096
    ds_read_b64_tr_b16 v[114:115], v16 offset:4608
    ds_read_b128 v[116:119], v22 offset:0
    s_waitcnt lgkmcnt(6)
    v_mfma_f32_32x32x16_bf16 v[64:79], v[96:99], v[100:103], v[64:79]
    ds_read_b64_tr_b16 v[120:121], v16 offset:6144
    ds_read_b64_tr_b16 v[122:123], v16 offset:6656
    ds_read_b128 v[124:127], v23 offset:0
    s_waitcnt lgkmcnt(6)
    v_mfma_f32_32x32x16_bf16 v[64:79], v[104:107], v[108:111], v[64:79]
    ds_read_b64_tr_b16 v[96:97], v16 offset:8192
    ds_read_b64_tr_b16 v[98:99], v16 offset:8704
    ds_read_b128 v[100:103], v24 offset:0
    s_waitcnt lgkmcnt(6)
    v_mfma_f32_32x32x16_bf16 v[64:79], v[112:115], v[116:119], v[64:79]
    ds_read_b64_tr_b16 v[104:105], v16 offset:10240
    ds_read_b64_tr_b16 v[106:107], v16 offset:10752
    ds_read_b128 v[108:111], v25 offset:0
    s_waitcnt lgkmcnt(6)
    v_mfma_f32_32x32x16_bf16 v[64:79], v[120:123], v[124:127], v[64:79]
    ds_read_b64_tr_b16 v[112:113], v16 offset:12288
    ds_read_b64_tr_b16 v[114:115], v16 offset:12800
    ds_read_b128 v[116:119], v26 offset:0
    s_waitcnt lgkmcnt(6)
    v_mfma_f32_32x32x16_bf16 v[64:79], v[96:99], v[100:103], v[64:79]
    ds_read_b64_tr_b16 v[120:121], v16 offset:14336
    ds_read_b64_tr_b16 v[122:123], v16 offset:14848
    ds_read_b128 v[124:127], v27 offset:0
    s_waitcnt lgkmcnt(6)
    v_mfma_f32_32x32x16_bf16 v[64:79], v[104:107], v[108:111], v[64:79]
    s_waitcnt lgkmcnt(3)
    v_mfma_f32_32x32x16_bf16 v[64:79], v[112:115], v[116:119], v[64:79]
    s_waitcnt lgkmcnt(0)
    v_mfma_f32_32x32x16_bf16 v[64:79], v[120:123], v[124:127], v[64:79]
    s_barrier
    ds_read_b64_tr_b16 v[96:97], v16 offset:32768
    ds_read_b64_tr_b16 v[98:99], v16 offset:33280
    ds_read_b128 v[100:103], v20 offset:32768
    ds_read_b64_tr_b16 v[104:105], v16 offset:34816
    ds_read_b64_tr_b16 v[106:107], v16 offset:35328
    ds_read_b128 v[108:111], v21 offset:32768
    ds_read_b64_tr_b16 v[112:113], v16 offset:36864
    ds_read_b64_tr_b16 v[114:115], v16 offset:37376
    ds_read_b128 v[116:119], v22 offset:32768
    s_waitcnt lgkmcnt(6)
    v_mfma_f32_32x32x16_bf16 v[64:79], v[96:99], v[100:103], v[64:79]
    ds_read_b64_tr_b16 v[120:121], v16 offset:38912
    ds_read_b64_tr_b16 v[122:123], v16 offset:39424
    ds_read_b128 v[124:127], v23 offset:32768
    s_waitcnt lgkmcnt(6)
    v_mfma_f32_32x32x16_bf16 v[64:79], v[104:107], v[108:111], v[64:79]
    ds_read_b64_tr_b16 v[96:97], v16 offset:40960
    ds_read_b64_tr_b16 v[98:99], v16 offset:41472
    ds_read_b128 v[100:103], v24 offset:32768
    s_waitcnt lgkmcnt(6)
    v_mfma_f32_32x32x16_bf16 v[64:79], v[112:115], v[116:119], v[64:79]
    ds_read_b64_tr_b16 v[104:105], v16 offset:43008
    ds_read_b64_tr_b16 v[106:107], v16 offset:43520
    ds_read_b128 v[108:111], v25 offset:32768
    s_waitcnt lgkmcnt(6)
    v_mfma_f32_32x32x16_bf16 v[64:79], v[120:123], v[124:127], v[64:79]
    ds_read_b64_tr_b16 v[112:113], v16 offset:45056
    ds_read_b64_tr_b16 v[114:115], v16 offset:45568
    ds_read_b128 v[116:119], v26 offset:32768
    s_waitcnt lgkmcnt(6)
    v_mfma_f32_32x32x16_bf16 v[64:79], v[96:99], v[100:103], v[64:79]
    ds_read_b64_tr_b16 v[120:121], v16 offset:47104
    ds_read_b64_tr_b16 v[122:123], v16 offset:47616
    ds_read_b128 v[124:127], v27 offset:32768
    s_waitcnt lgkmcnt(6)
    v_mfma_f32_32x32x16_bf16 v[64:79], v[104:107], v[108:111], v[64:79]
    s_waitcnt lgkmcnt(3)
    v_mfma_f32_32x32x16_bf16 v[64:79], v[112:115], v[116:119], v[64:79]
    s_waitcnt lgkmcnt(0)
    v_mfma_f32_32x32x16_bf16 v[64:79], v[120:123], v[124:127], v[64:79]
    s_barrier
    ds_read_b64_tr_b16 v[96:97], v17 offset:0
    ds_read_b64_tr_b16 v[98:99], v17 offset:512
    ds_read_b128 v[100:103], v28 offset:0
    ds_read_b64_tr_b16 v[104:105], v17 offset:2048
    ds_read_b64_tr_b16 v[106:107], v17 offset:2560
    ds_read_b128 v[108:111], v29 offset:0
    ds_read_b64_tr_b16 v[112:113], v17 offset:4096
    ds_read_b64_tr_b16 v[114:115], v17 offset:4608
    ds_read_b128 v[116:119], v30 offset:0
    s_waitcnt lgkmcnt(6)
    v_mfma_f32_32x32x16_bf16 v[64:79], v[96:99], v[100:103], v[64:79]
    ds_read_b64_tr_b16 v[120:121], v17 offset:6144
    ds_read_b64_tr_b16 v[122:123], v17 offset:6656
    ds_read_b128 v[124:127], v31 offset:0
    s_waitcnt lgkmcnt(6)
    v_mfma_f32_32x32x16_bf16 v[64:79], v[104:107], v[108:111], v[64:79]
    ds_read_b64_tr_b16 v[96:97], v17 offset:8192
    ds_read_b64_tr_b16 v[98:99], v17 offset:8704
    ds_read_b128 v[100:103], v32 offset:0
    s_waitcnt lgkmcnt(6)
    v_mfma_f32_32x32x16_bf16 v[64:79], v[112:115], v[116:119], v[64:79]
    ds_read_b64_tr_b16 v[104:105], v17 offset:10240
    ds_read_b64_tr_b16 v[106:107], v17 offset:10752
    ds_read_b128 v[108:111], v33 offset:0
    s_waitcnt lgkmcnt(6)
    v_mfma_f32_32x32x16_bf16 v[64:79], v[120:123], v[124:127], v[64:79]
    ds_read_b64_tr_b16 v[112:113], v17 offset:12288
    ds_read_b64_tr_b16 v[114:115], v17 offset:12800
    ds_read_b128 v[116:119], v34 offset:0
    s_waitcnt lgkmcnt(6)
    v_mfma_f32_32x32x16_bf16 v[64:79], v[96:99], v[100:103], v[64:79]
    ds_read_b64_tr_b16 v[120:121], v17 offset:14336
    ds_read_b64_tr_b16 v[122:123], v17 offset:14848
    ds_read_b128 v[124:127], v35 offset:0
    s_waitcnt lgkmcnt(6)
    v_mfma_f32_32x32x16_bf16 v[64:79], v[104:107], v[108:111], v[64:79]
    s_waitcnt lgkmcnt(3)
    v_mfma_f32_32x32x16_bf16 v[64:79], v[112:115], v[116:119], v[64:79]
    s_waitcnt lgkmcnt(0)
    v_mfma_f32_32x32x16_bf16 v[64:79], v[120:123], v[124:127], v[64:79]
    s_barrier
    ds_read_b64_tr_b16 v[96:97], v17 offset:32768
    ds_read_b64_tr_b16 v[98:99], v17 offset:33280
    ds_read_b128 v[100:103], v28 offset:32768
    ds_read_b64_tr_b16 v[104:105], v17 offset:34816
    ds_read_b64_tr_b16 v[106:107], v17 offset:35328
    ds_read_b128 v[108:111], v29 offset:32768
    ds_read_b64_tr_b16 v[112:113], v17 offset:36864
    ds_read_b64_tr_b16 v[114:115], v17 offset:37376
    ds_read_b128 v[116:119], v30 offset:32768
    s_waitcnt lgkmcnt(6)
    v_mfma_f32_32x32x16_bf16 v[64:79], v[96:99], v[100:103], v[64:79]
    ds_read_b64_tr_b16 v[120:121], v17 offset:38912
    ds_read_b64_tr_b16 v[122:123], v17 offset:39424
    ds_read_b128 v[124:127], v31 offset:32768
    s_waitcnt lgkmcnt(6)
    v_mfma_f32_32x32x16_bf16 v[64:79], v[104:107], v[108:111], v[64:79]
    ds_read_b64_tr_b16 v[96:97], v17 offset:40960
    ds_read_b64_tr_b16 v[98:99], v17 offset:41472
    ds_read_b128 v[100:103], v32 offset:32768
    s_waitcnt lgkmcnt(6)
    v_mfma_f32_32x32x16_bf16 v[64:79], v[112:115], v[116:119], v[64:79]
    ds_read_b64_tr_b16 v[104:105], v17 offset:43008
    ds_read_b64_tr_b16 v[106:107], v17 offset:43520
    ds_read_b128 v[108:111], v33 offset:32768
    s_waitcnt lgkmcnt(6)
    v_mfma_f32_32x32x16_bf16 v[64:79], v[120:123], v[124:127], v[64:79]
    ds_read_b64_tr_b16 v[112:113], v17 offset:45056
    ds_read_b64_tr_b16 v[114:115], v17 offset:45568
    ds_read_b128 v[116:119], v34 offset:32768
    s_waitcnt lgkmcnt(6)
    v_mfma_f32_32x32x16_bf16 v[64:79], v[96:99], v[100:103], v[64:79]
    ds_read_b64_tr_b16 v[120:121], v17 offset:47104
    ds_read_b64_tr_b16 v[122:123], v17 offset:47616
    ds_read_b128 v[124:127], v35 offset:32768
    s_waitcnt lgkmcnt(6)
    v_mfma_f32_32x32x16_bf16 v[64:79], v[104:107], v[108:111], v[64:79]
    s_waitcnt lgkmcnt(3)
    v_mfma_f32_32x32x16_bf16 v[64:79], v[112:115], v[116:119], v[64:79]
    s_waitcnt lgkmcnt(0)
    v_mfma_f32_32x32x16_bf16 v[64:79], v[120:123], v[124:127], v[64:79]
    s_barrier
    ds_read_b64_tr_b16 v[96:97], v16 offset:0
    ds_read_b64_tr_b16 v[98:99], v16 offset:512
    ds_read_b128 v[100:103], v20 offset:0
    ds_read_b64_tr_b16 v[104:105], v16 offset:2048
    ds_read_b64_tr_b16 v[106:107], v16 offset:2560
    ds_read_b128 v[108:111], v21 offset:0
    ds_read_b64_tr_b16 v[112:113], v16 offset:4096
    ds_read_b64_tr_b16 v[114:115], v16 offset:4608
    ds_read_b128 v[116:119], v22 offset:0
    s_waitcnt lgkmcnt(6)
    v_mfma_f32_32x32x16_bf16 v[64:79], v[96:99], v[100:103], v[64:79]
    ds_read_b64_tr_b16 v[120:121], v16 offset:6144
    ds_read_b64_tr_b16 v[122:123], v16 offset:6656
    ds_read_b128 v[124:127], v23 offset:0
    s_waitcnt lgkmcnt(6)
    v_mfma_f32_32x32x16_bf16 v[64:79], v[104:107], v[108:111], v[64:79]
    ds_read_b64_tr_b16 v[96:97], v16 offset:8192
    ds_read_b64_tr_b16 v[98:99], v16 offset:8704
    ds_read_b128 v[100:103], v24 offset:0
    s_waitcnt lgkmcnt(6)
    v_mfma_f32_32x32x16_bf16 v[64:79], v[112:115], v[116:119], v[64:79]
    ds_read_b64_tr_b16 v[104:105], v16 offset:10240
    ds_read_b64_tr_b16 v[106:107], v16 offset:10752
    ds_read_b128 v[108:111], v25 offset:0
    s_waitcnt lgkmcnt(6)
    v_mfma_f32_32x32x16_bf16 v[64:79], v[120:123], v[124:127], v[64:79]
    ds_read_b64_tr_b16 v[112:113], v16 offset:12288
    ds_read_b64_tr_b16 v[114:115], v16 offset:12800
    ds_read_b128 v[116:119], v26 offset:0
    s_waitcnt lgkmcnt(6)
    v_mfma_f32_32x32x16_bf16 v[64:79], v[96:99], v[100:103], v[64:79]
    ds_read_b64_tr_b16 v[120:121], v16 offset:14336
    ds_read_b64_tr_b16 v[122:123], v16 offset:14848
    ds_read_b128 v[124:127], v27 offset:0
    s_waitcnt lgkmcnt(6)
    v_mfma_f32_32x32x16_bf16 v[64:79], v[104:107], v[108:111], v[64:79]
    s_waitcnt lgkmcnt(3)
    v_mfma_f32_32x32x16_bf16 v[64:79], v[112:115], v[116:119], v[64:79]
    s_waitcnt lgkmcnt(0)
    v_mfma_f32_32x32x16_bf16 v[64:79], v[120:123], v[124:127], v[64:79]
    s_barrier
    ds_read_b64_tr_b16 v[96:97], v16 offset:32768
    ds_read_b64_tr_b16 v[98:99], v16 offset:33280
    ds_read_b128 v[100:103], v20 offset:32768
    ds_read_b64_tr_b16 v[104:105], v16 offset:34816
    ds_read_b64_tr_b16 v[106:107], v16 offset:35328
    ds_read_b128 v[108:111], v21 offset:32768
    ds_read_b64_tr_b16 v[112:113], v16 offset:36864
    ds_read_b64_tr_b16 v[114:115], v16 offset:37376
    ds_read_b128 v[116:119], v22 offset:32768
    s_waitcnt lgkmcnt(6)
    v_mfma_f32_32x32x16_bf16 v[64:79], v[96:99], v[100:103], v[64:79]
    ds_read_b64_tr_b16 v[120:121], v16 offset:38912
    ds_read_b64_tr_b16 v[122:123], v16 offset:39424
    ds_read_b128 v[124:127], v23 offset:32768
    s_waitcnt lgkmcnt(6)
    v_mfma_f32_32x32x16_bf16 v[64:79], v[104:107], v[108:111], v[64:79]
    ds_read_b64_tr_b16 v[96:97], v16 offset:40960
    ds_read_b64_tr_b16 v[98:99], v16 offset:41472
    ds_read_b128 v[100:103], v24 offset:32768
    s_waitcnt lgkmcnt(6)
    v_mfma_f32_32x32x16_bf16 v[64:79], v[112:115], v[116:119], v[64:79]
    ds_read_b64_tr_b16 v[104:105], v16 offset:43008
    ds_read_b64_tr_b16 v[106:107], v16 offset:43520
    ds_read_b128 v[108:111], v25 offset:32768
    s_waitcnt lgkmcnt(6)
    v_mfma_f32_32x32x16_bf16 v[64:79], v[120:123], v[124:127], v[64:79]
    ds_read_b64_tr_b16 v[112:113], v16 offset:45056
    ds_read_b64_tr_b16 v[114:115], v16 offset:45568
    ds_read_b128 v[116:119], v26 offset:32768
    s_waitcnt lgkmcnt(6)
    v_mfma_f32_32x32x16_bf16 v[64:79], v[96:99], v[100:103], v[64:79]
    ds_read_b64_tr_b16 v[120:121], v16 offset:47104
    ds_read_b64_tr_b16 v[122:123], v16 offset:47616
    ds_read_b128 v[124:127], v27 offset:32768
    s_waitcnt lgkmcnt(6)
    v_mfma_f32_32x32x16_bf16 v[64:79], v[104:107], v[108:111], v[64:79]
    s_waitcnt lgkmcnt(3)
    v_mfma_f32_32x32x16_bf16 v[64:79], v[112:115], v[116:119], v[64:79]
    s_waitcnt lgkmcnt(0)
    v_mfma_f32_32x32x16_bf16 v[64:79], v[120:123], v[124:127], v[64:79]
    s_barrier
    ds_read_b64_tr_b16 v[96:97], v17 offset:0
    ds_read_b64_tr_b16 v[98:99], v17 offset:512
    ds_read_b128 v[100:103], v28 offset:0
    ds_read_b64_tr_b16 v[104:105], v17 offset:2048
    ds_read_b64_tr_b16 v[106:107], v17 offset:2560
    ds_read_b128 v[108:111], v29 offset:0
    ds_read_b64_tr_b16 v[112:113], v17 offset:4096
    ds_read_b64_tr_b16 v[114:115], v17 offset:4608
    ds_read_b128 v[116:119], v30 offset:0
    s_waitcnt lgkmcnt(6)
    v_mfma_f32_32x32x16_bf16 v[64:79], v[96:99], v[100:103], v[64:79]
    ds_read_b64_tr_b16 v[120:121], v17 offset:6144
    ds_read_b64_tr_b16 v[122:123], v17 offset:6656
    ds_read_b128 v[124:127], v31 offset:0
    s_waitcnt lgkmcnt(6)
    v_mfma_f32_32x32x16_bf16 v[64:79], v[104:107], v[108:111], v[64:79]
    ds_read_b64_tr_b16 v[96:97], v17 offset:8192
    ds_read_b64_tr_b16 v[98:99], v17 offset:8704
    ds_read_b128 v[100:103], v32 offset:0
    s_waitcnt lgkmcnt(6)
    v_mfma_f32_32x32x16_bf16 v[64:79], v[112:115], v[116:119], v[64:79]
    ds_read_b64_tr_b16 v[104:105], v17 offset:10240
    ds_read_b64_tr_b16 v[106:107], v17 offset:10752
    ds_read_b128 v[108:111], v33 offset:0
    s_waitcnt lgkmcnt(6)
    v_mfma_f32_32x32x16_bf16 v[64:79], v[120:123], v[124:127], v[64:79]
    ds_read_b64_tr_b16 v[112:113], v17 offset:12288
    ds_read_b64_tr_b16 v[114:115], v17 offset:12800
    ds_read_b128 v[116:119], v34 offset:0
    s_waitcnt lgkmcnt(6)
    v_mfma_f32_32x32x16_bf16 v[64:79], v[96:99], v[100:103], v[64:79]
    ds_read_b64_tr_b16 v[120:121], v17 offset:14336
    ds_read_b64_tr_b16 v[122:123], v17 offset:14848
    ds_read_b128 v[124:127], v35 offset:0
    s_waitcnt lgkmcnt(6)
    v_mfma_f32_32x32x16_bf16 v[64:79], v[104:107], v[108:111], v[64:79]
    s_waitcnt lgkmcnt(3)
    v_mfma_f32_32x32x16_bf16 v[64:79], v[112:115], v[116:119], v[64:79]
    s_waitcnt lgkmcnt(0)
    v_mfma_f32_32x32x16_bf16 v[64:79], v[120:123], v[124:127], v[64:79]
    s_barrier
    ds_read_b64_tr_b16 v[96:97], v17 offset:32768
    ds_read_b64_tr_b16 v[98:99], v17 offset:33280
    ds_read_b128 v[100:103], v28 offset:32768
    ds_read_b64_tr_b16 v[104:105], v17 offset:34816
    ds_read_b64_tr_b16 v[106:107], v17 offset:35328
    ds_read_b128 v[108:111], v29 offset:32768
    ds_read_b64_tr_b16 v[112:113], v17 offset:36864
    ds_read_b64_tr_b16 v[114:115], v17 offset:37376
    ds_read_b128 v[116:119], v30 offset:32768
    s_waitcnt lgkmcnt(6)
    v_mfma_f32_32x32x16_bf16 v[64:79], v[96:99], v[100:103], v[64:79]
    ds_read_b64_tr_b16 v[120:121], v17 offset:38912
    ds_read_b64_tr_b16 v[122:123], v17 offset:39424
    ds_read_b128 v[124:127], v31 offset:32768
    s_waitcnt lgkmcnt(6)
    v_mfma_f32_32x32x16_bf16 v[64:79], v[104:107], v[108:111], v[64:79]
    ds_read_b64_tr_b16 v[96:97], v17 offset:40960
    ds_read_b64_tr_b16 v[98:99], v17 offset:41472
    ds_read_b128 v[100:103], v32 offset:32768
    s_waitcnt lgkmcnt(6)
    v_mfma_f32_32x32x16_bf16 v[64:79], v[112:115], v[116:119], v[64:79]
    ds_read_b64_tr_b16 v[104:105], v17 offset:43008
    ds_read_b64_tr_b16 v[106:107], v17 offset:43520
    ds_read_b128 v[108:111], v33 offset:32768
    s_waitcnt lgkmcnt(6)
    v_mfma_f32_32x32x16_bf16 v[64:79], v[120:123], v[124:127], v[64:79]
    ds_read_b64_tr_b16 v[112:113], v17 offset:45056
    ds_read_b64_tr_b16 v[114:115], v17 offset:45568
    ds_read_b128 v[116:119], v34 offset:32768
    s_waitcnt lgkmcnt(6)
    v_mfma_f32_32x32x16_bf16 v[64:79], v[96:99], v[100:103], v[64:79]
    ds_read_b64_tr_b16 v[120:121], v17 offset:47104
    ds_read_b64_tr_b16 v[122:123], v17 offset:47616
    ds_read_b128 v[124:127], v35 offset:32768
    s_waitcnt lgkmcnt(6)
    v_mfma_f32_32x32x16_bf16 v[64:79], v[104:107], v[108:111], v[64:79]
    s_waitcnt lgkmcnt(3)
    v_mfma_f32_32x32x16_bf16 v[64:79], v[112:115], v[116:119], v[64:79]
    s_waitcnt lgkmcnt(0)
    v_mfma_f32_32x32x16_bf16 v[64:79], v[120:123], v[124:127], v[64:79]
    s_barrier
    ds_read_b64_tr_b16 v[96:97], v16 offset:0
    ds_read_b64_tr_b16 v[98:99], v16 offset:512
    ds_read_b128 v[100:103], v20 offset:0
    ds_read_b64_tr_b16 v[104:105], v16 offset:2048
    ds_read_b64_tr_b16 v[106:107], v16 offset:2560
    ds_read_b128 v[108:111], v21 offset:0
    ds_read_b64_tr_b16 v[112:113], v16 offset:4096
    ds_read_b64_tr_b16 v[114:115], v16 offset:4608
    ds_read_b128 v[116:119], v22 offset:0
    s_waitcnt lgkmcnt(6)
    v_mfma_f32_32x32x16_bf16 v[64:79], v[96:99], v[100:103], v[64:79]
    ds_read_b64_tr_b16 v[120:121], v16 offset:6144
    ds_read_b64_tr_b16 v[122:123], v16 offset:6656
    ds_read_b128 v[124:127], v23 offset:0
    s_waitcnt lgkmcnt(6)
    v_mfma_f32_32x32x16_bf16 v[64:79], v[104:107], v[108:111], v[64:79]
    ds_read_b64_tr_b16 v[96:97], v16 offset:8192
    ds_read_b64_tr_b16 v[98:99], v16 offset:8704
    ds_read_b128 v[100:103], v24 offset:0
    s_waitcnt lgkmcnt(6)
    v_mfma_f32_32x32x16_bf16 v[64:79], v[112:115], v[116:119], v[64:79]
    ds_read_b64_tr_b16 v[104:105], v16 offset:10240
    ds_read_b64_tr_b16 v[106:107], v16 offset:10752
    ds_read_b128 v[108:111], v25 offset:0
    s_waitcnt lgkmcnt(6)
    v_mfma_f32_32x32x16_bf16 v[64:79], v[120:123], v[124:127], v[64:79]
    ds_read_b64_tr_b16 v[112:113], v16 offset:12288
    ds_read_b64_tr_b16 v[114:115], v16 offset:12800
    ds_read_b128 v[116:119], v26 offset:0
    s_waitcnt lgkmcnt(6)
    v_mfma_f32_32x32x16_bf16 v[64:79], v[96:99], v[100:103], v[64:79]
    ds_read_b64_tr_b16 v[120:121], v16 offset:14336
    ds_read_b64_tr_b16 v[122:123], v16 offset:14848
    ds_read_b128 v[124:127], v27 offset:0
    s_waitcnt lgkmcnt(6)
    v_mfma_f32_32x32x16_bf16 v[64:79], v[104:107], v[108:111], v[64:79]
    s_waitcnt lgkmcnt(3)
    v_mfma_f32_32x32x16_bf16 v[64:79], v[112:115], v[116:119], v[64:79]
    s_waitcnt lgkmcnt(0)
    v_mfma_f32_32x32x16_bf16 v[64:79], v[120:123], v[124:127], v[64:79]
    s_barrier
    ds_read_b64_tr_b16 v[96:97], v16 offset:32768
    ds_read_b64_tr_b16 v[98:99], v16 offset:33280
    ds_read_b128 v[100:103], v20 offset:32768
    ds_read_b64_tr_b16 v[104:105], v16 offset:34816
    ds_read_b64_tr_b16 v[106:107], v16 offset:35328
    ds_read_b128 v[108:111], v21 offset:32768
    ds_read_b64_tr_b16 v[112:113], v16 offset:36864
    ds_read_b64_tr_b16 v[114:115], v16 offset:37376
    ds_read_b128 v[116:119], v22 offset:32768
    s_waitcnt lgkmcnt(6)
    v_mfma_f32_32x32x16_bf16 v[64:79], v[96:99], v[100:103], v[64:79]
    ds_read_b64_tr_b16 v[120:121], v16 offset:38912
    ds_read_b64_tr_b16 v[122:123], v16 offset:39424
    ds_read_b128 v[124:127], v23 offset:32768
    s_waitcnt lgkmcnt(6)
    v_mfma_f32_32x32x16_bf16 v[64:79], v[104:107], v[108:111], v[64:79]
    ds_read_b64_tr_b16 v[96:97], v16 offset:40960
    ds_read_b64_tr_b16 v[98:99], v16 offset:41472
    ds_read_b128 v[100:103], v24 offset:32768
    s_waitcnt lgkmcnt(6)
    v_mfma_f32_32x32x16_bf16 v[64:79], v[112:115], v[116:119], v[64:79]
    ds_read_b64_tr_b16 v[104:105], v16 offset:43008
    ds_read_b64_tr_b16 v[106:107], v16 offset:43520
    ds_read_b128 v[108:111], v25 offset:32768
    s_waitcnt lgkmcnt(6)
    v_mfma_f32_32x32x16_bf16 v[64:79], v[120:123], v[124:127], v[64:79]
    ds_read_b64_tr_b16 v[112:113], v16 offset:45056
    ds_read_b64_tr_b16 v[114:115], v16 offset:45568
    ds_read_b128 v[116:119], v26 offset:32768
    s_waitcnt lgkmcnt(6)
    v_mfma_f32_32x32x16_bf16 v[64:79], v[96:99], v[100:103], v[64:79]
    ds_read_b64_tr_b16 v[120:121], v16 offset:47104
    ds_read_b64_tr_b16 v[122:123], v16 offset:47616
    ds_read_b128 v[124:127], v27 offset:32768
    s_waitcnt lgkmcnt(6)
    v_mfma_f32_32x32x16_bf16 v[64:79], v[104:107], v[108:111], v[64:79]
    s_waitcnt lgkmcnt(3)
    v_mfma_f32_32x32x16_bf16 v[64:79], v[112:115], v[116:119], v[64:79]
    s_waitcnt lgkmcnt(0)
    v_mfma_f32_32x32x16_bf16 v[64:79], v[120:123], v[124:127], v[64:79]
    s_barrier
    ds_read_b64_tr_b16 v[96:97], v17 offset:0
    ds_read_b64_tr_b16 v[98:99], v17 offset:512
    ds_read_b128 v[100:103], v28 offset:0
    ds_read_b64_tr_b16 v[104:105], v17 offset:2048
    ds_read_b64_tr_b16 v[106:107], v17 offset:2560
    ds_read_b128 v[108:111], v29 offset:0
    ds_read_b64_tr_b16 v[112:113], v17 offset:4096
    ds_read_b64_tr_b16 v[114:115], v17 offset:4608
    ds_read_b128 v[116:119], v30 offset:0
    s_waitcnt lgkmcnt(6)
    v_mfma_f32_32x32x16_bf16 v[64:79], v[96:99], v[100:103], v[64:79]
    ds_read_b64_tr_b16 v[120:121], v17 offset:6144
    ds_read_b64_tr_b16 v[122:123], v17 offset:6656
    ds_read_b128 v[124:127], v31 offset:0
    s_waitcnt lgkmcnt(6)
    v_mfma_f32_32x32x16_bf16 v[64:79], v[104:107], v[108:111], v[64:79]
    ds_read_b64_tr_b16 v[96:97], v17 offset:8192
    ds_read_b64_tr_b16 v[98:99], v17 offset:8704
    ds_read_b128 v[100:103], v32 offset:0
    s_waitcnt lgkmcnt(6)
    v_mfma_f32_32x32x16_bf16 v[64:79], v[112:115], v[116:119], v[64:79]
    ds_read_b64_tr_b16 v[104:105], v17 offset:10240
    ds_read_b64_tr_b16 v[106:107], v17 offset:10752
    ds_read_b128 v[108:111], v33 offset:0
    s_waitcnt lgkmcnt(6)
    v_mfma_f32_32x32x16_bf16 v[64:79], v[120:123], v[124:127], v[64:79]
    ds_read_b64_tr_b16 v[112:113], v17 offset:12288
    ds_read_b64_tr_b16 v[114:115], v17 offset:12800
    ds_read_b128 v[116:119], v34 offset:0
    s_waitcnt lgkmcnt(6)
    v_mfma_f32_32x32x16_bf16 v[64:79], v[96:99], v[100:103], v[64:79]
    ds_read_b64_tr_b16 v[120:121], v17 offset:14336
    ds_read_b64_tr_b16 v[122:123], v17 offset:14848
    ds_read_b128 v[124:127], v35 offset:0
    s_waitcnt lgkmcnt(6)
    v_mfma_f32_32x32x16_bf16 v[64:79], v[104:107], v[108:111], v[64:79]
    s_waitcnt lgkmcnt(3)
    v_mfma_f32_32x32x16_bf16 v[64:79], v[112:115], v[116:119], v[64:79]
    s_waitcnt lgkmcnt(0)
    v_mfma_f32_32x32x16_bf16 v[64:79], v[120:123], v[124:127], v[64:79]
    s_barrier
    ds_read_b64_tr_b16 v[96:97], v17 offset:32768
    ds_read_b64_tr_b16 v[98:99], v17 offset:33280
    ds_read_b128 v[100:103], v28 offset:32768
    ds_read_b64_tr_b16 v[104:105], v17 offset:34816
    ds_read_b64_tr_b16 v[106:107], v17 offset:35328
    ds_read_b128 v[108:111], v29 offset:32768
    ds_read_b64_tr_b16 v[112:113], v17 offset:36864
    ds_read_b64_tr_b16 v[114:115], v17 offset:37376
    ds_read_b128 v[116:119], v30 offset:32768
    s_waitcnt lgkmcnt(6)
    v_mfma_f32_32x32x16_bf16 v[64:79], v[96:99], v[100:103], v[64:79]
    ds_read_b64_tr_b16 v[120:121], v17 offset:38912
    ds_read_b64_tr_b16 v[122:123], v17 offset:39424
    ds_read_b128 v[124:127], v31 offset:32768
    s_waitcnt lgkmcnt(6)
    v_mfma_f32_32x32x16_bf16 v[64:79], v[104:107], v[108:111], v[64:79]
    ds_read_b64_tr_b16 v[96:97], v17 offset:40960
    ds_read_b64_tr_b16 v[98:99], v17 offset:41472
    ds_read_b128 v[100:103], v32 offset:32768
    s_waitcnt lgkmcnt(6)
    v_mfma_f32_32x32x16_bf16 v[64:79], v[112:115], v[116:119], v[64:79]
    ds_read_b64_tr_b16 v[104:105], v17 offset:43008
    ds_read_b64_tr_b16 v[106:107], v17 offset:43520
    ds_read_b128 v[108:111], v33 offset:32768
    s_waitcnt lgkmcnt(6)
    v_mfma_f32_32x32x16_bf16 v[64:79], v[120:123], v[124:127], v[64:79]
    ds_read_b64_tr_b16 v[112:113], v17 offset:45056
    ds_read_b64_tr_b16 v[114:115], v17 offset:45568
    ds_read_b128 v[116:119], v34 offset:32768
    s_waitcnt lgkmcnt(6)
    v_mfma_f32_32x32x16_bf16 v[64:79], v[96:99], v[100:103], v[64:79]
    ds_read_b64_tr_b16 v[120:121], v17 offset:47104
    ds_read_b64_tr_b16 v[122:123], v17 offset:47616
    ds_read_b128 v[124:127], v35 offset:32768
    s_waitcnt lgkmcnt(6)
    v_mfma_f32_32x32x16_bf16 v[64:79], v[104:107], v[108:111], v[64:79]
    s_waitcnt lgkmcnt(3)
    v_mfma_f32_32x32x16_bf16 v[64:79], v[112:115], v[116:119], v[64:79]
    s_waitcnt lgkmcnt(0)
    v_mfma_f32_32x32x16_bf16 v[64:79], v[120:123], v[124:127], v[64:79]
    s_barrier
    ds_read_b64_tr_b16 v[96:97], v16 offset:0
    ds_read_b64_tr_b16 v[98:99], v16 offset:512
    ds_read_b128 v[100:103], v20 offset:0
    ds_read_b64_tr_b16 v[104:105], v16 offset:2048
    ds_read_b64_tr_b16 v[106:107], v16 offset:2560
    ds_read_b128 v[108:111], v21 offset:0
    ds_read_b64_tr_b16 v[112:113], v16 offset:4096
    ds_read_b64_tr_b16 v[114:115], v16 offset:4608
    ds_read_b128 v[116:119], v22 offset:0
    s_waitcnt lgkmcnt(6)
    v_mfma_f32_32x32x16_bf16 v[64:79], v[96:99], v[100:103], v[64:79]
    ds_read_b64_tr_b16 v[120:121], v16 offset:6144
    ds_read_b64_tr_b16 v[122:123], v16 offset:6656
    ds_read_b128 v[124:127], v23 offset:0
    s_waitcnt lgkmcnt(6)
    v_mfma_f32_32x32x16_bf16 v[64:79], v[104:107], v[108:111], v[64:79]
    ds_read_b64_tr_b16 v[96:97], v16 offset:8192
    ds_read_b64_tr_b16 v[98:99], v16 offset:8704
    ds_read_b128 v[100:103], v24 offset:0
    s_waitcnt lgkmcnt(6)
    v_mfma_f32_32x32x16_bf16 v[64:79], v[112:115], v[116:119], v[64:79]
    ds_read_b64_tr_b16 v[104:105], v16 offset:10240
    ds_read_b64_tr_b16 v[106:107], v16 offset:10752
    ds_read_b128 v[108:111], v25 offset:0
    s_waitcnt lgkmcnt(6)
    v_mfma_f32_32x32x16_bf16 v[64:79], v[120:123], v[124:127], v[64:79]
    ds_read_b64_tr_b16 v[112:113], v16 offset:12288
    ds_read_b64_tr_b16 v[114:115], v16 offset:12800
    ds_read_b128 v[116:119], v26 offset:0
    s_waitcnt lgkmcnt(6)
    v_mfma_f32_32x32x16_bf16 v[64:79], v[96:99], v[100:103], v[64:79]
    ds_read_b64_tr_b16 v[120:121], v16 offset:14336
    ds_read_b64_tr_b16 v[122:123], v16 offset:14848
    ds_read_b128 v[124:127], v27 offset:0
    s_waitcnt lgkmcnt(6)
    v_mfma_f32_32x32x16_bf16 v[64:79], v[104:107], v[108:111], v[64:79]
    s_waitcnt lgkmcnt(3)
    v_mfma_f32_32x32x16_bf16 v[64:79], v[112:115], v[116:119], v[64:79]
    s_waitcnt lgkmcnt(0)
    v_mfma_f32_32x32x16_bf16 v[64:79], v[120:123], v[124:127], v[64:79]
    s_barrier
    ds_read_b64_tr_b16 v[96:97], v16 offset:32768
    ds_read_b64_tr_b16 v[98:99], v16 offset:33280
    ds_read_b128 v[100:103], v20 offset:32768
    ds_read_b64_tr_b16 v[104:105], v16 offset:34816
    ds_read_b64_tr_b16 v[106:107], v16 offset:35328
    ds_read_b128 v[108:111], v21 offset:32768
    ds_read_b64_tr_b16 v[112:113], v16 offset:36864
    ds_read_b64_tr_b16 v[114:115], v16 offset:37376
    ds_read_b128 v[116:119], v22 offset:32768
    s_waitcnt lgkmcnt(6)
    v_mfma_f32_32x32x16_bf16 v[64:79], v[96:99], v[100:103], v[64:79]
    ds_read_b64_tr_b16 v[120:121], v16 offset:38912
    ds_read_b64_tr_b16 v[122:123], v16 offset:39424
    ds_read_b128 v[124:127], v23 offset:32768
    s_waitcnt lgkmcnt(6)
    v_mfma_f32_32x32x16_bf16 v[64:79], v[104:107], v[108:111], v[64:79]
    ds_read_b64_tr_b16 v[96:97], v16 offset:40960
    ds_read_b64_tr_b16 v[98:99], v16 offset:41472
    ds_read_b128 v[100:103], v24 offset:32768
    s_waitcnt lgkmcnt(6)
    v_mfma_f32_32x32x16_bf16 v[64:79], v[112:115], v[116:119], v[64:79]
    ds_read_b64_tr_b16 v[104:105], v16 offset:43008
    ds_read_b64_tr_b16 v[106:107], v16 offset:43520
    ds_read_b128 v[108:111], v25 offset:32768
    s_waitcnt lgkmcnt(6)
    v_mfma_f32_32x32x16_bf16 v[64:79], v[120:123], v[124:127], v[64:79]
    ds_read_b64_tr_b16 v[112:113], v16 offset:45056
    ds_read_b64_tr_b16 v[114:115], v16 offset:45568
    ds_read_b128 v[116:119], v26 offset:32768
    s_waitcnt lgkmcnt(6)
    v_mfma_f32_32x32x16_bf16 v[64:79], v[96:99], v[100:103], v[64:79]
    ds_read_b64_tr_b16 v[120:121], v16 offset:47104
    ds_read_b64_tr_b16 v[122:123], v16 offset:47616
    ds_read_b128 v[124:127], v27 offset:32768
    s_waitcnt lgkmcnt(6)
    v_mfma_f32_32x32x16_bf16 v[64:79], v[104:107], v[108:111], v[64:79]
    s_waitcnt lgkmcnt(3)
    v_mfma_f32_32x32x16_bf16 v[64:79], v[112:115], v[116:119], v[64:79]
    s_waitcnt lgkmcnt(0)
    v_mfma_f32_32x32x16_bf16 v[64:79], v[120:123], v[124:127], v[64:79]
    v_lshrrev_b32 v14, 1, v3
    v_lshl_add_u32 v14, v14, 2, v12
    v_lshl_add_u32 v14, v9, 5, v14
    v_lshlrev_b32 v14, 7, v14
    v_lshl_add_u32 v14, v10, 6, v14
    v_and_b32 v15, 1, v3
    v_lshl_add_u32 v14, v15, 5, v14
    v_lshl_add_u32 v14, v13, 3, v14
    v_add_u32 v14, 131072, v14
    ds_read_b64_tr_b16 v[80:81], v14 offset:0
    ds_read_b64_tr_b16 v[82:83], v14 offset:1024
    ds_read_b64_tr_b16 v[84:85], v14 offset:2048
    ds_read_b64_tr_b16 v[86:87], v14 offset:3072
    s_nop 7
    v_cvt_pk_bf16_f32 v41, v64, v65
    v_lshlrev_b32 v64, 16, v41
    v_and_b32 v65, 0xffff0000, v41
    v_cvt_pk_bf16_f32 v41, v66, v67
    v_lshlrev_b32 v66, 16, v41
    v_and_b32 v67, 0xffff0000, v41
    v_cvt_pk_bf16_f32 v41, v68, v69
    v_lshlrev_b32 v68, 16, v41
    v_and_b32 v69, 0xffff0000, v41
    v_cvt_pk_bf16_f32 v41, v70, v71
    v_lshlrev_b32 v70, 16, v41
    v_and_b32 v71, 0xffff0000, v41
    v_cvt_pk_bf16_f32 v41, v72, v73
    v_lshlrev_b32 v72, 16, v41
    v_and_b32 v73, 0xffff0000, v41
    v_cvt_pk_bf16_f32 v41, v74, v75
    v_lshlrev_b32 v74, 16, v41
    v_and_b32 v75, 0xffff0000, v41
    v_cvt_pk_bf16_f32 v41, v76, v77
    v_lshlrev_b32 v76, 16, v41
    v_and_b32 v77, 0xffff0000, v41
    v_cvt_pk_bf16_f32 v41, v78, v79
    v_lshlrev_b32 v78, 16, v41
    v_and_b32 v79, 0xffff0000, v41
    s_waitcnt vmcnt(0) lgkmcnt(0)
    v_lshlrev_b32 v41, 16, v80
    v_add_f32 v64, v64, v41
    v_and_b32 v41, 0xffff0000, v80
    v_add_f32 v65, v65, v41
    v_lshlrev_b32 v41, 16, v81
    v_add_f32 v66, v66, v41
    v_and_b32 v41, 0xffff0000, v81
    v_add_f32 v67, v67, v41
    v_lshlrev_b32 v41, 16, v82
    v_add_f32 v68, v68, v41
    v_and_b32 v41, 0xffff0000, v82
    v_add_f32 v69, v69, v41
    v_lshlrev_b32 v41, 16, v83
    v_add_f32 v70, v70, v41
    v_and_b32 v41, 0xffff0000, v83
    v_add_f32 v71, v71, v41
    v_lshlrev_b32 v41, 16, v84
    v_add_f32 v72, v72, v41
    v_and_b32 v41, 0xffff0000, v84
    v_add_f32 v73, v73, v41
    v_lshlrev_b32 v41, 16, v85
    v_add_f32 v74, v74, v41
    v_and_b32 v41, 0xffff0000, v85
    v_add_f32 v75, v75, v41
    v_lshlrev_b32 v41, 16, v86
    v_add_f32 v76, v76, v41
    v_and_b32 v41, 0xffff0000, v86
    v_add_f32 v77, v77, v41
    v_lshlrev_b32 v41, 16, v87
    v_add_f32 v78, v78, v41
    v_and_b32 v41, 0xffff0000, v87
    v_add_f32 v79, v79, v41
    v_cvt_pk_bf16_f32 v88, v64, v65
    v_cvt_pk_bf16_f32 v89, v66, v67
    v_cvt_pk_bf16_f32 v90, v68, v69
    v_cvt_pk_bf16_f32 v91, v70, v71
    v_cvt_pk_bf16_f32 v92, v72, v73
    v_cvt_pk_bf16_f32 v93, v74, v75
    v_cvt_pk_bf16_f32 v94, v76, v77
    v_cvt_pk_bf16_f32 v95, v78, v79
    v_mov_b32 v42, 0
    v_mov_b32 v43, 0
    v_lshl_add_u32 v14, v9, 3, v11
    v_lshlrev_b32 v14, 9, v14
    v_lshl_add_u32 v15, v10, 5, v18
    v_lshl_add_u32 v14, v15, 1, v14
    v_add_u32 v14, 131072, v14
    v_lshlrev_b32 v41, 16, v88
    ds_write_b16 v14, v88 offset:0
    v_sub_f32 v41, v41, v40
    v_add_f32 v42, v42, v41
    v_fmac_f32 v43, v41, v41
    v_and_b32 v41, 0xffff0000, v88
    ds_write_b16_d16_hi v14, v88 offset:128
    v_sub_f32 v41, v41, v40
    v_add_f32 v42, v42, v41
    v_fmac_f32 v43, v41, v41
    v_lshlrev_b32 v41, 16, v89
    ds_write_b16 v14, v89 offset:256
    v_sub_f32 v41, v41, v40
    v_add_f32 v42, v42, v41
    v_fmac_f32 v43, v41, v41
    v_and_b32 v41, 0xffff0000, v89
    ds_write_b16_d16_hi v14, v89 offset:384
    v_sub_f32 v41, v41, v40
    v_add_f32 v42, v42, v41
    v_fmac_f32 v43, v41, v41
    v_lshlrev_b32 v41, 16, v90
    ds_write_b16 v14, v90 offset:1024
    v_sub_f32 v41, v41, v40
    v_add_f32 v42, v42, v41
    v_fmac_f32 v43, v41, v41
    v_and_b32 v41, 0xffff0000, v90
    ds_write_b16_d16_hi v14, v90 offset:1152
    v_sub_f32 v41, v41, v40
    v_add_f32 v42, v42, v41
    v_fmac_f32 v43, v41, v41
    v_lshlrev_b32 v41, 16, v91
    ds_write_b16 v14, v91 offset:1280
    v_sub_f32 v41, v41, v40
    v_add_f32 v42, v42, v41
    v_fmac_f32 v43, v41, v41
    v_and_b32 v41, 0xffff0000, v91
    ds_write_b16_d16_hi v14, v91 offset:1408
    v_sub_f32 v41, v41, v40
    v_add_f32 v42, v42, v41
    v_fmac_f32 v43, v41, v41
    v_lshlrev_b32 v41, 16, v92
    ds_write_b16 v14, v92 offset:2048
    v_sub_f32 v41, v41, v40
    v_add_f32 v42, v42, v41
    v_fmac_f32 v43, v41, v41
    v_and_b32 v41, 0xffff0000, v92
    ds_write_b16_d16_hi v14, v92 offset:2176
    v_sub_f32 v41, v41, v40
    v_add_f32 v42, v42, v41
    v_fmac_f32 v43, v41, v41
    v_lshlrev_b32 v41, 16, v93
    ds_write_b16 v14, v93 offset:2304
    v_sub_f32 v41, v41, v40
    v_add_f32 v42, v42, v41
    v_fmac_f32 v43, v41, v41
    v_and_b32 v41, 0xffff0000, v93
    ds_write_b16_d16_hi v14, v93 offset:2432
    v_sub_f32 v41, v41, v40
    v_add_f32 v42, v42, v41
    v_fmac_f32 v43, v41, v41
    v_lshlrev_b32 v41, 16, v94
    ds_write_b16 v14, v94 offset:3072
    v_sub_f32 v41, v41, v40
    v_add_f32 v42, v42, v41
    v_fmac_f32 v43, v41, v41
    v_and_b32 v41, 0xffff0000, v94
    ds_write_b16_d16_hi v14, v94 offset:3200
    v_sub_f32 v41, v41, v40
    v_add_f32 v42, v42, v41
    v_fmac_f32 v43, v41, v41
    v_lshlrev_b32 v41, 16, v95
    ds_write_b16 v14, v95 offset:3328
    v_sub_f32 v41, v41, v40
    v_add_f32 v42, v42, v41
    v_fmac_f32 v43, v41, v41
    v_and_b32 v41, 0xffff0000, v95
    ds_write_b16_d16_hi v14, v95 offset:3456
    v_sub_f32 v41, v41, v40
    v_add_f32 v42, v42, v41
    v_fmac_f32 v43, v41, v41
    s_nop 1
    v_permlane32_swap_b32 v42, v43
    s_nop 1
    v_add_f32 v42, v42, v43
    v_lshl_add_u32 v15, v10, 5, v18
    v_lshlrev_b32 v15, 2, v15
    v_lshl_add_u32 v15, v11, 13, v15
    s_lshl_b32 s51, s40, 8
    s_add_u32 s51, s51, 19996672
    buffer_atomic_add_f32 v42, v15, s[32:35], s51 offen
    s_waitcnt lgkmcnt(0)
    s_barrier
    v_lshlrev_b32 v14, 5, v0
    v_add_u32 v14, 131072, v14
    ds_read_b128 v[96:99], v14
    ds_read_b128 v[100:103], v14 offset:16
    v_lshrrev_b32 v15, 2, v0
    v_lshlrev_b32 v15, 12, v15
    v_and_b32 v14, 3, v0
    v_lshl_add_u32 v15, v14, 5, v15
    s_add_u32 s48, s47, 4194304
    s_waitcnt lgkmcnt(0)
    buffer_store_dwordx4 v[96:99], v15, s[32:35], s48 offen sc0 sc1
    buffer_store_dwordx4 v[100:103], v15, s[32:35], s48 offen offset:16 sc0 sc1
gemm2a_kernel_end:
    s_endpgm
.text
.globl conv2_kernel
.p2align 8
.type conv2_kernel,@function
conv2_kernel:
    s_load_dwordx16 s[4:19], s[0:1], 0
    s_load_dwordx8 s[20:27], s[0:1], 64
    s_load_dwordx2 s[28:29], s[0:1], 96
    s_cmp_ge_u32 s2, 512
    s_cbranch_scc1 conv2_kernel_end
    v_lshlrev_b32 v1, 4, v0
    v_lshlrev_b32 v2, 3, v0
    v_lshrrev_b32 v45, 6, v0
    s_lshl_b32 s3, s2, 12
    s_add_u32 s36, s3, 4194304
    s_add_u32 s37, s3, 6291456
    s_mul_i32 s38, s2, 4224
    s_add_u32 s38, s38, 16777216
    s_mov_b32 s39, 19988480
    s_mov_b32 s40, 19996672
    s_mov_b32 s41, 20004864
    v_readfirstlane_b32 s46, v45
    s_waitcnt lgkmcnt(0)
    s_mov_b32 s32, s28
    s_mov_b32 s33, s29
    s_mov_b32 s34, 268435456
    s_mov_b32 s35, 0x00020000
    buffer_load_dwordx4 v[16:19], v1, s[32:35], s39 offen
    buffer_load_dwordx4 v[20:23], v1, s[32:35], s40 offen
    buffer_load_dwordx4 v[24:27], v1, s[32:35], s41 offen
    buffer_load_dwordx2 v[4:5], v2, s[32:35], s36 offen
    s_lshr_b32 s3, s2, 1
    s_lshl_b32 s3, s3, 2
    s_add_u32 s16, s16, s3
    s_addc_u32 s17, s17, 0
    s_load_dword s42, s[16:17], 0
    v_mov_b32 v40, 0
    v_mov_b32 v41, 0
    v_mov_b32 v42, 0
    v_mov_b32 v43, 0
    s_cmp_ge_u32 s46, 4
    s_cbranch_scc1 conv2_kernel_nok
    buffer_load_dwordx4 v[8:11], v1, s[32:35], s38 offen
    buffer_load_dwordx2 v[12:13], v1, s[32:35], s38 offen offset:16
conv2_kernel_nok:
    v_and_b32 v44, 63, v0
    v_and_b32 v46, 31, v44
    v_lshrrev_b32 v47, 5, v44
    v_and_b32 v48, 3, v46
    v_sub_u32 v48, 3, v48
    v_mul_u32_u24 v48, 4160, v48
    v_lshrrev_b32 v49, 2, v46
    v_lshlrev_b32 v49, 3, v49
    v_sub_u32 v48, v48, v49
    v_lshl_add_u32 v48, v47, 4, v48
    v_lshlrev_b32 v49, 9, v45
    v_sub_u32 v48, v48, v49
    v_add_u32 v48, 1592, v48
    v_lshlrev_b32 v49, 3, v45
    v_sub_u32 v49, v46, v49
    v_add_u32 v49, 25, v49
    v_mul_u32_u24 v49, 80, v49
    v_lshl_add_u32 v49, v47, 4, v49
    v_add_u32 v49, 16640, v49
    v_lshrrev_b32 v50, 3, v0
    v_and_b32 v51, 7, v0
    v_mul_u32_u24 v57, 80, v50
    v_lshl_add_u32 v57, v51, 3, v57
    v_mul_u32_u24 v58, 144, v50
    v_lshl_add_u32 v58, v51, 4, v58
    v_mul_u32_u24 v59, 9216, v45
    v_mul_u32_u24 v50, 144, v46
    v_add_u32 v59, v59, v50
    v_lshl_add_u32 v59, v47, 4, v59
    v_mov_b32 v64, 0
    v_mov_b32 v65, 0
    v_mov_b32 v66, 0
    v_mov_b32 v67, 0
    v_mov_b32 v68, 0
    v_mov_b32 v69, 0
    v_mov_b32 v70, 0
    v_mov_b32 v71, 0
    v_mov_b32 v72, 0
    v_mov_b32 v73, 0
    v_mov_b32 v74, 0
    v_mov_b32 v75, 0
    v_mov_b32 v76, 0
    v_mov_b32 v77, 0
    v_mov_b32 v78, 0
    v_mov_b32 v79, 0
    v_mov_b32 v80, 0
    v_mov_b32 v81, 0
    v_mov_b32 v82, 0
    v_mov_b32 v83, 0
    v_mov_b32 v84, 0
    v_mov_b32 v85, 0
    v_mov_b32 v86, 0
    v_mov_b32 v87, 0
    v_mov_b32 v88, 0
    v_mov_b32 v89, 0
    v_mov_b32 v90, 0
    v_mov_b32 v91, 0
    v_mov_b32 v92, 0
    v_mov_b32 v93, 0
    v_mov_b32 v94, 0
    v_mov_b32 v95, 0
    s_cmp_ge_u32 s46, 4
    s_cbranch_scc1 conv2_kernel_hi
    v_cmp_gt_u32 vcc, 4, v0
    s_and_saveexec_b64 s[44:45], vcc
    ds_write_b128 v1, v[40:43] offset:4096
    ds_write_b128 v1, v[40:43] offset:8256
    ds_write_b128 v1, v[40:43] offset:12416
    ds_write_b128 v1, v[40:43] offset:16576
    s_mov_b64 exec, s[44:45]
    s_waitcnt vmcnt(0)
    ds_write_b128 v1, v[8:11] offset:0
    v_alignbyte_b32 v52, v9, v8, 2
    v_alignbyte_b32 v53, v10, v9, 2
    v_alignbyte_b32 v54, v11, v10, 2
    v_alignbyte_b32 v55, v12, v11, 2
    v_alignbyte_b32 v56, v13, v12, 2
    v_mov_b32 v60, v9
    v_mov_b32 v61, v10
    v_mov_b32 v62, v11
    v_mov_b32 v63, v12
    ds_write_b128 v1, v[52:55] offset:4160
    ds_write_b128 v1, v[60:63] offset:8320
    v_mov_b32 v8, v53
    v_mov_b32 v9, v54
    v_mov_b32 v10, v55
    v_mov_b32 v11, v56
    ds_write_b128 v1, v[8:11] offset:12480
    s_branch conv2_kernel_join
conv2_kernel_hi:
    v_cmp_gt_u32 vcc, 416, v0
    s_and_saveexec_b64 s[44:45], vcc
    ds_write_b128 v1, v[40:43] offset:12544
    s_mov_b64 exec, s[44:45]
conv2_kernel_join:
    s_waitcnt vmcnt(1)
    v_mul_f32 v20, 0x3b000000, v20
    v_mul_f32 v24, 0x3b000000, v24
    v_add_f32 v16, v16, v20
    v_fma_f32 v24, -v20, v20, v24
    v_max_f32 v24, 0, v24
    v_mul_f32 v21, 0x3b000000, v21
    v_mul_f32 v25, 0x3b000000, v25
    v_add_f32 v17, v17, v21
    v_fma_f32 v25, -v21, v21, v25
    v_max_f32 v25, 0, v25
    v_mul_f32 v22, 0x3b000000, v22
    v_mul_f32 v26, 0x3b000000, v26
    v_add_f32 v18, v18, v22
    v_fma_f32 v26, -v22, v22, v26
    v_max_f32 v26, 0, v26
    v_mul_f32 v23, 0x3b000000, v23
    v_mul_f32 v27, 0x3b000000, v27
    v_add_f32 v19, v19, v23
    v_fma_f32 v27, -v23, v23, v27
    v_max_f32 v27, 0, v27
    v_cvt_pk_bf16_f32 v50, v16, v17
    v_lshlrev_b32 v16, 16, v50
    v_and_b32 v17, 0xffff0000, v50
    v_cvt_pk_bf16_f32 v51, v24, v25
    v_lshlrev_b32 v24, 16, v51
    v_and_b32 v25, 0xffff0000, v51
    v_cvt_pk_bf16_f32 v50, v18, v19
    v_lshlrev_b32 v18, 16, v50
    v_and_b32 v19, 0xffff0000, v50
    v_cvt_pk_bf16_f32 v51, v26, v27
    v_lshlrev_b32 v26, 16, v51
    v_and_b32 v27, 0xffff0000, v51
    v_add_f32 v24, 0x3727c5ac, v24
    v_add_f32 v25, 0x3727c5ac, v25
    v_add_f32 v26, 0x3727c5ac, v26
    v_add_f32 v27, 0x3727c5ac, v27
    v_cvt_pk_bf16_f32 v51, v24, v25
    v_lshlrev_b32 v24, 16, v51
    v_and_b32 v25, 0xffff0000, v51
    v_cvt_pk_bf16_f32 v51, v26, v27
    v_lshlrev_b32 v26, 16, v51
    v_and_b32 v27, 0xffff0000, v51
    v_sqrt_f32 v20, v24
    v_sqrt_f32 v21, v25
    v_sqrt_f32 v22, v26
    v_sqrt_f32 v23, v27
    s_nop 0
    v_cvt_pk_bf16_f32 v51, v20, v21
    v_lshlrev_b32 v20, 16, v51
    v_and_b32 v21, 0xffff0000, v51
    v_cvt_pk_bf16_f32 v51, v22, v23
    v_lshlrev_b32 v22, 16, v51
    v_and_b32 v23, 0xffff0000, v51
    v_rcp_f32 v24, v20
    v_rcp_f32 v25, v21
    v_rcp_f32 v26, v22
    v_rcp_f32 v27, v23
    s_waitcnt vmcnt(0)
    v_lshlrev_b32 v28, 16, v4
    v_and_b32 v29, 0xffff0000, v4
    v_lshlrev_b32 v30, 16, v5
    v_and_b32 v31, 0xffff0000, v5
    v_sub_f32 v32, v28, v16
    v_sub_f32 v33, v29, v17
    v_sub_f32 v34, v30, v18
    v_sub_f32 v35, v31, v19
    v_cvt_pk_bf16_f32 v50, v32, v33
    v_lshlrev_b32 v32, 16, v50
    v_and_b32 v33, 0xffff0000, v50
    v_cvt_pk_bf16_f32 v50, v34, v35
    v_lshlrev_b32 v34, 16, v50
    v_and_b32 v35, 0xffff0000, v50
    v_mul_f32 v36, v32, v24
    v_mul_f32 v37, v33, v25
    v_mul_f32 v38, v34, v26
    v_mul_f32 v39, v35, v27
    v_fma_f32 v32, -v36, v20, v32
    v_fma_f32 v33, -v37, v21, v33
    v_fma_f32 v34, -v38, v22, v34
    v_fma_f32 v35, -v39, v23, v35
    v_fmac_f32 v36, v32, v24
    v_fmac_f32 v37, v33, v25
    v_fmac_f32 v38, v34, v26
    v_fmac_f32 v39, v35, v27
    v_cvt_pk_bf16_f32 v6, v36, v37
    v_lshlrev_b32 v36, 16, v6
    v_and_b32 v37, 0xffff0000, v6
    v_cvt_pk_bf16_f32 v7, v38, v39
    v_lshlrev_b32 v38, 16, v7
    v_and_b32 v39, 0xffff0000, v7
    ds_write_b64 v57, v[6:7] offset:19200
    s_waitcnt lgkmcnt(0)
    s_barrier
    s_cmp_ge_u32 s46, 4
    s_cbranch_scc1 conv2_kernel_skipmain
    ds_read_b64 v[96:97], v48 offset:2496
    ds_read_b64 v[98:99], v48 offset:2504
    ds_read_b128 v[108:111], v49 offset:3120
    ds_read_b128 v[104:107], v49 offset:560
    ds_read_b64 v[100:101], v48 offset:448
    ds_read_b64 v[102:103], v48 offset:456
    s_waitcnt lgkmcnt(3)
    v_mfma_f32_32x32x16_bf16 v[80:95], v[96:99], v[108:111], v[80:95]
    ds_read_b64 v[112:113], v48 offset:2528
    ds_read_b64 v[114:115], v48 offset:2536
    ds_read_b128 v[124:127], v49 offset:3152
    s_waitcnt lgkmcnt(5)
    v_mfma_f32_32x32x16_bf16 v[64:79], v[96:99], v[104:107], v[64:79]
    ds_read_b128 v[120:123], v49 offset:592
    s_waitcnt lgkmcnt(4)
    v_mfma_f32_32x32x16_bf16 v[80:95], v[100:103], v[104:107], v[80:95]
    ds_read_b64 v[116:117], v48 offset:480
    ds_read_b64 v[118:119], v48 offset:488
    s_waitcnt lgkmcnt(3)
    v_mfma_f32_32x32x16_bf16 v[80:95], v[112:115], v[124:127], v[80:95]
    ds_read_b64 v[96:97], v48 offset:2432
    ds_read_b64 v[98:99], v48 offset:2440
    ds_read_b128 v[108:111], v49 offset:3040
    s_waitcnt lgkmcnt(5)
    v_mfma_f32_32x32x16_bf16 v[64:79], v[112:115], v[120:123], v[64:79]
    ds_read_b128 v[104:107], v49 offset:480
    s_waitcnt lgkmcnt(4)
    v_mfma_f32_32x32x16_bf16 v[80:95], v[116:119], v[120:123], v[80:95]
    ds_read_b64 v[100:101], v48 offset:384
    ds_read_b64 v[102:103], v48 offset:392
    s_waitcnt lgkmcnt(3)
    v_mfma_f32_32x32x16_bf16 v[80:95], v[96:99], v[108:111], v[80:95]
    ds_read_b64 v[112:113], v48 offset:2464
    ds_read_b64 v[114:115], v48 offset:2472
    ds_read_b128 v[124:127], v49 offset:3072
    s_waitcnt lgkmcnt(5)
    v_mfma_f32_32x32x16_bf16 v[64:79], v[96:99], v[104:107], v[64:79]
    ds_read_b128 v[120:123], v49 offset:512
    s_waitcnt lgkmcnt(4)
    v_mfma_f32_32x32x16_bf16 v[80:95], v[100:103], v[104:107], v[80:95]
    ds_read_b64 v[116:117], v48 offset:416
    ds_read_b64 v[118:119], v48 offset:424
    s_waitcnt lgkmcnt(3)
    v_mfma_f32_32x32x16_bf16 v[80:95], v[112:115], v[124:127], v[80:95]
    ds_read_b64 v[96:97], v48 offset:2368
    ds_read_b64 v[98:99], v48 offset:2376
    ds_read_b128 v[108:111], v49 offset:2960
    s_waitcnt lgkmcnt(5)
    v_mfma_f32_32x32x16_bf16 v[64:79], v[112:115], v[120:123], v[64:79]
    ds_read_b128 v[104:107], v49 offset:400
    s_waitcnt lgkmcnt(4)
    v_mfma_f32_32x32x16_bf16 v[80:95], v[116:119], v[120:123], v[80:95]
    ds_read_b64 v[100:101], v48 offset:320
    ds_read_b64 v[102:103], v48 offset:328
    s_waitcnt lgkmcnt(3)
    v_mfma_f32_32x32x16_bf16 v[80:95], v[96:99], v[108:111], v[80:95]
    ds_read_b64 v[112:113], v48 offset:2400
    ds_read_b64 v[114:115], v48 offset:2408
    ds_read_b128 v[124:127], v49 offset:2992
    s_waitcnt lgkmcnt(5)
    v_mfma_f32_32x32x16_bf16 v[64:79], v[96:99], v[104:107], v[64:79]
    ds_read_b128 v[120:123], v49 offset:432
    s_waitcnt lgkmcnt(4)
    v_mfma_f32_32x32x16_bf16 v[80:95], v[100:103], v[104:107], v[80:95]
    ds_read_b64 v[116:117], v48 offset:352
    ds_read_b64 v[118:119], v48 offset:360
    s_waitcnt lgkmcnt(3)
    v_mfma_f32_32x32x16_bf16 v[80:95], v[112:115], v[124:127], v[80:95]
    ds_read_b64 v[96:97], v48 offset:2304
    ds_read_b64 v[98:99], v48 offset:2312
    ds_read_b128 v[108:111], v49 offset:2880
    s_waitcnt lgkmcnt(5)
    v_mfma_f32_32x32x16_bf16 v[64:79], v[112:115], v[120:123], v[64:79]
    ds_read_b128 v[104:107], v49 offset:320
    s_waitcnt lgkmcnt(4)
    v_mfma_f32_32x32x16_bf16 v[80:95], v[116:119], v[120:123], v[80:95]
    ds_read_b64 v[100:101], v48 offset:256
    ds_read_b64 v[102:103], v48 offset:264
    s_waitcnt lgkmcnt(3)
    v_mfma_f32_32x32x16_bf16 v[80:95], v[96:99], v[108:111], v[80:95]
    ds_read_b64 v[112:113], v48 offset:2336
    ds_read_b64 v[114:115], v48 offset:2344
    ds_read_b128 v[124:127], v49 offset:2912
    s_waitcnt lgkmcnt(5)
    v_mfma_f32_32x32x16_bf16 v[64:79], v[96:99], v[104:107], v[64:79]
    ds_read_b128 v[120:123], v49 offset:352
    s_waitcnt lgkmcnt(4)
    v_mfma_f32_32x32x16_bf16 v[80:95], v[100:103], v[104:107], v[80:95]
    ds_read_b64 v[116:117], v48 offset:288
    ds_read_b64 v[118:119], v48 offset:296
    s_waitcnt lgkmcnt(3)
    v_mfma_f32_32x32x16_bf16 v[80:95], v[112:115], v[124:127], v[80:95]
    ds_read_b64 v[96:97], v48 offset:2240
    ds_read_b64 v[98:99], v48 offset:2248
    ds_read_b128 v[108:111], v49 offset:2800
    s_waitcnt lgkmcnt(5)
    v_mfma_f32_32x32x16_bf16 v[64:79], v[112:115], v[120:123], v[64:79]
    ds_read_b128 v[104:107], v49 offset:240
    s_waitcnt lgkmcnt(4)
    v_mfma_f32_32x32x16_bf16 v[80:95], v[116:119], v[120:123], v[80:95]
    ds_read_b64 v[100:101], v48 offset:192
    ds_read_b64 v[102:103], v48 offset:200
    s_waitcnt lgkmcnt(3)
    v_mfma_f32_32x32x16_bf16 v[80:95], v[96:99], v[108:111], v[80:95]
    ds_read_b64 v[112:113], v48 offset:2272
    ds_read_b64 v[114:115], v48 offset:2280
    ds_read_b128 v[124:127], v49 offset:2832
    s_waitcnt lgkmcnt(5)
    v_mfma_f32_32x32x16_bf16 v[64:79], v[96:99], v[104:107], v[64:79]
    ds_read_b128 v[120:123], v49 offset:272
    s_waitcnt lgkmcnt(4)
    v_mfma_f32_32x32x16_bf16 v[80:95], v[100:103], v[104:107], v[80:95]
    ds_read_b64 v[116:117], v48 offset:224
    ds_read_b64 v[118:119], v48 offset:232
    s_waitcnt lgkmcnt(3)
    v_mfma_f32_32x32x16_bf16 v[80:95], v[112:115], v[124:127], v[80:95]
    ds_read_b64 v[96:97], v48 offset:2176
    ds_read_b64 v[98:99], v48 offset:2184
    ds_read_b128 v[108:111], v49 offset:2720
    s_waitcnt lgkmcnt(5)
    v_mfma_f32_32x32x16_bf16 v[64:79], v[112:115], v[120:123], v[64:79]
    ds_read_b128 v[104:107], v49 offset:160
    s_waitcnt lgkmcnt(4)
    v_mfma_f32_32x32x16_bf16 v[80:95], v[116:119], v[120:123], v[80:95]
    ds_read_b64 v[100:101], v48 offset:128
    ds_read_b64 v[102:103], v48 offset:136
    s_waitcnt lgkmcnt(3)
    v_mfma_f32_32x32x16_bf16 v[80:95], v[96:99], v[108:111], v[80:95]
    ds_read_b64 v[112:113], v48 offset:2208
    ds_read_b64 v[114:115], v48 offset:2216
    ds_read_b128 v[124:127], v49 offset:2752
    s_waitcnt lgkmcnt(5)
    v_mfma_f32_32x32x16_bf16 v[64:79], v[96:99], v[104:107], v[64:79]
    ds_read_b128 v[120:123], v49 offset:192
    s_waitcnt lgkmcnt(4)
    v_mfma_f32_32x32x16_bf16 v[80:95], v[100:103], v[104:107], v[80:95]
    ds_read_b64 v[116:117], v48 offset:160
    ds_read_b64 v[118:119], v48 offset:168
    s_waitcnt lgkmcnt(3)
    v_mfma_f32_32x32x16_bf16 v[80:95], v[112:115], v[124:127], v[80:95]
    ds_read_b64 v[96:97], v48 offset:2112
    ds_read_b64 v[98:99], v48 offset:2120
    ds_read_b128 v[108:111], v49 offset:2640
    s_waitcnt lgkmcnt(5)
    v_mfma_f32_32x32x16_bf16 v[64:79], v[112:115], v[120:123], v[64:79]
    ds_read_b128 v[104:107], v49 offset:80
    s_waitcnt lgkmcnt(4)
    v_mfma_f32_32x32x16_bf16 v[80:95], v[116:119], v[120:123], v[80:95]
    ds_read_b64 v[100:101], v48 offset:64
    ds_read_b64 v[102:103], v48 offset:72
    s_waitcnt lgkmcnt(3)
    v_mfma_f32_32x32x16_bf16 v[80:95], v[96:99], v[108:111], v[80:95]
    ds_read_b64 v[112:113], v48 offset:2144
    ds_read_b64 v[114:115], v48 offset:2152
    ds_read_b128 v[124:127], v49 offset:2672
    s_waitcnt lgkmcnt(5)
    v_mfma_f32_32x32x16_bf16 v[64:79], v[96:99], v[104:107], v[64:79]
    ds_read_b128 v[120:123], v49 offset:112
    s_waitcnt lgkmcnt(4)
    v_mfma_f32_32x32x16_bf16 v[80:95], v[100:103], v[104:107], v[80:95]
    ds_read_b64 v[116:117], v48 offset:96
    ds_read_b64 v[118:119], v48 offset:104
    s_waitcnt lgkmcnt(3)
    v_mfma_f32_32x32x16_bf16 v[80:95], v[112:115], v[124:127], v[80:95]
    ds_read_b64 v[96:97], v48 offset:2048
    ds_read_b64 v[98:99], v48 offset:2056
    ds_read_b128 v[108:111], v49 offset:2560
    s_waitcnt lgkmcnt(5)
    v_mfma_f32_32x32x16_bf16 v[64:79], v[112:115], v[120:123], v[64:79]
    ds_read_b128 v[104:107], v49 offset:0
    s_waitcnt lgkmcnt(4)
    v_mfma_f32_32x32x16_bf16 v[80:95], v[116:119], v[120:123], v[80:95]
    ds_read_b64 v[100:101], v48 offset:0
    ds_read_b64 v[102:103], v48 offset:8
    s_waitcnt lgkmcnt(3)
    v_mfma_f32_32x32x16_bf16 v[80:95], v[96:99], v[108:111], v[80:95]
    ds_read_b64 v[112:113], v48 offset:2080
    ds_read_b64 v[114:115], v48 offset:2088
    ds_read_b128 v[124:127], v49 offset:2592
    s_waitcnt lgkmcnt(5)
    v_mfma_f32_32x32x16_bf16 v[64:79], v[96:99], v[104:107], v[64:79]
    ds_read_b128 v[120:123], v49 offset:32
    s_waitcnt lgkmcnt(4)
    v_mfma_f32_32x32x16_bf16 v[80:95], v[100:103], v[104:107], v[80:95]
    ds_read_b64 v[116:117], v48 offset:32
    ds_read_b64 v[118:119], v48 offset:40
    s_waitcnt lgkmcnt(3)
    v_mfma_f32_32x32x16_bf16 v[80:95], v[112:115], v[124:127], v[80:95]
    s_waitcnt lgkmcnt(2)
    v_mfma_f32_32x32x16_bf16 v[64:79], v[112:115], v[120:123], v[64:79]
    s_waitcnt lgkmcnt(0)
    v_mfma_f32_32x32x16_bf16 v[80:95], v[116:119], v[120:123], v[80:95]
conv2_kernel_skipmain:
    s_and_b32 s43, s2, 1
    s_lshl_b32 s43, s43, 4
    s_lshr_b32 s42, s42, s43
    s_lshl_b32 s42, s42, 16
    v_mul_f32 v32, s42, v36
    v_mul_f32 v33, s42, v37
    v_mul_f32 v34, s42, v38
    v_mul_f32 v35, s42, v39
    v_cvt_pk_bf16_f32 v50, v32, v33
    v_lshlrev_b32 v32, 16, v50
    v_and_b32 v33, 0xffff0000, v50
    v_cvt_pk_bf16_f32 v50, v34, v35
    v_lshlrev_b32 v34, 16, v50
    v_and_b32 v35, 0xffff0000, v50
    s_barrier
    s_cmp_ge_u32 s46, 4
    s_cbranch_scc1 conv2_kernel_skipw
    s_nop 3
    ds_write_b128 v59, v[64:67] offset:0
    ds_write_b128 v59, v[68:71] offset:32
    ds_write_b128 v59, v[72:75] offset:64
    ds_write_b128 v59, v[76:79] offset:96
    ds_write_b128 v59, v[80:83] offset:4608
    ds_write_b128 v59, v[84:87] offset:4640
    ds_write_b128 v59, v[88:91] offset:4672
    ds_write_b128 v59, v[92:95] offset:4704
    s_waitcnt lgkmcnt(0)
conv2_kernel_skipw:
    s_barrier
    ds_read_b128 v[96:99], v58 offset:0
    ds_read_b128 v[100:103], v58 offset:9216
    ds_read_b128 v[104:107], v58 offset:18432
    ds_read_b128 v[108:111], v58 offset:27648
    s_waitcnt lgkmcnt(2)
    v_add_f32 v96, v96, v100
    v_add_f32 v97, v97, v101
    v_add_f32 v98, v98, v102
    v_add_f32 v99, v99, v103
    s_waitcnt lgkmcnt(0)
    v_add_f32 v104, v104, v108
    v_add_f32 v105, v105, v109
    v_add_f32 v106, v106, v110
    v_add_f32 v107, v107, v111
    v_add_f32 v96, v96, v104
    v_add_f32 v97, v97, v105
    v_add_f32 v98, v98, v106
    v_add_f32 v99, v99, v107
    v_cvt_pk_bf16_f32 v50, v96, v97
    v_lshlrev_b32 v96, 16, v50
    v_and_b32 v97, 0xffff0000, v50
    v_cvt_pk_bf16_f32 v50, v98, v99
    v_lshlrev_b32 v98, 16, v50
    v_and_b32 v99, 0xffff0000, v50
    v_add_f32 v96, v96, v32
    v_add_f32 v97, v97, v33
    v_add_f32 v98, v98, v34
    v_add_f32 v99, v99, v35
    v_cvt_pk_bf16_f32 v50, v96, v97
    v_lshlrev_b32 v96, 16, v50
    v_and_b32 v97, 0xffff0000, v50
    v_cvt_pk_bf16_f32 v50, v98, v99
    v_lshlrev_b32 v98, 16, v50
    v_and_b32 v99, 0xffff0000, v50
    v_add_f32 v96, v96, v28
    v_add_f32 v97, v97, v29
    v_add_f32 v98, v98, v30
    v_add_f32 v99, v99, v31
    v_cvt_pk_bf16_f32 v100, v96, v97
    v_cvt_pk_bf16_f32 v101, v98, v99
    buffer_store_dwordx2 v[100:101], v2, s[32:35], s37 offen sc0 sc1
conv2_kernel_end:
    s_endpgm
.text
.globl gemm1b_kernel
.p2align 8
.type gemm1b_kernel,@function
gemm1b_kernel:
    s_load_dwordx16 s[4:19], s[0:1], 0
    s_load_dwordx8 s[20:27], s[0:1], 64
    s_load_dwordx2 s[28:29], s[0:1], 96
    s_cmp_ge_u32 s2, 224
    s_cbranch_scc1 gemm1b_kernel_end
    v_and_b32 v1, 63, v0
    v_lshrrev_b32 v2, 6, v0
    v_lshrrev_b32 v3, 4, v1
    v_and_b32 v4, 15, v1
    v_readfirstlane_b32 s42, v2
    v_and_b32 v2, 3, v2
    s_and_b32 s3, s2, 6
    s_lshl_b32 s3, s3, 1
    s_lshr_b32 s40, s2, 3
    s_and_b32 s40, s40, 3
    s_add_u32 s40, s3, s40
    s_and_b32 s3, s2, 1
    s_mul_i32 s3, s3, 7
    s_lshr_b32 s41, s2, 5
    s_add_u32 s41, s41, s3
    v_lshrrev_b32 v12, 2, v1
    v_and_b32 v12, 3, v12
    v_and_b32 v13, 3, v1
    v_lshrrev_b32 v14, 1, v3
    v_lshl_add_u32 v14, v14, 3, v12
    v_lshlrev_b32 v14, 8, v14
    v_and_b32 v15, 1, v3
    v_lshl_add_u32 v14, v15, 5, v14
    v_lshrrev_b32 v15, 1, v13
    v_lshl_add_u32 v14, v15, 4, v14
    v_and_b32 v15, 1, v13
    v_lshl_add_u32 v14, v15, 3, v14
    s_waitcnt lgkmcnt(0)
    s_mov_b32 s32, s28
    s_mov_b32 s33, s29
    s_mov_b32 s34, 268435456
    s_mov_b32 s35, 0x00020000
    s_cmp_lt_u32 s42, 4
    s_cbranch_scc1 gemm1b_kernel_compute
    s_cmp_ge_u32 s42, 8
    s_cbranch_scc1 gemm1b_kernel_stats
    s_mov_b32 s36, s20
    s_mov_b32 s37, s21
    s_mov_b32 s38, 1835008
    s_mov_b32 s39, 0x00020000
    s_and_b32 s42, s42, 3
    v_lshlrev_b32 v5, 2, v3
    v_xor_b32 v4, v4, v5
    v_lshl_add_u32 v5, v2, 4, v3
    v_mul_u32_u24 v6, 3584, v5
    v_lshl_add_u32 v6, v4, 4, v6
    v_lshlrev_b32 v7, 12, v5
    v_lshl_add_u32 v7, v4, 4, v7
    s_lshl_b32 s43, s41, 8
    s_lshl_b32 s44, s40, 8
    s_add_u32 s44, s44, 6291456
    s_lshl_b32 s45, s42, 12
    s_add_u32 s46, s44, 0
    s_add_u32 m0, s45, 16384
    s_nop 0
    buffer_load_dwordx4 v7, s[32:35], s46 offen lds
    s_add_u32 s46, s44, 16384
    s_add_u32 m0, s45, 17408
    s_nop 0
    buffer_load_dwordx4 v7, s[32:35], s46 offen lds
    s_add_u32 s46, s44, 32768
    s_add_u32 m0, s45, 18432
    s_nop 0
    buffer_load_dwordx4 v7, s[32:35], s46 offen lds
    s_add_u32 s46, s44, 49152
    s_add_u32 m0, s45, 19456
    s_nop 0
    buffer_load_dwordx4 v7, s[32:35], s46 offen lds
    s_add_u32 s46, s43, 0
    s_add_u32 m0, s45, 0
    s_nop 0
    buffer_load_dwordx4 v6, s[36:39], s46 offen lds
    s_add_u32 s46, s43, 14336
    s_add_u32 m0, s45, 1024
    s_nop 0
    buffer_load_dwordx4 v6, s[36:39], s46 offen lds
    s_add_u32 s46, s43, 28672
    s_add_u32 m0, s45, 2048
    s_nop 0
    buffer_load_dwordx4 v6, s[36:39], s46 offen lds
    s_add_u32 s46, s43, 43008
    s_add_u32 m0, s45, 3072
    s_nop 0
    buffer_load_dwordx4 v6, s[36:39], s46 offen lds
    s_add_u32 s46, s44, 262144
    s_add_u32 m0, s45, 49152
    s_nop 0
    buffer_load_dwordx4 v7, s[32:35], s46 offen lds
    s_add_u32 s46, s44, 278528
    s_add_u32 m0, s45, 50176
    s_nop 0
    buffer_load_dwordx4 v7, s[32:35], s46 offen lds
    s_add_u32 s46, s44, 294912
    s_add_u32 m0, s45, 51200
    s_nop 0
    buffer_load_dwordx4 v7, s[32:35], s46 offen lds
    s_add_u32 s46, s44, 311296
    s_add_u32 m0, s45, 52224
    s_nop 0
    buffer_load_dwordx4 v7, s[32:35], s46 offen lds
    s_add_u32 s46, s43, 229376
    s_add_u32 m0, s45, 32768
    s_nop 0
    buffer_load_dwordx4 v6, s[36:39], s46 offen lds
    s_add_u32 s46, s43, 243712
    s_add_u32 m0, s45, 33792
    s_nop 0
    buffer_load_dwordx4 v6, s[36:39], s46 offen lds
    s_add_u32 s46, s43, 258048
    s_add_u32 m0, s45, 34816
    s_nop 0
    buffer_load_dwordx4 v6, s[36:39], s46 offen lds
    s_add_u32 s46, s43, 272384
    s_add_u32 m0, s45, 35840
    s_nop 0
    buffer_load_dwordx4 v6, s[36:39], s46 offen lds
    s_waitcnt vmcnt(8)
    s_barrier
    s_add_u32 s46, s44, 524288
    s_add_u32 m0, s45, 81920
    s_nop 0
    buffer_load_dwordx4 v7, s[32:35], s46 offen lds
    s_add_u32 s46, s44, 540672
    s_add_u32 m0, s45, 82944
    s_nop 0
    buffer_load_dwordx4 v7, s[32:35], s46 offen lds
    s_add_u32 s46, s44, 557056
    s_add_u32 m0, s45, 83968
    s_nop 0
    buffer_load_dwordx4 v7, s[32:35], s46 offen lds
    s_add_u32 s46, s44, 573440
    s_add_u32 m0, s45, 84992
    s_nop 0
    buffer_load_dwordx4 v7, s[32:35], s46 offen lds
    s_add_u32 s46, s43, 458752
    s_add_u32 m0, s45, 65536
    s_nop 0
    buffer_load_dwordx4 v6, s[36:39], s46 offen lds
    s_add_u32 s46, s43, 473088
    s_add_u32 m0, s45, 66560
    s_nop 0
    buffer_load_dwordx4 v6, s[36:39], s46 offen lds
    s_add_u32 s46, s43, 487424
    s_add_u32 m0, s45, 67584
    s_nop 0
    buffer_load_dwordx4 v6, s[36:39], s46 offen lds
    s_add_u32 s46, s43, 501760
    s_add_u32 m0, s45, 68608
    s_nop 0
    buffer_load_dwordx4 v6, s[36:39], s46 offen lds
    s_add_u32 s46, s44, 786432
    s_add_u32 m0, s45, 114688
    s_nop 0
    buffer_load_dwordx4 v7, s[32:35], s46 offen lds
    s_add_u32 s46, s44, 802816
    s_add_u32 m0, s45, 115712
    s_nop 0
    buffer_load_dwordx4 v7, s[32:35], s46 offen lds
    s_add_u32 s46, s44, 819200
    s_add_u32 m0, s45, 116736
    s_nop 0
    buffer_load_dwordx4 v7, s[32:35], s46 offen lds
    s_add_u32 s46, s44, 835584
    s_add_u32 m0, s45, 117760
    s_nop 0
    buffer_load_dwordx4 v7, s[32:35], s46 offen lds
    s_add_u32 s46, s43, 688128
    s_add_u32 m0, s45, 98304
    s_nop 0
    buffer_load_dwordx4 v6, s[36:39], s46 offen lds
    s_add_u32 s46, s43, 702464
    s_add_u32 m0, s45, 99328
    s_nop 0
    buffer_load_dwordx4 v6, s[36:39], s46 offen lds
    s_add_u32 s46, s43, 716800
    s_add_u32 m0, s45, 100352
    s_nop 0
    buffer_load_dwordx4 v6, s[36:39], s46 offen lds
    s_add_u32 s46, s43, 731136
    s_add_u32 m0, s45, 101376
    s_nop 0
    buffer_load_dwordx4 v6, s[36:39], s46 offen lds
    s_waitcnt vmcnt(16)
    s_barrier
    s_add_u32 s46, s44, 1048576
    s_add_u32 m0, s45, 16384
    s_nop 0
    buffer_load_dwordx4 v7, s[32:35], s46 offen lds
    s_add_u32 s46, s44, 1064960
    s_add_u32 m0, s45, 17408
    s_nop 0
    buffer_load_dwordx4 v7, s[32:35], s46 offen lds
    s_add_u32 s46, s44, 1081344
    s_add_u32 m0, s45, 18432
    s_nop 0
    buffer_load_dwordx4 v7, s[32:35], s46 offen lds
    s_add_u32 s46, s44, 1097728
    s_add_u32 m0, s45, 19456
    s_nop 0
    buffer_load_dwordx4 v7, s[32:35], s46 offen lds
    s_add_u32 s46, s43, 917504
    s_add_u32 m0, s45, 0
    s_nop 0
    buffer_load_dwordx4 v6, s[36:39], s46 offen lds
    s_add_u32 s46, s43, 931840
    s_add_u32 m0, s45, 1024
    s_nop 0
    buffer_load_dwordx4 v6, s[36:39], s46 offen lds
    s_add_u32 s46, s43, 946176
    s_add_u32 m0, s45, 2048
    s_nop 0
    buffer_load_dwordx4 v6, s[36:39], s46 offen lds
    s_add_u32 s46, s43, 960512
    s_add_u32 m0, s45, 3072
    s_nop 0
    buffer_load_dwordx4 v6, s[36:39], s46 offen lds
    s_waitcnt vmcnt(16)
    s_barrier
    s_add_u32 s46, s44, 1310720
    s_add_u32 m0, s45, 49152
    s_nop 0
    buffer_load_dwordx4 v7, s[32:35], s46 offen lds
    s_add_u32 s46, s44, 1327104
    s_add_u32 m0, s45, 50176
    s_nop 0
    buffer_load_dwordx4 v7, s[32:35], s46 offen lds
    s_add_u32 s46, s44, 1343488
    s_add_u32 m0, s45, 51200
    s_nop 0
    buffer_load_dwordx4 v7, s[32:35], s46 offen lds
    s_add_u32 s46, s44, 1359872
    s_add_u32 m0, s45, 52224
    s_nop 0
    buffer_load_dwordx4 v7, s[32:35], s46 offen lds
    s_add_u32 s46, s43, 1146880
    s_add_u32 m0, s45, 32768
    s_nop 0
    buffer_load_dwordx4 v6, s[36:39], s46 offen lds
    s_add_u32 s46, s43, 1161216
    s_add_u32 m0, s45, 33792
    s_nop 0
    buffer_load_dwordx4 v6, s[36:39], s46 offen lds
    s_add_u32 s46, s43, 1175552
    s_add_u32 m0, s45, 34816
    s_nop 0
    buffer_load_dwordx4 v6, s[36:39], s46 offen lds
    s_add_u32 s46, s43, 1189888
    s_add_u32 m0, s45, 35840
    s_nop 0
    buffer_load_dwordx4 v6, s[36:39], s46 offen lds
    s_waitcnt vmcnt(16)
    s_barrier
    s_add_u32 s46, s44, 1572864
    s_add_u32 m0, s45, 81920
    s_nop 0
    buffer_load_dwordx4 v7, s[32:35], s46 offen lds
    s_add_u32 s46, s44, 1589248
    s_add_u32 m0, s45, 82944
    s_nop 0
    buffer_load_dwordx4 v7, s[32:35], s46 offen lds
    s_add_u32 s46, s44, 1605632
    s_add_u32 m0, s45, 83968
    s_nop 0
    buffer_load_dwordx4 v7, s[32:35], s46 offen lds
    s_add_u32 s46, s44, 1622016
    s_add_u32 m0, s45, 84992
    s_nop 0
    buffer_load_dwordx4 v7, s[32:35], s46 offen lds
    s_add_u32 s46, s43, 1376256
    s_add_u32 m0, s45, 65536
    s_nop 0
    buffer_load_dwordx4 v6, s[36:39], s46 offen lds
    s_add_u32 s46, s43, 1390592
    s_add_u32 m0, s45, 66560
    s_nop 0
    buffer_load_dwordx4 v6, s[36:39], s46 offen lds
    s_add_u32 s46, s43, 1404928
    s_add_u32 m0, s45, 67584
    s_nop 0
    buffer_load_dwordx4 v6, s[36:39], s46 offen lds
    s_add_u32 s46, s43, 1419264
    s_add_u32 m0, s45, 68608
    s_nop 0
    buffer_load_dwordx4 v6, s[36:39], s46 offen lds
    s_waitcnt vmcnt(16)
    s_barrier
    s_add_u32 s46, s44, 1835008
    s_add_u32 m0, s45, 114688
    s_nop 0
    buffer_load_dwordx4 v7, s[32:35], s46 offen lds
    s_add_u32 s46, s44, 1851392
    s_add_u32 m0, s45, 115712
    s_nop 0
    buffer_load_dwordx4 v7, s[32:35], s46 offen lds
    s_add_u32 s46, s44, 1867776
    s_add_u32 m0, s45, 116736
    s_nop 0
    buffer_load_dwordx4 v7, s[32:35], s46 offen lds
    s_add_u32 s46, s44, 1884160
    s_add_u32 m0, s45, 117760
    s_nop 0
    buffer_load_dwordx4 v7, s[32:35], s46 offen lds
    s_add_u32 s46, s43, 1605632
    s_add_u32 m0, s45, 98304
    s_nop 0
    buffer_load_dwordx4 v6, s[36:39], s46 offen lds
    s_add_u32 s46, s43, 1619968
    s_add_u32 m0, s45, 99328
    s_nop 0
    buffer_load_dwordx4 v6, s[36:39], s46 offen lds
    s_add_u32 s46, s43, 1634304
    s_add_u32 m0, s45, 100352
    s_nop 0
    buffer_load_dwordx4 v6, s[36:39], s46 offen lds
    s_add_u32 s46, s43, 1648640
    s_add_u32 m0, s45, 101376
    s_nop 0
    buffer_load_dwordx4 v6, s[36:39], s46 offen lds
    s_waitcnt vmcnt(16)
    s_barrier
    s_waitcnt vmcnt(8)
    s_barrier
    s_waitcnt vmcnt(0)
    s_barrier
    s_endpgm
gemm1b_kernel_stats:
    v_and_b32 v36, 31, v1
    v_lshl_add_u32 v36, v2, 5, v36
    v_lshlrev_b32 v37, 2, v36
    s_lshl_b32 s47, s41, 9
    s_add_u32 s47, s47, 20054016
    buffer_load_dword v30, v37, s[32:35], s47 offen
    v_add_u32 v31, 132096, v37
    v_xor_b32 v15, v2, v12
    v_lshl_add_u32 v18, v15, 6, v14
    v_add_u32 v18, 0x4000, v18
    v_add_u32 v22, 0x10000, v18
    v_mov_b32 v28, 0x3f803f80
    v_mov_b32 v32, 0
    v_mov_b32 v33, 0
    v_mov_b32 v34, 0
    v_mov_b32 v35, 0
    v_mov_b32 v36, 0
    v_mov_b32 v37, 0
    v_mov_b32 v38, 0
    v_mov_b32 v39, 0
    s_barrier
    ds_read_b64_tr_b16 v[64:65], v18 offset:0
    ds_read_b64_tr_b16 v[66:67], v18 offset:1024
    ds_read_b64_tr_b16 v[68:69], v18 offset:4096
    ds_read_b64_tr_b16 v[70:71], v18 offset:5120
    ds_read_b64_tr_b16 v[72:73], v18 offset:8192
    ds_read_b64_tr_b16 v[74:75], v18 offset:9216
    ds_read_b64_tr_b16 v[76:77], v18 offset:12288
    ds_read_b64_tr_b16 v[78:79], v18 offset:13312
    s_waitcnt lgkmcnt(6)
    v_lshlrev_b32 v80, 16, v64
    v_and_b32 v81, 0xffff0000, v64
    v_add_f32 v32, v32, v80
    v_add_f32 v33, v33, v81
    v_fmac_f32 v36, v80, v80
    v_fmac_f32 v37, v81, v81
    v_lshlrev_b32 v82, 16, v65
    v_and_b32 v83, 0xffff0000, v65
    v_add_f32 v34, v34, v82
    v_add_f32 v35, v35, v83
    v_fmac_f32 v38, v82, v82
    v_fmac_f32 v39, v83, v83
    v_lshlrev_b32 v80, 16, v66
    v_and_b32 v81, 0xffff0000, v66
    v_add_f32 v32, v32, v80
    v_add_f32 v33, v33, v81
    v_fmac_f32 v36, v80, v80
    v_fmac_f32 v37, v81, v81
    v_lshlrev_b32 v82, 16, v67
    v_and_b32 v83, 0xffff0000, v67
    v_add_f32 v34, v34, v82
    v_add_f32 v35, v35, v83
    v_fmac_f32 v38, v82, v82
    v_fmac_f32 v39, v83, v83
    s_waitcnt lgkmcnt(4)
    v_lshlrev_b32 v80, 16, v68
    v_and_b32 v81, 0xffff0000, v68
    v_add_f32 v32, v32, v80
    v_add_f32 v33, v33, v81
    v_fmac_f32 v36, v80, v80
    v_fmac_f32 v37, v81, v81
    v_lshlrev_b32 v82, 16, v69
    v_and_b32 v83, 0xffff0000, v69
    v_add_f32 v34, v34, v82
    v_add_f32 v35, v35, v83
    v_fmac_f32 v38, v82, v82
    v_fmac_f32 v39, v83, v83
    v_lshlrev_b32 v80, 16, v70
    v_and_b32 v81, 0xffff0000, v70
    v_add_f32 v32, v32, v80
    v_add_f32 v33, v33, v81
    v_fmac_f32 v36, v80, v80
    v_fmac_f32 v37, v81, v81
    v_lshlrev_b32 v82, 16, v71
    v_and_b32 v83, 0xffff0000, v71
    v_add_f32 v34, v34, v82
    v_add_f32 v35, v35, v83
    v_fmac_f32 v38, v82, v82
    v_fmac_f32 v39, v83, v83
    s_waitcnt lgkmcnt(2)
    v_lshlrev_b32 v80, 16, v72
    v_and_b32 v81, 0xffff0000, v72
    v_add_f32 v32, v32, v80
    v_add_f32 v33, v33, v81
    v_fmac_f32 v36, v80, v80
    v_fmac_f32 v37, v81, v81
    v_lshlrev_b32 v82, 16, v73
    v_and_b32 v83, 0xffff0000, v73
    v_add_f32 v34, v34, v82
    v_add_f32 v35, v35, v83
    v_fmac_f32 v38, v82, v82
    v_fmac_f32 v39, v83, v83
    v_lshlrev_b32 v80, 16, v74
    v_and_b32 v81, 0xffff0000, v74
    v_add_f32 v32, v32, v80
    v_add_f32 v33, v33, v81
    v_fmac_f32 v36, v80, v80
    v_fmac_f32 v37, v81, v81
    v_lshlrev_b32 v82, 16, v75
    v_and_b32 v83, 0xffff0000, v75
    v_add_f32 v34, v34, v82
    v_add_f32 v35, v35, v83
    v_fmac_f32 v38, v82, v82
    v_fmac_f32 v39, v83, v83
    s_waitcnt lgkmcnt(0)
    v_lshlrev_b32 v80, 16, v76
    v_and_b32 v81, 0xffff0000, v76
    v_add_f32 v32, v32, v80
    v_add_f32 v33, v33, v81
    v_fmac_f32 v36, v80, v80
    v_fmac_f32 v37, v81, v81
    v_lshlrev_b32 v82, 16, v77
    v_and_b32 v83, 0xffff0000, v77
    v_add_f32 v34, v34, v82
    v_add_f32 v35, v35, v83
    v_fmac_f32 v38, v82, v82
    v_fmac_f32 v39, v83, v83
    v_lshlrev_b32 v80, 16, v78
    v_and_b32 v81, 0xffff0000, v78
    v_add_f32 v32, v32, v80
    v_add_f32 v33, v33, v81
    v_fmac_f32 v36, v80, v80
    v_fmac_f32 v37, v81, v81
    v_lshlrev_b32 v82, 16, v79
    v_and_b32 v83, 0xffff0000, v79
    v_add_f32 v34, v34, v82
    v_add_f32 v35, v35, v83
    v_fmac_f32 v38, v82, v82
    v_fmac_f32 v39, v83, v83
    s_barrier
    ds_read_b64_tr_b16 v[64:65], v18 offset:32768
    ds_read_b64_tr_b16 v[66:67], v18 offset:33792
    ds_read_b64_tr_b16 v[68:69], v18 offset:36864
    ds_read_b64_tr_b16 v[70:71], v18 offset:37888
    ds_read_b64_tr_b16 v[72:73], v18 offset:40960
    ds_read_b64_tr_b16 v[74:75], v18 offset:41984
    ds_read_b64_tr_b16 v[76:77], v18 offset:45056
    ds_read_b64_tr_b16 v[78:79], v18 offset:46080
    s_waitcnt lgkmcnt(6)
    v_lshlrev_b32 v80, 16, v64
    v_and_b32 v81, 0xffff0000, v64
    v_add_f32 v32, v32, v80
    v_add_f32 v33, v33, v81
    v_fmac_f32 v36, v80, v80
    v_fmac_f32 v37, v81, v81
    v_lshlrev_b32 v82, 16, v65
    v_and_b32 v83, 0xffff0000, v65
    v_add_f32 v34, v34, v82
    v_add_f32 v35, v35, v83
    v_fmac_f32 v38, v82, v82
    v_fmac_f32 v39, v83, v83
    v_lshlrev_b32 v80, 16, v66
    v_and_b32 v81, 0xffff0000, v66
    v_add_f32 v32, v32, v80
    v_add_f32 v33, v33, v81
    v_fmac_f32 v36, v80, v80
    v_fmac_f32 v37, v81, v81
    v_lshlrev_b32 v82, 16, v67
    v_and_b32 v83, 0xffff0000, v67
    v_add_f32 v34, v34, v82
    v_add_f32 v35, v35, v83
    v_fmac_f32 v38, v82, v82
    v_fmac_f32 v39, v83, v83
    s_waitcnt lgkmcnt(4)
    v_lshlrev_b32 v80, 16, v68
    v_and_b32 v81, 0xffff0000, v68
    v_add_f32 v32, v32, v80
    v_add_f32 v33, v33, v81
    v_fmac_f32 v36, v80, v80
    v_fmac_f32 v37, v81, v81
    v_lshlrev_b32 v82, 16, v69
    v_and_b32 v83, 0xffff0000, v69
    v_add_f32 v34, v34, v82
    v_add_f32 v35, v35, v83
    v_fmac_f32 v38, v82, v82
    v_fmac_f32 v39, v83, v83
    v_lshlrev_b32 v80, 16, v70
    v_and_b32 v81, 0xffff0000, v70
    v_add_f32 v32, v32, v80
    v_add_f32 v33, v33, v81
    v_fmac_f32 v36, v80, v80
    v_fmac_f32 v37, v81, v81
    v_lshlrev_b32 v82, 16, v71
    v_and_b32 v83, 0xffff0000, v71
    v_add_f32 v34, v34, v82
    v_add_f32 v35, v35, v83
    v_fmac_f32 v38, v82, v82
    v_fmac_f32 v39, v83, v83
    s_waitcnt lgkmcnt(2)
    v_lshlrev_b32 v80, 16, v72
    v_and_b32 v81, 0xffff0000, v72
    v_add_f32 v32, v32, v80
    v_add_f32 v33, v33, v81
    v_fmac_f32 v36, v80, v80
    v_fmac_f32 v37, v81, v81
    v_lshlrev_b32 v82, 16, v73
    v_and_b32 v83, 0xffff0000, v73
    v_add_f32 v34, v34, v82
    v_add_f32 v35, v35, v83
    v_fmac_f32 v38, v82, v82
    v_fmac_f32 v39, v83, v83
    v_lshlrev_b32 v80, 16, v74
    v_and_b32 v81, 0xffff0000, v74
    v_add_f32 v32, v32, v80
    v_add_f32 v33, v33, v81
    v_fmac_f32 v36, v80, v80
    v_fmac_f32 v37, v81, v81
    v_lshlrev_b32 v82, 16, v75
    v_and_b32 v83, 0xffff0000, v75
    v_add_f32 v34, v34, v82
    v_add_f32 v35, v35, v83
    v_fmac_f32 v38, v82, v82
    v_fmac_f32 v39, v83, v83
    s_waitcnt lgkmcnt(0)
    v_lshlrev_b32 v80, 16, v76
    v_and_b32 v81, 0xffff0000, v76
    v_add_f32 v32, v32, v80
    v_add_f32 v33, v33, v81
    v_fmac_f32 v36, v80, v80
    v_fmac_f32 v37, v81, v81
    v_lshlrev_b32 v82, 16, v77
    v_and_b32 v83, 0xffff0000, v77
    v_add_f32 v34, v34, v82
    v_add_f32 v35, v35, v83
    v_fmac_f32 v38, v82, v82
    v_fmac_f32 v39, v83, v83
    v_lshlrev_b32 v80, 16, v78
    v_and_b32 v81, 0xffff0000, v78
    v_add_f32 v32, v32, v80
    v_add_f32 v33, v33, v81
    v_fmac_f32 v36, v80, v80
    v_fmac_f32 v37, v81, v81
    v_lshlrev_b32 v82, 16, v79
    v_and_b32 v83, 0xffff0000, v79
    v_add_f32 v34, v34, v82
    v_add_f32 v35, v35, v83
    v_fmac_f32 v38, v82, v82
    v_fmac_f32 v39, v83, v83
    s_barrier
    ds_read_b64_tr_b16 v[64:65], v22 offset:0
    ds_read_b64_tr_b16 v[66:67], v22 offset:1024
    ds_read_b64_tr_b16 v[68:69], v22 offset:4096
    ds_read_b64_tr_b16 v[70:71], v22 offset:5120
    ds_read_b64_tr_b16 v[72:73], v22 offset:8192
    ds_read_b64_tr_b16 v[74:75], v22 offset:9216
    ds_read_b64_tr_b16 v[76:77], v22 offset:12288
    ds_read_b64_tr_b16 v[78:79], v22 offset:13312
    s_waitcnt lgkmcnt(6)
    v_lshlrev_b32 v80, 16, v64
    v_and_b32 v81, 0xffff0000, v64
    v_add_f32 v32, v32, v80
    v_add_f32 v33, v33, v81
    v_fmac_f32 v36, v80, v80
    v_fmac_f32 v37, v81, v81
    v_lshlrev_b32 v82, 16, v65
    v_and_b32 v83, 0xffff0000, v65
    v_add_f32 v34, v34, v82
    v_add_f32 v35, v35, v83
    v_fmac_f32 v38, v82, v82
    v_fmac_f32 v39, v83, v83
    v_lshlrev_b32 v80, 16, v66
    v_and_b32 v81, 0xffff0000, v66
    v_add_f32 v32, v32, v80
    v_add_f32 v33, v33, v81
    v_fmac_f32 v36, v80, v80
    v_fmac_f32 v37, v81, v81
    v_lshlrev_b32 v82, 16, v67
    v_and_b32 v83, 0xffff0000, v67
    v_add_f32 v34, v34, v82
    v_add_f32 v35, v35, v83
    v_fmac_f32 v38, v82, v82
    v_fmac_f32 v39, v83, v83
    s_waitcnt lgkmcnt(4)
    v_lshlrev_b32 v80, 16, v68
    v_and_b32 v81, 0xffff0000, v68
    v_add_f32 v32, v32, v80
    v_add_f32 v33, v33, v81
    v_fmac_f32 v36, v80, v80
    v_fmac_f32 v37, v81, v81
    v_lshlrev_b32 v82, 16, v69
    v_and_b32 v83, 0xffff0000, v69
    v_add_f32 v34, v34, v82
    v_add_f32 v35, v35, v83
    v_fmac_f32 v38, v82, v82
    v_fmac_f32 v39, v83, v83
    v_lshlrev_b32 v80, 16, v70
    v_and_b32 v81, 0xffff0000, v70
    v_add_f32 v32, v32, v80
    v_add_f32 v33, v33, v81
    v_fmac_f32 v36, v80, v80
    v_fmac_f32 v37, v81, v81
    v_lshlrev_b32 v82, 16, v71
    v_and_b32 v83, 0xffff0000, v71
    v_add_f32 v34, v34, v82
    v_add_f32 v35, v35, v83
    v_fmac_f32 v38, v82, v82
    v_fmac_f32 v39, v83, v83
    s_waitcnt lgkmcnt(2)
    v_lshlrev_b32 v80, 16, v72
    v_and_b32 v81, 0xffff0000, v72
    v_add_f32 v32, v32, v80
    v_add_f32 v33, v33, v81
    v_fmac_f32 v36, v80, v80
    v_fmac_f32 v37, v81, v81
    v_lshlrev_b32 v82, 16, v73
    v_and_b32 v83, 0xffff0000, v73
    v_add_f32 v34, v34, v82
    v_add_f32 v35, v35, v83
    v_fmac_f32 v38, v82, v82
    v_fmac_f32 v39, v83, v83
    v_lshlrev_b32 v80, 16, v74
    v_and_b32 v81, 0xffff0000, v74
    v_add_f32 v32, v32, v80
    v_add_f32 v33, v33, v81
    v_fmac_f32 v36, v80, v80
    v_fmac_f32 v37, v81, v81
    v_lshlrev_b32 v82, 16, v75
    v_and_b32 v83, 0xffff0000, v75
    v_add_f32 v34, v34, v82
    v_add_f32 v35, v35, v83
    v_fmac_f32 v38, v82, v82
    v_fmac_f32 v39, v83, v83
    s_waitcnt lgkmcnt(0)
    v_lshlrev_b32 v80, 16, v76
    v_and_b32 v81, 0xffff0000, v76
    v_add_f32 v32, v32, v80
    v_add_f32 v33, v33, v81
    v_fmac_f32 v36, v80, v80
    v_fmac_f32 v37, v81, v81
    v_lshlrev_b32 v82, 16, v77
    v_and_b32 v83, 0xffff0000, v77
    v_add_f32 v34, v34, v82
    v_add_f32 v35, v35, v83
    v_fmac_f32 v38, v82, v82
    v_fmac_f32 v39, v83, v83
    v_lshlrev_b32 v80, 16, v78
    v_and_b32 v81, 0xffff0000, v78
    v_add_f32 v32, v32, v80
    v_add_f32 v33, v33, v81
    v_fmac_f32 v36, v80, v80
    v_fmac_f32 v37, v81, v81
    v_lshlrev_b32 v82, 16, v79
    v_and_b32 v83, 0xffff0000, v79
    v_add_f32 v34, v34, v82
    v_add_f32 v35, v35, v83
    v_fmac_f32 v38, v82, v82
    v_fmac_f32 v39, v83, v83
    s_barrier
    ds_read_b64_tr_b16 v[64:65], v22 offset:32768
    ds_read_b64_tr_b16 v[66:67], v22 offset:33792
    ds_read_b64_tr_b16 v[68:69], v22 offset:36864
    ds_read_b64_tr_b16 v[70:71], v22 offset:37888
    ds_read_b64_tr_b16 v[72:73], v22 offset:40960
    ds_read_b64_tr_b16 v[74:75], v22 offset:41984
    ds_read_b64_tr_b16 v[76:77], v22 offset:45056
    ds_read_b64_tr_b16 v[78:79], v22 offset:46080
    s_waitcnt lgkmcnt(6)
    v_lshlrev_b32 v80, 16, v64
    v_and_b32 v81, 0xffff0000, v64
    v_add_f32 v32, v32, v80
    v_add_f32 v33, v33, v81
    v_fmac_f32 v36, v80, v80
    v_fmac_f32 v37, v81, v81
    v_lshlrev_b32 v82, 16, v65
    v_and_b32 v83, 0xffff0000, v65
    v_add_f32 v34, v34, v82
    v_add_f32 v35, v35, v83
    v_fmac_f32 v38, v82, v82
    v_fmac_f32 v39, v83, v83
    v_lshlrev_b32 v80, 16, v66
    v_and_b32 v81, 0xffff0000, v66
    v_add_f32 v32, v32, v80
    v_add_f32 v33, v33, v81
    v_fmac_f32 v36, v80, v80
    v_fmac_f32 v37, v81, v81
    v_lshlrev_b32 v82, 16, v67
    v_and_b32 v83, 0xffff0000, v67
    v_add_f32 v34, v34, v82
    v_add_f32 v35, v35, v83
    v_fmac_f32 v38, v82, v82
    v_fmac_f32 v39, v83, v83
    s_waitcnt lgkmcnt(4)
    v_lshlrev_b32 v80, 16, v68
    v_and_b32 v81, 0xffff0000, v68
    v_add_f32 v32, v32, v80
    v_add_f32 v33, v33, v81
    v_fmac_f32 v36, v80, v80
    v_fmac_f32 v37, v81, v81
    v_lshlrev_b32 v82, 16, v69
    v_and_b32 v83, 0xffff0000, v69
    v_add_f32 v34, v34, v82
    v_add_f32 v35, v35, v83
    v_fmac_f32 v38, v82, v82
    v_fmac_f32 v39, v83, v83
    v_lshlrev_b32 v80, 16, v70
    v_and_b32 v81, 0xffff0000, v70
    v_add_f32 v32, v32, v80
    v_add_f32 v33, v33, v81
    v_fmac_f32 v36, v80, v80
    v_fmac_f32 v37, v81, v81
    v_lshlrev_b32 v82, 16, v71
    v_and_b32 v83, 0xffff0000, v71
    v_add_f32 v34, v34, v82
    v_add_f32 v35, v35, v83
    v_fmac_f32 v38, v82, v82
    v_fmac_f32 v39, v83, v83
    s_waitcnt lgkmcnt(2)
    v_lshlrev_b32 v80, 16, v72
    v_and_b32 v81, 0xffff0000, v72
    v_add_f32 v32, v32, v80
    v_add_f32 v33, v33, v81
    v_fmac_f32 v36, v80, v80
    v_fmac_f32 v37, v81, v81
    v_lshlrev_b32 v82, 16, v73
    v_and_b32 v83, 0xffff0000, v73
    v_add_f32 v34, v34, v82
    v_add_f32 v35, v35, v83
    v_fmac_f32 v38, v82, v82
    v_fmac_f32 v39, v83, v83
    v_lshlrev_b32 v80, 16, v74
    v_and_b32 v81, 0xffff0000, v74
    v_add_f32 v32, v32, v80
    v_add_f32 v33, v33, v81
    v_fmac_f32 v36, v80, v80
    v_fmac_f32 v37, v81, v81
    v_lshlrev_b32 v82, 16, v75
    v_and_b32 v83, 0xffff0000, v75
    v_add_f32 v34, v34, v82
    v_add_f32 v35, v35, v83
    v_fmac_f32 v38, v82, v82
    v_fmac_f32 v39, v83, v83
    s_waitcnt lgkmcnt(0)
    v_lshlrev_b32 v80, 16, v76
    v_and_b32 v81, 0xffff0000, v76
    v_add_f32 v32, v32, v80
    v_add_f32 v33, v33, v81
    v_fmac_f32 v36, v80, v80
    v_fmac_f32 v37, v81, v81
    v_lshlrev_b32 v82, 16, v77
    v_and_b32 v83, 0xffff0000, v77
    v_add_f32 v34, v34, v82
    v_add_f32 v35, v35, v83
    v_fmac_f32 v38, v82, v82
    v_fmac_f32 v39, v83, v83
    v_lshlrev_b32 v80, 16, v78
    v_and_b32 v81, 0xffff0000, v78
    v_add_f32 v32, v32, v80
    v_add_f32 v33, v33, v81
    v_fmac_f32 v36, v80, v80
    v_fmac_f32 v37, v81, v81
    v_lshlrev_b32 v82, 16, v79
    v_and_b32 v83, 0xffff0000, v79
    v_add_f32 v34, v34, v82
    v_add_f32 v35, v35, v83
    v_fmac_f32 v38, v82, v82
    v_fmac_f32 v39, v83, v83
    s_barrier
    ds_read_b64_tr_b16 v[64:65], v18 offset:0
    ds_read_b64_tr_b16 v[66:67], v18 offset:1024
    ds_read_b64_tr_b16 v[68:69], v18 offset:4096
    ds_read_b64_tr_b16 v[70:71], v18 offset:5120
    ds_read_b64_tr_b16 v[72:73], v18 offset:8192
    ds_read_b64_tr_b16 v[74:75], v18 offset:9216
    ds_read_b64_tr_b16 v[76:77], v18 offset:12288
    ds_read_b64_tr_b16 v[78:79], v18 offset:13312
    s_waitcnt lgkmcnt(6)
    v_lshlrev_b32 v80, 16, v64
    v_and_b32 v81, 0xffff0000, v64
    v_add_f32 v32, v32, v80
    v_add_f32 v33, v33, v81
    v_fmac_f32 v36, v80, v80
    v_fmac_f32 v37, v81, v81
    v_lshlrev_b32 v82, 16, v65
    v_and_b32 v83, 0xffff0000, v65
    v_add_f32 v34, v34, v82
    v_add_f32 v35, v35, v83
    v_fmac_f32 v38, v82, v82
    v_fmac_f32 v39, v83, v83
    v_lshlrev_b32 v80, 16, v66
    v_and_b32 v81, 0xffff0000, v66
    v_add_f32 v32, v32, v80
    v_add_f32 v33, v33, v81
    v_fmac_f32 v36, v80, v80
    v_fmac_f32 v37, v81, v81
    v_lshlrev_b32 v82, 16, v67
    v_and_b32 v83, 0xffff0000, v67
    v_add_f32 v34, v34, v82
    v_add_f32 v35, v35, v83
    v_fmac_f32 v38, v82, v82
    v_fmac_f32 v39, v83, v83
    s_waitcnt lgkmcnt(4)
    v_lshlrev_b32 v80, 16, v68
    v_and_b32 v81, 0xffff0000, v68
    v_add_f32 v32, v32, v80
    v_add_f32 v33, v33, v81
    v_fmac_f32 v36, v80, v80
    v_fmac_f32 v37, v81, v81
    v_lshlrev_b32 v82, 16, v69
    v_and_b32 v83, 0xffff0000, v69
    v_add_f32 v34, v34, v82
    v_add_f32 v35, v35, v83
    v_fmac_f32 v38, v82, v82
    v_fmac_f32 v39, v83, v83
    v_lshlrev_b32 v80, 16, v70
    v_and_b32 v81, 0xffff0000, v70
    v_add_f32 v32, v32, v80
    v_add_f32 v33, v33, v81
    v_fmac_f32 v36, v80, v80
    v_fmac_f32 v37, v81, v81
    v_lshlrev_b32 v82, 16, v71
    v_and_b32 v83, 0xffff0000, v71
    v_add_f32 v34, v34, v82
    v_add_f32 v35, v35, v83
    v_fmac_f32 v38, v82, v82
    v_fmac_f32 v39, v83, v83
    s_waitcnt lgkmcnt(2)
    v_lshlrev_b32 v80, 16, v72
    v_and_b32 v81, 0xffff0000, v72
    v_add_f32 v32, v32, v80
    v_add_f32 v33, v33, v81
    v_fmac_f32 v36, v80, v80
    v_fmac_f32 v37, v81, v81
    v_lshlrev_b32 v82, 16, v73
    v_and_b32 v83, 0xffff0000, v73
    v_add_f32 v34, v34, v82
    v_add_f32 v35, v35, v83
    v_fmac_f32 v38, v82, v82
    v_fmac_f32 v39, v83, v83
    v_lshlrev_b32 v80, 16, v74
    v_and_b32 v81, 0xffff0000, v74
    v_add_f32 v32, v32, v80
    v_add_f32 v33, v33, v81
    v_fmac_f32 v36, v80, v80
    v_fmac_f32 v37, v81, v81
    v_lshlrev_b32 v82, 16, v75
    v_and_b32 v83, 0xffff0000, v75
    v_add_f32 v34, v34, v82
    v_add_f32 v35, v35, v83
    v_fmac_f32 v38, v82, v82
    v_fmac_f32 v39, v83, v83
    s_waitcnt lgkmcnt(0)
    v_lshlrev_b32 v80, 16, v76
    v_and_b32 v81, 0xffff0000, v76
    v_add_f32 v32, v32, v80
    v_add_f32 v33, v33, v81
    v_fmac_f32 v36, v80, v80
    v_fmac_f32 v37, v81, v81
    v_lshlrev_b32 v82, 16, v77
    v_and_b32 v83, 0xffff0000, v77
    v_add_f32 v34, v34, v82
    v_add_f32 v35, v35, v83
    v_fmac_f32 v38, v82, v82
    v_fmac_f32 v39, v83, v83
    v_lshlrev_b32 v80, 16, v78
    v_and_b32 v81, 0xffff0000, v78
    v_add_f32 v32, v32, v80
    v_add_f32 v33, v33, v81
    v_fmac_f32 v36, v80, v80
    v_fmac_f32 v37, v81, v81
    v_lshlrev_b32 v82, 16, v79
    v_and_b32 v83, 0xffff0000, v79
    v_add_f32 v34, v34, v82
    v_add_f32 v35, v35, v83
    v_fmac_f32 v38, v82, v82
    v_fmac_f32 v39, v83, v83
    s_barrier
    ds_read_b64_tr_b16 v[64:65], v18 offset:32768
    ds_read_b64_tr_b16 v[66:67], v18 offset:33792
    ds_read_b64_tr_b16 v[68:69], v18 offset:36864
    ds_read_b64_tr_b16 v[70:71], v18 offset:37888
    ds_read_b64_tr_b16 v[72:73], v18 offset:40960
    ds_read_b64_tr_b16 v[74:75], v18 offset:41984
    ds_read_b64_tr_b16 v[76:77], v18 offset:45056
    ds_read_b64_tr_b16 v[78:79], v18 offset:46080
    s_waitcnt lgkmcnt(6)
    v_lshlrev_b32 v80, 16, v64
    v_and_b32 v81, 0xffff0000, v64
    v_add_f32 v32, v32, v80
    v_add_f32 v33, v33, v81
    v_fmac_f32 v36, v80, v80
    v_fmac_f32 v37, v81, v81
    v_lshlrev_b32 v82, 16, v65
    v_and_b32 v83, 0xffff0000, v65
    v_add_f32 v34, v34, v82
    v_add_f32 v35, v35, v83
    v_fmac_f32 v38, v82, v82
    v_fmac_f32 v39, v83, v83
    v_lshlrev_b32 v80, 16, v66
    v_and_b32 v81, 0xffff0000, v66
    v_add_f32 v32, v32, v80
    v_add_f32 v33, v33, v81
    v_fmac_f32 v36, v80, v80
    v_fmac_f32 v37, v81, v81
    v_lshlrev_b32 v82, 16, v67
    v_and_b32 v83, 0xffff0000, v67
    v_add_f32 v34, v34, v82
    v_add_f32 v35, v35, v83
    v_fmac_f32 v38, v82, v82
    v_fmac_f32 v39, v83, v83
    s_waitcnt lgkmcnt(4)
    v_lshlrev_b32 v80, 16, v68
    v_and_b32 v81, 0xffff0000, v68
    v_add_f32 v32, v32, v80
    v_add_f32 v33, v33, v81
    v_fmac_f32 v36, v80, v80
    v_fmac_f32 v37, v81, v81
    v_lshlrev_b32 v82, 16, v69
    v_and_b32 v83, 0xffff0000, v69
    v_add_f32 v34, v34, v82
    v_add_f32 v35, v35, v83
    v_fmac_f32 v38, v82, v82
    v_fmac_f32 v39, v83, v83
    v_lshlrev_b32 v80, 16, v70
    v_and_b32 v81, 0xffff0000, v70
    v_add_f32 v32, v32, v80
    v_add_f32 v33, v33, v81
    v_fmac_f32 v36, v80, v80
    v_fmac_f32 v37, v81, v81
    v_lshlrev_b32 v82, 16, v71
    v_and_b32 v83, 0xffff0000, v71
    v_add_f32 v34, v34, v82
    v_add_f32 v35, v35, v83
    v_fmac_f32 v38, v82, v82
    v_fmac_f32 v39, v83, v83
    s_waitcnt lgkmcnt(2)
    v_lshlrev_b32 v80, 16, v72
    v_and_b32 v81, 0xffff0000, v72
    v_add_f32 v32, v32, v80
    v_add_f32 v33, v33, v81
    v_fmac_f32 v36, v80, v80
    v_fmac_f32 v37, v81, v81
    v_lshlrev_b32 v82, 16, v73
    v_and_b32 v83, 0xffff0000, v73
    v_add_f32 v34, v34, v82
    v_add_f32 v35, v35, v83
    v_fmac_f32 v38, v82, v82
    v_fmac_f32 v39, v83, v83
    v_lshlrev_b32 v80, 16, v74
    v_and_b32 v81, 0xffff0000, v74
    v_add_f32 v32, v32, v80
    v_add_f32 v33, v33, v81
    v_fmac_f32 v36, v80, v80
    v_fmac_f32 v37, v81, v81
    v_lshlrev_b32 v82, 16, v75
    v_and_b32 v83, 0xffff0000, v75
    v_add_f32 v34, v34, v82
    v_add_f32 v35, v35, v83
    v_fmac_f32 v38, v82, v82
    v_fmac_f32 v39, v83, v83
    s_waitcnt lgkmcnt(0)
    v_lshlrev_b32 v80, 16, v76
    v_and_b32 v81, 0xffff0000, v76
    v_add_f32 v32, v32, v80
    v_add_f32 v33, v33, v81
    v_fmac_f32 v36, v80, v80
    v_fmac_f32 v37, v81, v81
    v_lshlrev_b32 v82, 16, v77
    v_and_b32 v83, 0xffff0000, v77
    v_add_f32 v34, v34, v82
    v_add_f32 v35, v35, v83
    v_fmac_f32 v38, v82, v82
    v_fmac_f32 v39, v83, v83
    v_lshlrev_b32 v80, 16, v78
    v_and_b32 v81, 0xffff0000, v78
    v_add_f32 v32, v32, v80
    v_add_f32 v33, v33, v81
    v_fmac_f32 v36, v80, v80
    v_fmac_f32 v37, v81, v81
    v_lshlrev_b32 v82, 16, v79
    v_and_b32 v83, 0xffff0000, v79
    v_add_f32 v34, v34, v82
    v_add_f32 v35, v35, v83
    v_fmac_f32 v38, v82, v82
    v_fmac_f32 v39, v83, v83
    s_barrier
    ds_read_b64_tr_b16 v[64:65], v22 offset:0
    ds_read_b64_tr_b16 v[66:67], v22 offset:1024
    ds_read_b64_tr_b16 v[68:69], v22 offset:4096
    ds_read_b64_tr_b16 v[70:71], v22 offset:5120
    ds_read_b64_tr_b16 v[72:73], v22 offset:8192
    ds_read_b64_tr_b16 v[74:75], v22 offset:9216
    ds_read_b64_tr_b16 v[76:77], v22 offset:12288
    ds_read_b64_tr_b16 v[78:79], v22 offset:13312
    s_waitcnt lgkmcnt(6)
    v_lshlrev_b32 v80, 16, v64
    v_and_b32 v81, 0xffff0000, v64
    v_add_f32 v32, v32, v80
    v_add_f32 v33, v33, v81
    v_fmac_f32 v36, v80, v80
    v_fmac_f32 v37, v81, v81
    v_lshlrev_b32 v82, 16, v65
    v_and_b32 v83, 0xffff0000, v65
    v_add_f32 v34, v34, v82
    v_add_f32 v35, v35, v83
    v_fmac_f32 v38, v82, v82
    v_fmac_f32 v39, v83, v83
    v_lshlrev_b32 v80, 16, v66
    v_and_b32 v81, 0xffff0000, v66
    v_add_f32 v32, v32, v80
    v_add_f32 v33, v33, v81
    v_fmac_f32 v36, v80, v80
    v_fmac_f32 v37, v81, v81
    v_lshlrev_b32 v82, 16, v67
    v_and_b32 v83, 0xffff0000, v67
    v_add_f32 v34, v34, v82
    v_add_f32 v35, v35, v83
    v_fmac_f32 v38, v82, v82
    v_fmac_f32 v39, v83, v83
    s_waitcnt lgkmcnt(4)
    v_lshlrev_b32 v80, 16, v68
    v_and_b32 v81, 0xffff0000, v68
    v_add_f32 v32, v32, v80
    v_add_f32 v33, v33, v81
    v_fmac_f32 v36, v80, v80
    v_fmac_f32 v37, v81, v81
    v_lshlrev_b32 v82, 16, v69
    v_and_b32 v83, 0xffff0000, v69
    v_add_f32 v34, v34, v82
    v_add_f32 v35, v35, v83
    v_fmac_f32 v38, v82, v82
    v_fmac_f32 v39, v83, v83
    v_lshlrev_b32 v80, 16, v70
    v_and_b32 v81, 0xffff0000, v70
    v_add_f32 v32, v32, v80
    v_add_f32 v33, v33, v81
    v_fmac_f32 v36, v80, v80
    v_fmac_f32 v37, v81, v81
    v_lshlrev_b32 v82, 16, v71
    v_and_b32 v83, 0xffff0000, v71
    v_add_f32 v34, v34, v82
    v_add_f32 v35, v35, v83
    v_fmac_f32 v38, v82, v82
    v_fmac_f32 v39, v83, v83
    s_waitcnt lgkmcnt(2)
    v_lshlrev_b32 v80, 16, v72
    v_and_b32 v81, 0xffff0000, v72
    v_add_f32 v32, v32, v80
    v_add_f32 v33, v33, v81
    v_fmac_f32 v36, v80, v80
    v_fmac_f32 v37, v81, v81
    v_lshlrev_b32 v82, 16, v73
    v_and_b32 v83, 0xffff0000, v73
    v_add_f32 v34, v34, v82
    v_add_f32 v35, v35, v83
    v_fmac_f32 v38, v82, v82
    v_fmac_f32 v39, v83, v83
    v_lshlrev_b32 v80, 16, v74
    v_and_b32 v81, 0xffff0000, v74
    v_add_f32 v32, v32, v80
    v_add_f32 v33, v33, v81
    v_fmac_f32 v36, v80, v80
    v_fmac_f32 v37, v81, v81
    v_lshlrev_b32 v82, 16, v75
    v_and_b32 v83, 0xffff0000, v75
    v_add_f32 v34, v34, v82
    v_add_f32 v35, v35, v83
    v_fmac_f32 v38, v82, v82
    v_fmac_f32 v39, v83, v83
    s_waitcnt lgkmcnt(0)
    v_lshlrev_b32 v80, 16, v76
    v_and_b32 v81, 0xffff0000, v76
    v_add_f32 v32, v32, v80
    v_add_f32 v33, v33, v81
    v_fmac_f32 v36, v80, v80
    v_fmac_f32 v37, v81, v81
    v_lshlrev_b32 v82, 16, v77
    v_and_b32 v83, 0xffff0000, v77
    v_add_f32 v34, v34, v82
    v_add_f32 v35, v35, v83
    v_fmac_f32 v38, v82, v82
    v_fmac_f32 v39, v83, v83
    v_lshlrev_b32 v80, 16, v78
    v_and_b32 v81, 0xffff0000, v78
    v_add_f32 v32, v32, v80
    v_add_f32 v33, v33, v81
    v_fmac_f32 v36, v80, v80
    v_fmac_f32 v37, v81, v81
    v_lshlrev_b32 v82, 16, v79
    v_and_b32 v83, 0xffff0000, v79
    v_add_f32 v34, v34, v82
    v_add_f32 v35, v35, v83
    v_fmac_f32 v38, v82, v82
    v_fmac_f32 v39, v83, v83
    s_barrier
    ds_read_b64_tr_b16 v[64:65], v22 offset:32768
    ds_read_b64_tr_b16 v[66:67], v22 offset:33792
    ds_read_b64_tr_b16 v[68:69], v22 offset:36864
    ds_read_b64_tr_b16 v[70:71], v22 offset:37888
    ds_read_b64_tr_b16 v[72:73], v22 offset:40960
    ds_read_b64_tr_b16 v[74:75], v22 offset:41984
    ds_read_b64_tr_b16 v[76:77], v22 offset:45056
    ds_read_b64_tr_b16 v[78:79], v22 offset:46080
    s_waitcnt lgkmcnt(6)
    v_lshlrev_b32 v80, 16, v64
    v_and_b32 v81, 0xffff0000, v64
    v_add_f32 v32, v32, v80
    v_add_f32 v33, v33, v81
    v_fmac_f32 v36, v80, v80
    v_fmac_f32 v37, v81, v81
    v_lshlrev_b32 v82, 16, v65
    v_and_b32 v83, 0xffff0000, v65
    v_add_f32 v34, v34, v82
    v_add_f32 v35, v35, v83
    v_fmac_f32 v38, v82, v82
    v_fmac_f32 v39, v83, v83
    v_lshlrev_b32 v80, 16, v66
    v_and_b32 v81, 0xffff0000, v66
    v_add_f32 v32, v32, v80
    v_add_f32 v33, v33, v81
    v_fmac_f32 v36, v80, v80
    v_fmac_f32 v37, v81, v81
    v_lshlrev_b32 v82, 16, v67
    v_and_b32 v83, 0xffff0000, v67
    v_add_f32 v34, v34, v82
    v_add_f32 v35, v35, v83
    v_fmac_f32 v38, v82, v82
    v_fmac_f32 v39, v83, v83
    s_waitcnt lgkmcnt(4)
    v_lshlrev_b32 v80, 16, v68
    v_and_b32 v81, 0xffff0000, v68
    v_add_f32 v32, v32, v80
    v_add_f32 v33, v33, v81
    v_fmac_f32 v36, v80, v80
    v_fmac_f32 v37, v81, v81
    v_lshlrev_b32 v82, 16, v69
    v_and_b32 v83, 0xffff0000, v69
    v_add_f32 v34, v34, v82
    v_add_f32 v35, v35, v83
    v_fmac_f32 v38, v82, v82
    v_fmac_f32 v39, v83, v83
    v_lshlrev_b32 v80, 16, v70
    v_and_b32 v81, 0xffff0000, v70
    v_add_f32 v32, v32, v80
    v_add_f32 v33, v33, v81
    v_fmac_f32 v36, v80, v80
    v_fmac_f32 v37, v81, v81
    v_lshlrev_b32 v82, 16, v71
    v_and_b32 v83, 0xffff0000, v71
    v_add_f32 v34, v34, v82
    v_add_f32 v35, v35, v83
    v_fmac_f32 v38, v82, v82
    v_fmac_f32 v39, v83, v83
    s_waitcnt lgkmcnt(2)
    v_lshlrev_b32 v80, 16, v72
    v_and_b32 v81, 0xffff0000, v72
    v_add_f32 v32, v32, v80
    v_add_f32 v33, v33, v81
    v_fmac_f32 v36, v80, v80
    v_fmac_f32 v37, v81, v81
    v_lshlrev_b32 v82, 16, v73
    v_and_b32 v83, 0xffff0000, v73
    v_add_f32 v34, v34, v82
    v_add_f32 v35, v35, v83
    v_fmac_f32 v38, v82, v82
    v_fmac_f32 v39, v83, v83
    v_lshlrev_b32 v80, 16, v74
    v_and_b32 v81, 0xffff0000, v74
    v_add_f32 v32, v32, v80
    v_add_f32 v33, v33, v81
    v_fmac_f32 v36, v80, v80
    v_fmac_f32 v37, v81, v81
    v_lshlrev_b32 v82, 16, v75
    v_and_b32 v83, 0xffff0000, v75
    v_add_f32 v34, v34, v82
    v_add_f32 v35, v35, v83
    v_fmac_f32 v38, v82, v82
    v_fmac_f32 v39, v83, v83
    s_waitcnt lgkmcnt(0)
    v_lshlrev_b32 v80, 16, v76
    v_and_b32 v81, 0xffff0000, v76
    v_add_f32 v32, v32, v80
    v_add_f32 v33, v33, v81
    v_fmac_f32 v36, v80, v80
    v_fmac_f32 v37, v81, v81
    v_lshlrev_b32 v82, 16, v77
    v_and_b32 v83, 0xffff0000, v77
    v_add_f32 v34, v34, v82
    v_add_f32 v35, v35, v83
    v_fmac_f32 v38, v82, v82
    v_fmac_f32 v39, v83, v83
    v_lshlrev_b32 v80, 16, v78
    v_and_b32 v81, 0xffff0000, v78
    v_add_f32 v32, v32, v80
    v_add_f32 v33, v33, v81
    v_fmac_f32 v36, v80, v80
    v_fmac_f32 v37, v81, v81
    v_lshlrev_b32 v82, 16, v79
    v_and_b32 v83, 0xffff0000, v79
    v_add_f32 v34, v34, v82
    v_add_f32 v35, v35, v83
    v_fmac_f32 v38, v82, v82
    v_fmac_f32 v39, v83, v83
    s_nop 3
    v_add_f32 v32, v32, v33
    v_add_f32 v34, v34, v35
    v_add_f32 v36, v36, v37
    v_add_f32 v38, v38, v39
    v_add_f32 v24, v32, v34
    v_add_f32 v26, v36, v38
    v_mov_b32 v32, v24
    v_mov_b32 v33, v26
    s_nop 1
    v_permlane32_swap_b32 v32, v24
    v_permlane32_swap_b32 v33, v26
    s_nop 1
    v_add_f32 v24, v24, v32
    v_add_f32 v26, v26, v33
    v_mul_f32 v24, 0x3b000000, v24
    v_mul_f32 v26, 0x3b000000, v26
    v_fma_f32 v26, -v24, v24, v26
    v_max_f32 v26, 0, v26
    v_and_b32 v36, 31, v1
    v_lshl_add_u32 v36, v2, 5, v36
    v_cvt_pk_bf16_f32 v39, v24, v26
    v_lshlrev_b32 v40, 16, v39
    v_and_b32 v42, 0xffff0000, v39
    v_add_f32 v42, 0x3727c5ac, v42
    v_cvt_pk_bf16_f32 v39, v42, v42
    v_lshlrev_b32 v42, 16, v39
    v_and_b32 v43, 0xffff0000, v39
    v_sqrt_f32 v42, v42
    s_nop 0
    v_cvt_pk_bf16_f32 v39, v42, v42
    v_lshlrev_b32 v42, 16, v39
    v_and_b32 v43, 0xffff0000, v39
    v_rcp_f32 v41, v42
    v_lshlrev_b32 v37, 3, v36
    v_add_u32 v37, 131072, v37
    ds_write_b64 v37, v[40:41]
    s_waitcnt vmcnt(0)
    ds_write_b32 v31, v30
    s_waitcnt lgkmcnt(0)
    s_barrier
    s_endpgm
gemm1b_kernel_compute:
    v_and_b32 v8, 1, v2
    v_lshrrev_b32 v9, 1, v2
    v_lshrrev_b32 v10, 5, v1
    v_lshl_add_u32 v15, v8, 1, 0
    v_xor_b32 v15, v15, v12
    v_lshl_add_u32 v16, v15, 6, v14
    v_add_u32 v20, 0x10000, v16
    v_lshl_add_u32 v15, v9, 1, 0
    v_xor_b32 v15, v15, v12
    v_lshl_add_u32 v18, v15, 6, v14
    v_add_u32 v18, 0x4000, v18
    v_add_u32 v22, 0x10000, v18
    v_lshl_add_u32 v15, v8, 1, 1
    v_xor_b32 v15, v15, v12
    v_lshl_add_u32 v17, v15, 6, v14
    v_add_u32 v21, 0x10000, v17
    v_lshl_add_u32 v15, v9, 1, 1
    v_xor_b32 v15, v15, v12
    v_lshl_add_u32 v19, v15, 6, v14
    v_add_u32 v19, 0x4000, v19
    v_add_u32 v23, 0x10000, v19
    v_mov_b32 v32, 0
    v_mov_b32 v33, 0
    v_mov_b32 v34, 0
    v_mov_b32 v35, 0
    v_mov_b32 v36, 0
    v_mov_b32 v37, 0
    v_mov_b32 v38, 0
    v_mov_b32 v39, 0
    v_mov_b32 v40, 0
    v_mov_b32 v41, 0
    v_mov_b32 v42, 0
    v_mov_b32 v43, 0
    v_mov_b32 v44, 0
    v_mov_b32 v45, 0
    v_mov_b32 v46, 0
    v_mov_b32 v47, 0
    v_mov_b32 v48, 0
    v_mov_b32 v49, 0
    v_mov_b32 v50, 0
    v_mov_b32 v51, 0
    v_mov_b32 v52, 0
    v_mov_b32 v53, 0
    v_mov_b32 v54, 0
    v_mov_b32 v55, 0
    v_mov_b32 v56, 0
    v_mov_b32 v57, 0
    v_mov_b32 v58, 0
    v_mov_b32 v59, 0
    v_mov_b32 v60, 0
    v_mov_b32 v61, 0
    v_mov_b32 v62, 0
    v_mov_b32 v63, 0
    v_mov_b32 v64, 0
    v_mov_b32 v65, 0
    v_mov_b32 v66, 0
    v_mov_b32 v67, 0
    v_mov_b32 v68, 0
    v_mov_b32 v69, 0
    v_mov_b32 v70, 0
    v_mov_b32 v71, 0
    v_mov_b32 v72, 0
    v_mov_b32 v73, 0
    v_mov_b32 v74, 0
    v_mov_b32 v75, 0
    v_mov_b32 v76, 0
    v_mov_b32 v77, 0
    v_mov_b32 v78, 0
    v_mov_b32 v79, 0
    v_mov_b32 v80, 0
    v_mov_b32 v81, 0
    v_mov_b32 v82, 0
    v_mov_b32 v83, 0
    v_mov_b32 v84, 0
    v_mov_b32 v85, 0
    v_mov_b32 v86, 0
    v_mov_b32 v87, 0
    v_mov_b32 v88, 0
    v_mov_b32 v89, 0
    v_mov_b32 v90, 0
    v_mov_b32 v91, 0
    v_mov_b32 v92, 0
    v_mov_b32 v93, 0
    v_mov_b32 v94, 0
    v_mov_b32 v95, 0
    v_and_b32 v24, 31, v1
    v_lshl_add_u32 v24, v9, 6, v24
    v_lshlrev_b32 v25, 3, v24
    v_add_u32 v25, 131072, v25
    v_mul_u32_u24 v26, 272, v24
    v_lshl_add_u32 v26, v8, 7, v26
    v_lshl_add_u32 v26, v10, 3, v26
    v_lshrrev_b32 v27, 4, v0
    v_and_b32 v30, 15, v0
    v_mul_u32_u24 v31, 272, v27
    v_lshl_add_u32 v31, v30, 4, v31
    v_mul_u32_u24 v27, 3584, v27
    v_lshl_add_u32 v27, v30, 4, v27
    v_lshlrev_b32 v28, 8, v8
    v_lshl_add_u32 v28, v10, 4, v28
    v_add_u32 v28, 132096, v28
    v_mov_b32 v29, 0
    s_mul_i32 s48, s40, 458752
    s_lshl_b32 s49, s41, 8
    s_add_u32 s48, s48, s49
    s_add_u32 s48, s48, 8388608
    s_barrier
    ds_read_b64_tr_b16 v[96:97], v16 offset:0
    ds_read_b64_tr_b16 v[98:99], v16 offset:1024
    ds_read_b64_tr_b16 v[104:105], v18 offset:0
    ds_read_b64_tr_b16 v[106:107], v18 offset:1024
    ds_read_b64_tr_b16 v[100:101], v17 offset:0
    ds_read_b64_tr_b16 v[102:103], v17 offset:1024
    ds_read_b64_tr_b16 v[108:109], v19 offset:0
    ds_read_b64_tr_b16 v[110:111], v19 offset:1024
    ds_read_b64_tr_b16 v[112:113], v16 offset:4096
    ds_read_b64_tr_b16 v[114:115], v16 offset:5120
    ds_read_b64_tr_b16 v[120:121], v18 offset:4096
    ds_read_b64_tr_b16 v[122:123], v18 offset:5120
    ds_read_b64_tr_b16 v[116:117], v17 offset:4096
    ds_read_b64_tr_b16 v[118:119], v17 offset:5120
    ds_read_b64_tr_b16 v[124:125], v19 offset:4096
    ds_read_b64_tr_b16 v[126:127], v19 offset:5120
    s_waitcnt lgkmcnt(8)
    v_mfma_f32_32x32x16_bf16 v[32:47], v[96:99], v[104:107], v[32:47]
    ds_read_b64_tr_b16 v[128:129], v16 offset:8192
    ds_read_b64_tr_b16 v[130:131], v16 offset:9216
    v_mfma_f32_32x32x16_bf16 v[64:79], v[100:103], v[104:107], v[64:79]
    ds_read_b64_tr_b16 v[136:137], v18 offset:8192
    ds_read_b64_tr_b16 v[138:139], v18 offset:9216
    v_mfma_f32_32x32x16_bf16 v[48:63], v[96:99], v[108:111], v[48:63]
    ds_read_b64_tr_b16 v[132:133], v17 offset:8192
    ds_read_b64_tr_b16 v[134:135], v17 offset:9216
    v_mfma_f32_32x32x16_bf16 v[80:95], v[100:103], v[108:111], v[80:95]
    ds_read_b64_tr_b16 v[140:141], v19 offset:8192
    ds_read_b64_tr_b16 v[142:143], v19 offset:9216
    s_waitcnt lgkmcnt(8)
    v_mfma_f32_32x32x16_bf16 v[32:47], v[112:115], v[120:123], v[32:47]
    ds_read_b64_tr_b16 v[96:97], v16 offset:12288
    ds_read_b64_tr_b16 v[98:99], v16 offset:13312
    v_mfma_f32_32x32x16_bf16 v[64:79], v[116:119], v[120:123], v[64:79]
    ds_read_b64_tr_b16 v[104:105], v18 offset:12288
    ds_read_b64_tr_b16 v[106:107], v18 offset:13312
    v_mfma_f32_32x32x16_bf16 v[48:63], v[112:115], v[124:127], v[48:63]
    ds_read_b64_tr_b16 v[100:101], v17 offset:12288
    ds_read_b64_tr_b16 v[102:103], v17 offset:13312
    v_mfma_f32_32x32x16_bf16 v[80:95], v[116:119], v[124:127], v[80:95]
    ds_read_b64_tr_b16 v[108:109], v19 offset:12288
    ds_read_b64_tr_b16 v[110:111], v19 offset:13312
    s_waitcnt lgkmcnt(0)
    v_mfma_f32_32x32x16_bf16 v[32:47], v[128:131], v[136:139], v[32:47]
    s_barrier
    ds_read_b64_tr_b16 v[112:113], v16 offset:32768
    ds_read_b64_tr_b16 v[114:115], v16 offset:33792
    v_mfma_f32_32x32x16_bf16 v[64:79], v[132:135], v[136:139], v[64:79]
    ds_read_b64_tr_b16 v[120:121], v18 offset:32768
    ds_read_b64_tr_b16 v[122:123], v18 offset:33792
    v_mfma_f32_32x32x16_bf16 v[48:63], v[128:131], v[140:143], v[48:63]
    ds_read_b64_tr_b16 v[116:117], v17 offset:32768
    ds_read_b64_tr_b16 v[118:119], v17 offset:33792
    v_mfma_f32_32x32x16_bf16 v[80:95], v[132:135], v[140:143], v[80:95]
    ds_read_b64_tr_b16 v[124:125], v19 offset:32768
    ds_read_b64_tr_b16 v[126:127], v19 offset:33792
    s_waitcnt lgkmcnt(8)
    v_mfma_f32_32x32x16_bf16 v[32:47], v[96:99], v[104:107], v[32:47]
    ds_read_b64_tr_b16 v[128:129], v16 offset:36864
    ds_read_b64_tr_b16 v[130:131], v16 offset:37888
    v_mfma_f32_32x32x16_bf16 v[64:79], v[100:103], v[104:107], v[64:79]
    ds_read_b64_tr_b16 v[136:137], v18 offset:36864
    ds_read_b64_tr_b16 v[138:139], v18 offset:37888
    v_mfma_f32_32x32x16_bf16 v[48:63], v[96:99], v[108:111], v[48:63]
    ds_read_b64_tr_b16 v[132:133], v17 offset:36864
    ds_read_b64_tr_b16 v[134:135], v17 offset:37888
    v_mfma_f32_32x32x16_bf16 v[80:95], v[100:103], v[108:111], v[80:95]
    ds_read_b64_tr_b16 v[140:141], v19 offset:36864
    ds_read_b64_tr_b16 v[142:143], v19 offset:37888
    s_waitcnt lgkmcnt(8)
    v_mfma_f32_32x32x16_bf16 v[32:47], v[112:115], v[120:123], v[32:47]
    ds_read_b64_tr_b16 v[96:97], v16 offset:40960
    ds_read_b64_tr_b16 v[98:99], v16 offset:41984
    v_mfma_f32_32x32x16_bf16 v[64:79], v[116:119], v[120:123], v[64:79]
    ds_read_b64_tr_b16 v[104:105], v18 offset:40960
    ds_read_b64_tr_b16 v[106:107], v18 offset:41984
    v_mfma_f32_32x32x16_bf16 v[48:63], v[112:115], v[124:127], v[48:63]
    ds_read_b64_tr_b16 v[100:101], v17 offset:40960
    ds_read_b64_tr_b16 v[102:103], v17 offset:41984
    v_mfma_f32_32x32x16_bf16 v[80:95], v[116:119], v[124:127], v[80:95]
    ds_read_b64_tr_b16 v[108:109], v19 offset:40960
    ds_read_b64_tr_b16 v[110:111], v19 offset:41984
    s_waitcnt lgkmcnt(8)
    v_mfma_f32_32x32x16_bf16 v[32:47], v[128:131], v[136:139], v[32:47]
    ds_read_b64_tr_b16 v[112:113], v16 offset:45056
    ds_read_b64_tr_b16 v[114:115], v16 offset:46080
    v_mfma_f32_32x32x16_bf16 v[64:79], v[132:135], v[136:139], v[64:79]
    ds_read_b64_tr_b16 v[120:121], v18 offset:45056
    ds_read_b64_tr_b16 v[122:123], v18 offset:46080
    v_mfma_f32_32x32x16_bf16 v[48:63], v[128:131], v[140:143], v[48:63]
    ds_read_b64_tr_b16 v[116:117], v17 offset:45056
    ds_read_b64_tr_b16 v[118:119], v17 offset:46080
    v_mfma_f32_32x32x16_bf16 v[80:95], v[132:135], v[140:143], v[80:95]
    ds_read_b64_tr_b16 v[124:125], v19 offset:45056
    ds_read_b64_tr_b16 v[126:127], v19 offset:46080
    s_waitcnt lgkmcnt(0)
    v_mfma_f32_32x32x16_bf16 v[32:47], v[96:99], v[104:107], v[32:47]
    s_barrier
    ds_read_b64_tr_b16 v[128:129], v20 offset:0
    ds_read_b64_tr_b16 v[130:131], v20 offset:1024
    v_mfma_f32_32x32x16_bf16 v[64:79], v[100:103], v[104:107], v[64:79]
    ds_read_b64_tr_b16 v[136:137], v22 offset:0
    ds_read_b64_tr_b16 v[138:139], v22 offset:1024
    v_mfma_f32_32x32x16_bf16 v[48:63], v[96:99], v[108:111], v[48:63]
    ds_read_b64_tr_b16 v[132:133], v21 offset:0
    ds_read_b64_tr_b16 v[134:135], v21 offset:1024
    v_mfma_f32_32x32x16_bf16 v[80:95], v[100:103], v[108:111], v[80:95]
    ds_read_b64_tr_b16 v[140:141], v23 offset:0
    ds_read_b64_tr_b16 v[142:143], v23 offset:1024
    s_waitcnt lgkmcnt(8)
    v_mfma_f32_32x32x16_bf16 v[32:47], v[112:115], v[120:123], v[32:47]
    ds_read_b64_tr_b16 v[96:97], v20 offset:4096
    ds_read_b64_tr_b16 v[98:99], v20 offset:5120
    v_mfma_f32_32x32x16_bf16 v[64:79], v[116:119], v[120:123], v[64:79]
    ds_read_b64_tr_b16 v[104:105], v22 offset:4096
    ds_read_b64_tr_b16 v[106:107], v22 offset:5120
    v_mfma_f32_32x32x16_bf16 v[48:63], v[112:115], v[124:127], v[48:63]
    ds_read_b64_tr_b16 v[100:101], v21 offset:4096
    ds_read_b64_tr_b16 v[102:103], v21 offset:5120
    v_mfma_f32_32x32x16_bf16 v[80:95], v[116:119], v[124:127], v[80:95]
    ds_read_b64_tr_b16 v[108:109], v23 offset:4096
    ds_read_b64_tr_b16 v[110:111], v23 offset:5120
    s_waitcnt lgkmcnt(8)
    v_mfma_f32_32x32x16_bf16 v[32:47], v[128:131], v[136:139], v[32:47]
    ds_read_b64_tr_b16 v[112:113], v20 offset:8192
    ds_read_b64_tr_b16 v[114:115], v20 offset:9216
    v_mfma_f32_32x32x16_bf16 v[64:79], v[132:135], v[136:139], v[64:79]
    ds_read_b64_tr_b16 v[120:121], v22 offset:8192
    ds_read_b64_tr_b16 v[122:123], v22 offset:9216
    v_mfma_f32_32x32x16_bf16 v[48:63], v[128:131], v[140:143], v[48:63]
    ds_read_b64_tr_b16 v[116:117], v21 offset:8192
    ds_read_b64_tr_b16 v[118:119], v21 offset:9216
    v_mfma_f32_32x32x16_bf16 v[80:95], v[132:135], v[140:143], v[80:95]
    ds_read_b64_tr_b16 v[124:125], v23 offset:8192
    ds_read_b64_tr_b16 v[126:127], v23 offset:9216
    s_waitcnt lgkmcnt(8)
    v_mfma_f32_32x32x16_bf16 v[32:47], v[96:99], v[104:107], v[32:47]
    ds_read_b64_tr_b16 v[128:129], v20 offset:12288
    ds_read_b64_tr_b16 v[130:131], v20 offset:13312
    v_mfma_f32_32x32x16_bf16 v[64:79], v[100:103], v[104:107], v[64:79]
    ds_read_b64_tr_b16 v[136:137], v22 offset:12288
    ds_read_b64_tr_b16 v[138:139], v22 offset:13312
    v_mfma_f32_32x32x16_bf16 v[48:63], v[96:99], v[108:111], v[48:63]
    ds_read_b64_tr_b16 v[132:133], v21 offset:12288
    ds_read_b64_tr_b16 v[134:135], v21 offset:13312
    v_mfma_f32_32x32x16_bf16 v[80:95], v[100:103], v[108:111], v[80:95]
    ds_read_b64_tr_b16 v[140:141], v23 offset:12288
    ds_read_b64_tr_b16 v[142:143], v23 offset:13312
    s_waitcnt lgkmcnt(0)
    v_mfma_f32_32x32x16_bf16 v[32:47], v[112:115], v[120:123], v[32:47]
    s_barrier
    ds_read_b64_tr_b16 v[96:97], v20 offset:32768
    ds_read_b64_tr_b16 v[98:99], v20 offset:33792
    v_mfma_f32_32x32x16_bf16 v[64:79], v[116:119], v[120:123], v[64:79]
    ds_read_b64_tr_b16 v[104:105], v22 offset:32768
    ds_read_b64_tr_b16 v[106:107], v22 offset:33792
    v_mfma_f32_32x32x16_bf16 v[48:63], v[112:115], v[124:127], v[48:63]
    ds_read_b64_tr_b16 v[100:101], v21 offset:32768
    ds_read_b64_tr_b16 v[102:103], v21 offset:33792
    v_mfma_f32_32x32x16_bf16 v[80:95], v[116:119], v[124:127], v[80:95]
    ds_read_b64_tr_b16 v[108:109], v23 offset:32768
    ds_read_b64_tr_b16 v[110:111], v23 offset:33792
    s_waitcnt lgkmcnt(8)
    v_mfma_f32_32x32x16_bf16 v[32:47], v[128:131], v[136:139], v[32:47]
    ds_read_b64_tr_b16 v[112:113], v20 offset:36864
    ds_read_b64_tr_b16 v[114:115], v20 offset:37888
    v_mfma_f32_32x32x16_bf16 v[64:79], v[132:135], v[136:139], v[64:79]
    ds_read_b64_tr_b16 v[120:121], v22 offset:36864
    ds_read_b64_tr_b16 v[122:123], v22 offset:37888
    v_mfma_f32_32x32x16_bf16 v[48:63], v[128:131], v[140:143], v[48:63]
    ds_read_b64_tr_b16 v[116:117], v21 offset:36864
    ds_read_b64_tr_b16 v[118:119], v21 offset:37888
    v_mfma_f32_32x32x16_bf16 v[80:95], v[132:135], v[140:143], v[80:95]
    ds_read_b64_tr_b16 v[124:125], v23 offset:36864
    ds_read_b64_tr_b16 v[126:127], v23 offset:37888
    s_waitcnt lgkmcnt(8)
    v_mfma_f32_32x32x16_bf16 v[32:47], v[96:99], v[104:107], v[32:47]
    ds_read_b64_tr_b16 v[128:129], v20 offset:40960
    ds_read_b64_tr_b16 v[130:131], v20 offset:41984
    v_mfma_f32_32x32x16_bf16 v[64:79], v[100:103], v[104:107], v[64:79]
    ds_read_b64_tr_b16 v[136:137], v22 offset:40960
    ds_read_b64_tr_b16 v[138:139], v22 offset:41984
    v_mfma_f32_32x32x16_bf16 v[48:63], v[96:99], v[108:111], v[48:63]
    ds_read_b64_tr_b16 v[132:133], v21 offset:40960
    ds_read_b64_tr_b16 v[134:135], v21 offset:41984
    v_mfma_f32_32x32x16_bf16 v[80:95], v[100:103], v[108:111], v[80:95]
    ds_read_b64_tr_b16 v[140:141], v23 offset:40960
    ds_read_b64_tr_b16 v[142:143], v23 offset:41984
    s_waitcnt lgkmcnt(8)
    v_mfma_f32_32x32x16_bf16 v[32:47], v[112:115], v[120:123], v[32:47]
    ds_read_b64_tr_b16 v[96:97], v20 offset:45056
    ds_read_b64_tr_b16 v[98:99], v20 offset:46080
    v_mfma_f32_32x32x16_bf16 v[64:79], v[116:119], v[120:123], v[64:79]
    ds_read_b64_tr_b16 v[104:105], v22 offset:45056
    ds_read_b64_tr_b16 v[106:107], v22 offset:46080
    v_mfma_f32_32x32x16_bf16 v[48:63], v[112:115], v[124:127], v[48:63]
    ds_read_b64_tr_b16 v[100:101], v21 offset:45056
    ds_read_b64_tr_b16 v[102:103], v21 offset:46080
    v_mfma_f32_32x32x16_bf16 v[80:95], v[116:119], v[124:127], v[80:95]
    ds_read_b64_tr_b16 v[108:109], v23 offset:45056
    ds_read_b64_tr_b16 v[110:111], v23 offset:46080
    s_waitcnt lgkmcnt(0)
    v_mfma_f32_32x32x16_bf16 v[32:47], v[128:131], v[136:139], v[32:47]
    s_barrier
    ds_read_b64_tr_b16 v[112:113], v16 offset:0
    ds_read_b64_tr_b16 v[114:115], v16 offset:1024
    v_mfma_f32_32x32x16_bf16 v[64:79], v[132:135], v[136:139], v[64:79]
    ds_read_b64_tr_b16 v[120:121], v18 offset:0
    ds_read_b64_tr_b16 v[122:123], v18 offset:1024
    v_mfma_f32_32x32x16_bf16 v[48:63], v[128:131], v[140:143], v[48:63]
    ds_read_b64_tr_b16 v[116:117], v17 offset:0
    ds_read_b64_tr_b16 v[118:119], v17 offset:1024
    v_mfma_f32_32x32x16_bf16 v[80:95], v[132:135], v[140:143], v[80:95]
    ds_read_b64_tr_b16 v[124:125], v19 offset:0
    ds_read_b64_tr_b16 v[126:127], v19 offset:1024
    s_waitcnt lgkmcnt(8)
    v_mfma_f32_32x32x16_bf16 v[32:47], v[96:99], v[104:107], v[32:47]
    ds_read_b64_tr_b16 v[128:129], v16 offset:4096
    ds_read_b64_tr_b16 v[130:131], v16 offset:5120
    v_mfma_f32_32x32x16_bf16 v[64:79], v[100:103], v[104:107], v[64:79]
    ds_read_b64_tr_b16 v[136:137], v18 offset:4096
    ds_read_b64_tr_b16 v[138:139], v18 offset:5120
    v_mfma_f32_32x32x16_bf16 v[48:63], v[96:99], v[108:111], v[48:63]
    ds_read_b64_tr_b16 v[132:133], v17 offset:4096
    ds_read_b64_tr_b16 v[134:135], v17 offset:5120
    v_mfma_f32_32x32x16_bf16 v[80:95], v[100:103], v[108:111], v[80:95]
    ds_read_b64_tr_b16 v[140:141], v19 offset:4096
    ds_read_b64_tr_b16 v[142:143], v19 offset:5120
    s_waitcnt lgkmcnt(8)
    v_mfma_f32_32x32x16_bf16 v[32:47], v[112:115], v[120:123], v[32:47]
    ds_read_b64_tr_b16 v[96:97], v16 offset:8192
    ds_read_b64_tr_b16 v[98:99], v16 offset:9216
    v_mfma_f32_32x32x16_bf16 v[64:79], v[116:119], v[120:123], v[64:79]
    ds_read_b64_tr_b16 v[104:105], v18 offset:8192
    ds_read_b64_tr_b16 v[106:107], v18 offset:9216
    v_mfma_f32_32x32x16_bf16 v[48:63], v[112:115], v[124:127], v[48:63]
    ds_read_b64_tr_b16 v[100:101], v17 offset:8192
    ds_read_b64_tr_b16 v[102:103], v17 offset:9216
    v_mfma_f32_32x32x16_bf16 v[80:95], v[116:119], v[124:127], v[80:95]
    ds_read_b64_tr_b16 v[108:109], v19 offset:8192
    ds_read_b64_tr_b16 v[110:111], v19 offset:9216
    s_waitcnt lgkmcnt(8)
    v_mfma_f32_32x32x16_bf16 v[32:47], v[128:131], v[136:139], v[32:47]
    ds_read_b64_tr_b16 v[112:113], v16 offset:12288
    ds_read_b64_tr_b16 v[114:115], v16 offset:13312
    v_mfma_f32_32x32x16_bf16 v[64:79], v[132:135], v[136:139], v[64:79]
    ds_read_b64_tr_b16 v[120:121], v18 offset:12288
    ds_read_b64_tr_b16 v[122:123], v18 offset:13312
    v_mfma_f32_32x32x16_bf16 v[48:63], v[128:131], v[140:143], v[48:63]
    ds_read_b64_tr_b16 v[116:117], v17 offset:12288
    ds_read_b64_tr_b16 v[118:119], v17 offset:13312
    v_mfma_f32_32x32x16_bf16 v[80:95], v[132:135], v[140:143], v[80:95]
    ds_read_b64_tr_b16 v[124:125], v19 offset:12288
    ds_read_b64_tr_b16 v[126:127], v19 offset:13312
    s_waitcnt lgkmcnt(0)
    v_mfma_f32_32x32x16_bf16 v[32:47], v[96:99], v[104:107], v[32:47]
    s_barrier
    ds_read_b64_tr_b16 v[128:129], v16 offset:32768
    ds_read_b64_tr_b16 v[130:131], v16 offset:33792
    v_mfma_f32_32x32x16_bf16 v[64:79], v[100:103], v[104:107], v[64:79]
    ds_read_b64_tr_b16 v[136:137], v18 offset:32768
    ds_read_b64_tr_b16 v[138:139], v18 offset:33792
    v_mfma_f32_32x32x16_bf16 v[48:63], v[96:99], v[108:111], v[48:63]
    ds_read_b64_tr_b16 v[132:133], v17 offset:32768
    ds_read_b64_tr_b16 v[134:135], v17 offset:33792
    v_mfma_f32_32x32x16_bf16 v[80:95], v[100:103], v[108:111], v[80:95]
    ds_read_b64_tr_b16 v[140:141], v19 offset:32768
    ds_read_b64_tr_b16 v[142:143], v19 offset:33792
    s_waitcnt lgkmcnt(8)
    v_mfma_f32_32x32x16_bf16 v[32:47], v[112:115], v[120:123], v[32:47]
    ds_read_b64_tr_b16 v[96:97], v16 offset:36864
    ds_read_b64_tr_b16 v[98:99], v16 offset:37888
    v_mfma_f32_32x32x16_bf16 v[64:79], v[116:119], v[120:123], v[64:79]
    ds_read_b64_tr_b16 v[104:105], v18 offset:36864
    ds_read_b64_tr_b16 v[106:107], v18 offset:37888
    v_mfma_f32_32x32x16_bf16 v[48:63], v[112:115], v[124:127], v[48:63]
    ds_read_b64_tr_b16 v[100:101], v17 offset:36864
    ds_read_b64_tr_b16 v[102:103], v17 offset:37888
    v_mfma_f32_32x32x16_bf16 v[80:95], v[116:119], v[124:127], v[80:95]
    ds_read_b64_tr_b16 v[108:109], v19 offset:36864
    ds_read_b64_tr_b16 v[110:111], v19 offset:37888
    s_waitcnt lgkmcnt(8)
    v_mfma_f32_32x32x16_bf16 v[32:47], v[128:131], v[136:139], v[32:47]
    ds_read_b64_tr_b16 v[112:113], v16 offset:40960
    ds_read_b64_tr_b16 v[114:115], v16 offset:41984
    v_mfma_f32_32x32x16_bf16 v[64:79], v[132:135], v[136:139], v[64:79]
    ds_read_b64_tr_b16 v[120:121], v18 offset:40960
    ds_read_b64_tr_b16 v[122:123], v18 offset:41984
    v_mfma_f32_32x32x16_bf16 v[48:63], v[128:131], v[140:143], v[48:63]
    ds_read_b64_tr_b16 v[116:117], v17 offset:40960
    ds_read_b64_tr_b16 v[118:119], v17 offset:41984
    v_mfma_f32_32x32x16_bf16 v[80:95], v[132:135], v[140:143], v[80:95]
    ds_read_b64_tr_b16 v[124:125], v19 offset:40960
    ds_read_b64_tr_b16 v[126:127], v19 offset:41984
    s_waitcnt lgkmcnt(8)
    v_mfma_f32_32x32x16_bf16 v[32:47], v[96:99], v[104:107], v[32:47]
    ds_read_b64_tr_b16 v[128:129], v16 offset:45056
    ds_read_b64_tr_b16 v[130:131], v16 offset:46080
    v_mfma_f32_32x32x16_bf16 v[64:79], v[100:103], v[104:107], v[64:79]
    ds_read_b64_tr_b16 v[136:137], v18 offset:45056
    ds_read_b64_tr_b16 v[138:139], v18 offset:46080
    v_mfma_f32_32x32x16_bf16 v[48:63], v[96:99], v[108:111], v[48:63]
    ds_read_b64_tr_b16 v[132:133], v17 offset:45056
    ds_read_b64_tr_b16 v[134:135], v17 offset:46080
    v_mfma_f32_32x32x16_bf16 v[80:95], v[100:103], v[108:111], v[80:95]
    ds_read_b64_tr_b16 v[140:141], v19 offset:45056
    ds_read_b64_tr_b16 v[142:143], v19 offset:46080
    s_waitcnt lgkmcnt(0)
    v_mfma_f32_32x32x16_bf16 v[32:47], v[112:115], v[120:123], v[32:47]
    s_barrier
    ds_read_b64_tr_b16 v[96:97], v20 offset:0
    ds_read_b64_tr_b16 v[98:99], v20 offset:1024
    v_mfma_f32_32x32x16_bf16 v[64:79], v[116:119], v[120:123], v[64:79]
    ds_read_b64_tr_b16 v[104:105], v22 offset:0
    ds_read_b64_tr_b16 v[106:107], v22 offset:1024
    v_mfma_f32_32x32x16_bf16 v[48:63], v[112:115], v[124:127], v[48:63]
    ds_read_b64_tr_b16 v[100:101], v21 offset:0
    ds_read_b64_tr_b16 v[102:103], v21 offset:1024
    v_mfma_f32_32x32x16_bf16 v[80:95], v[116:119], v[124:127], v[80:95]
    ds_read_b64_tr_b16 v[108:109], v23 offset:0
    ds_read_b64_tr_b16 v[110:111], v23 offset:1024
    s_waitcnt lgkmcnt(8)
    v_mfma_f32_32x32x16_bf16 v[32:47], v[128:131], v[136:139], v[32:47]
    ds_read_b64_tr_b16 v[112:113], v20 offset:4096
    ds_read_b64_tr_b16 v[114:115], v20 offset:5120
    v_mfma_f32_32x32x16_bf16 v[64:79], v[132:135], v[136:139], v[64:79]
    ds_read_b64_tr_b16 v[120:121], v22 offset:4096
    ds_read_b64_tr_b16 v[122:123], v22 offset:5120
    v_mfma_f32_32x32x16_bf16 v[48:63], v[128:131], v[140:143], v[48:63]
    ds_read_b64_tr_b16 v[116:117], v21 offset:4096
    ds_read_b64_tr_b16 v[118:119], v21 offset:5120
    v_mfma_f32_32x32x16_bf16 v[80:95], v[132:135], v[140:143], v[80:95]
    ds_read_b64_tr_b16 v[124:125], v23 offset:4096
    ds_read_b64_tr_b16 v[126:127], v23 offset:5120
    s_waitcnt lgkmcnt(8)
    v_mfma_f32_32x32x16_bf16 v[32:47], v[96:99], v[104:107], v[32:47]
    ds_read_b64_tr_b16 v[128:129], v20 offset:8192
    ds_read_b64_tr_b16 v[130:131], v20 offset:9216
    v_mfma_f32_32x32x16_bf16 v[64:79], v[100:103], v[104:107], v[64:79]
    ds_read_b64_tr_b16 v[136:137], v22 offset:8192
    ds_read_b64_tr_b16 v[138:139], v22 offset:9216
    v_mfma_f32_32x32x16_bf16 v[48:63], v[96:99], v[108:111], v[48:63]
    ds_read_b64_tr_b16 v[132:133], v21 offset:8192
    ds_read_b64_tr_b16 v[134:135], v21 offset:9216
    v_mfma_f32_32x32x16_bf16 v[80:95], v[100:103], v[108:111], v[80:95]
    ds_read_b64_tr_b16 v[140:141], v23 offset:8192
    ds_read_b64_tr_b16 v[142:143], v23 offset:9216
    s_waitcnt lgkmcnt(8)
    v_mfma_f32_32x32x16_bf16 v[32:47], v[112:115], v[120:123], v[32:47]
    ds_read_b64_tr_b16 v[96:97], v20 offset:12288
    ds_read_b64_tr_b16 v[98:99], v20 offset:13312
    v_mfma_f32_32x32x16_bf16 v[64:79], v[116:119], v[120:123], v[64:79]
    ds_read_b64_tr_b16 v[104:105], v22 offset:12288
    ds_read_b64_tr_b16 v[106:107], v22 offset:13312
    v_mfma_f32_32x32x16_bf16 v[48:63], v[112:115], v[124:127], v[48:63]
    ds_read_b64_tr_b16 v[100:101], v21 offset:12288
    ds_read_b64_tr_b16 v[102:103], v21 offset:13312
    v_mfma_f32_32x32x16_bf16 v[80:95], v[116:119], v[124:127], v[80:95]
    ds_read_b64_tr_b16 v[108:109], v23 offset:12288
    ds_read_b64_tr_b16 v[110:111], v23 offset:13312
    s_waitcnt lgkmcnt(0)
    v_mfma_f32_32x32x16_bf16 v[32:47], v[128:131], v[136:139], v[32:47]
    s_barrier
    ds_read_b64_tr_b16 v[112:113], v20 offset:32768
    ds_read_b64_tr_b16 v[114:115], v20 offset:33792
    v_mfma_f32_32x32x16_bf16 v[64:79], v[132:135], v[136:139], v[64:79]
    ds_read_b64_tr_b16 v[120:121], v22 offset:32768
    ds_read_b64_tr_b16 v[122:123], v22 offset:33792
    v_mfma_f32_32x32x16_bf16 v[48:63], v[128:131], v[140:143], v[48:63]
    ds_read_b64_tr_b16 v[116:117], v21 offset:32768
    ds_read_b64_tr_b16 v[118:119], v21 offset:33792
    v_mfma_f32_32x32x16_bf16 v[80:95], v[132:135], v[140:143], v[80:95]
    ds_read_b64_tr_b16 v[124:125], v23 offset:32768
    ds_read_b64_tr_b16 v[126:127], v23 offset:33792
    s_waitcnt lgkmcnt(8)
    v_mfma_f32_32x32x16_bf16 v[32:47], v[96:99], v[104:107], v[32:47]
    ds_read_b64_tr_b16 v[128:129], v20 offset:36864
    ds_read_b64_tr_b16 v[130:131], v20 offset:37888
    v_mfma_f32_32x32x16_bf16 v[64:79], v[100:103], v[104:107], v[64:79]
    ds_read_b64_tr_b16 v[136:137], v22 offset:36864
    ds_read_b64_tr_b16 v[138:139], v22 offset:37888
    v_mfma_f32_32x32x16_bf16 v[48:63], v[96:99], v[108:111], v[48:63]
    ds_read_b64_tr_b16 v[132:133], v21 offset:36864
    ds_read_b64_tr_b16 v[134:135], v21 offset:37888
    v_mfma_f32_32x32x16_bf16 v[80:95], v[100:103], v[108:111], v[80:95]
    ds_read_b64_tr_b16 v[140:141], v23 offset:36864
    ds_read_b64_tr_b16 v[142:143], v23 offset:37888
    s_waitcnt lgkmcnt(8)
    v_mfma_f32_32x32x16_bf16 v[32:47], v[112:115], v[120:123], v[32:47]
    ds_read_b64_tr_b16 v[96:97], v20 offset:40960
    ds_read_b64_tr_b16 v[98:99], v20 offset:41984
    v_mfma_f32_32x32x16_bf16 v[64:79], v[116:119], v[120:123], v[64:79]
    ds_read_b64_tr_b16 v[104:105], v22 offset:40960
    ds_read_b64_tr_b16 v[106:107], v22 offset:41984
    v_mfma_f32_32x32x16_bf16 v[48:63], v[112:115], v[124:127], v[48:63]
    ds_read_b64_tr_b16 v[100:101], v21 offset:40960
    ds_read_b64_tr_b16 v[102:103], v21 offset:41984
    v_mfma_f32_32x32x16_bf16 v[80:95], v[116:119], v[124:127], v[80:95]
    ds_read_b64_tr_b16 v[108:109], v23 offset:40960
    ds_read_b64_tr_b16 v[110:111], v23 offset:41984
    s_waitcnt lgkmcnt(8)
    v_mfma_f32_32x32x16_bf16 v[32:47], v[128:131], v[136:139], v[32:47]
    ds_read_b64_tr_b16 v[112:113], v20 offset:45056
    ds_read_b64_tr_b16 v[114:115], v20 offset:46080
    v_mfma_f32_32x32x16_bf16 v[64:79], v[132:135], v[136:139], v[64:79]
    ds_read_b64_tr_b16 v[120:121], v22 offset:45056
    ds_read_b64_tr_b16 v[122:123], v22 offset:46080
    v_mfma_f32_32x32x16_bf16 v[48:63], v[128:131], v[140:143], v[48:63]
    ds_read_b64_tr_b16 v[116:117], v21 offset:45056
    ds_read_b64_tr_b16 v[118:119], v21 offset:46080
    v_mfma_f32_32x32x16_bf16 v[80:95], v[132:135], v[140:143], v[80:95]
    ds_read_b64_tr_b16 v[124:125], v23 offset:45056
    ds_read_b64_tr_b16 v[126:127], v23 offset:46080
    s_waitcnt lgkmcnt(8)
    v_mfma_f32_32x32x16_bf16 v[32:47], v[96:99], v[104:107], v[32:47]
    v_mfma_f32_32x32x16_bf16 v[64:79], v[100:103], v[104:107], v[64:79]
    v_mfma_f32_32x32x16_bf16 v[48:63], v[96:99], v[108:111], v[48:63]
    v_mfma_f32_32x32x16_bf16 v[80:95], v[100:103], v[108:111], v[80:95]
    s_waitcnt lgkmcnt(0)
    v_mfma_f32_32x32x16_bf16 v[32:47], v[112:115], v[120:123], v[32:47]
    v_mfma_f32_32x32x16_bf16 v[64:79], v[116:119], v[120:123], v[64:79]
    v_mfma_f32_32x32x16_bf16 v[48:63], v[112:115], v[124:127], v[48:63]
    v_mfma_f32_32x32x16_bf16 v[80:95], v[116:119], v[124:127], v[80:95]
    s_barrier
    ds_read_b64 v[144:145], v25
    ds_read_b64 v[148:149], v25 offset:256
    ds_read_b128 v[96:99], v28 offset:0
    ds_read_b128 v[100:103], v28 offset:32
    ds_read_b128 v[104:107], v28 offset:64
    ds_read_b128 v[108:111], v28 offset:96
    ds_read_b128 v[112:115], v28 offset:128
    ds_read_b128 v[116:119], v28 offset:160
    ds_read_b128 v[120:123], v28 offset:192
    ds_read_b128 v[124:127], v28 offset:224
    s_waitcnt lgkmcnt(8)
    v_mov_b32 v146, v145
    v_mov_b32 v147, v145
    v_mov_b32 v145, v144
    v_mov_b32 v150, v149
    v_mov_b32 v151, v149
    v_mov_b32 v149, v148
    s_waitcnt lgkmcnt(0)
    v_pk_fma_f32 v[32:33], v[144:145], v[96:97], v[32:33] neg_lo:[1,0,0] neg_hi:[1,0,0]
    v_pk_fma_f32 v[34:35], v[144:145], v[98:99], v[34:35] neg_lo:[1,0,0] neg_hi:[1,0,0]
    v_pk_fma_f32 v[36:37], v[144:145], v[100:101], v[36:37] neg_lo:[1,0,0] neg_hi:[1,0,0]
    v_pk_fma_f32 v[38:39], v[144:145], v[102:103], v[38:39] neg_lo:[1,0,0] neg_hi:[1,0,0]
    v_pk_fma_f32 v[40:41], v[144:145], v[104:105], v[40:41] neg_lo:[1,0,0] neg_hi:[1,0,0]
    v_pk_fma_f32 v[42:43], v[144:145], v[106:107], v[42:43] neg_lo:[1,0,0] neg_hi:[1,0,0]
    v_pk_fma_f32 v[44:45], v[144:145], v[108:109], v[44:45] neg_lo:[1,0,0] neg_hi:[1,0,0]
    v_pk_fma_f32 v[46:47], v[144:145], v[110:111], v[46:47] neg_lo:[1,0,0] neg_hi:[1,0,0]
    v_pk_mul_f32 v[32:33], v[32:33], v[146:147]
    v_pk_mul_f32 v[34:35], v[34:35], v[146:147]
    v_pk_mul_f32 v[36:37], v[36:37], v[146:147]
    v_pk_mul_f32 v[38:39], v[38:39], v[146:147]
    v_pk_mul_f32 v[40:41], v[40:41], v[146:147]
    v_pk_mul_f32 v[42:43], v[42:43], v[146:147]
    v_pk_mul_f32 v[44:45], v[44:45], v[146:147]
    v_pk_mul_f32 v[46:47], v[46:47], v[146:147]
    v_cvt_pk_bf16_f32 v128, v32, v33
    v_cvt_pk_bf16_f32 v129, v34, v35
    v_cvt_pk_bf16_f32 v130, v36, v37
    v_cvt_pk_bf16_f32 v131, v38, v39
    v_cvt_pk_bf16_f32 v132, v40, v41
    v_cvt_pk_bf16_f32 v133, v42, v43
    v_cvt_pk_bf16_f32 v134, v44, v45
    v_cvt_pk_bf16_f32 v135, v46, v47
    v_pk_max_i16 v128, v128, v29
    v_pk_max_i16 v129, v129, v29
    v_pk_max_i16 v130, v130, v29
    v_pk_max_i16 v131, v131, v29
    v_pk_max_i16 v132, v132, v29
    v_pk_max_i16 v133, v133, v29
    v_pk_max_i16 v134, v134, v29
    v_pk_max_i16 v135, v135, v29
    ds_write_b64 v26, v[128:129] offset:0
    ds_write_b64 v26, v[130:131] offset:16
    ds_write_b64 v26, v[132:133] offset:32
    ds_write_b64 v26, v[134:135] offset:48
    v_pk_fma_f32 v[48:49], v[148:149], v[96:97], v[48:49] neg_lo:[1,0,0] neg_hi:[1,0,0]
    v_pk_fma_f32 v[50:51], v[148:149], v[98:99], v[50:51] neg_lo:[1,0,0] neg_hi:[1,0,0]
    v_pk_fma_f32 v[52:53], v[148:149], v[100:101], v[52:53] neg_lo:[1,0,0] neg_hi:[1,0,0]
    v_pk_fma_f32 v[54:55], v[148:149], v[102:103], v[54:55] neg_lo:[1,0,0] neg_hi:[1,0,0]
    v_pk_fma_f32 v[56:57], v[148:149], v[104:105], v[56:57] neg_lo:[1,0,0] neg_hi:[1,0,0]
    v_pk_fma_f32 v[58:59], v[148:149], v[106:107], v[58:59] neg_lo:[1,0,0] neg_hi:[1,0,0]
    v_pk_fma_f32 v[60:61], v[148:149], v[108:109], v[60:61] neg_lo:[1,0,0] neg_hi:[1,0,0]
    v_pk_fma_f32 v[62:63], v[148:149], v[110:111], v[62:63] neg_lo:[1,0,0] neg_hi:[1,0,0]
    v_pk_mul_f32 v[48:49], v[48:49], v[150:151]
    v_pk_mul_f32 v[50:51], v[50:51], v[150:151]
    v_pk_mul_f32 v[52:53], v[52:53], v[150:151]
    v_pk_mul_f32 v[54:55], v[54:55], v[150:151]
    v_pk_mul_f32 v[56:57], v[56:57], v[150:151]
    v_pk_mul_f32 v[58:59], v[58:59], v[150:151]
    v_pk_mul_f32 v[60:61], v[60:61], v[150:151]
    v_pk_mul_f32 v[62:63], v[62:63], v[150:151]
    v_cvt_pk_bf16_f32 v136, v48, v49
    v_cvt_pk_bf16_f32 v137, v50, v51
    v_cvt_pk_bf16_f32 v138, v52, v53
    v_cvt_pk_bf16_f32 v139, v54, v55
    v_cvt_pk_bf16_f32 v140, v56, v57
    v_cvt_pk_bf16_f32 v141, v58, v59
    v_cvt_pk_bf16_f32 v142, v60, v61
    v_cvt_pk_bf16_f32 v143, v62, v63
    v_pk_max_i16 v136, v136, v29
    v_pk_max_i16 v137, v137, v29
    v_pk_max_i16 v138, v138, v29
    v_pk_max_i16 v139, v139, v29
    v_pk_max_i16 v140, v140, v29
    v_pk_max_i16 v141, v141, v29
    v_pk_max_i16 v142, v142, v29
    v_pk_max_i16 v143, v143, v29
    ds_write_b64 v26, v[136:137] offset:8704
    ds_write_b64 v26, v[138:139] offset:8720
    ds_write_b64 v26, v[140:141] offset:8736
    ds_write_b64 v26, v[142:143] offset:8752
    v_pk_fma_f32 v[64:65], v[144:145], v[112:113], v[64:65] neg_lo:[1,0,0] neg_hi:[1,0,0]
    v_pk_fma_f32 v[66:67], v[144:145], v[114:115], v[66:67] neg_lo:[1,0,0] neg_hi:[1,0,0]
    v_pk_fma_f32 v[68:69], v[144:145], v[116:117], v[68:69] neg_lo:[1,0,0] neg_hi:[1,0,0]
    v_pk_fma_f32 v[70:71], v[144:145], v[118:119], v[70:71] neg_lo:[1,0,0] neg_hi:[1,0,0]
    v_pk_fma_f32 v[72:73], v[144:145], v[120:121], v[72:73] neg_lo:[1,0,0] neg_hi:[1,0,0]
    v_pk_fma_f32 v[74:75], v[144:145], v[122:123], v[74:75] neg_lo:[1,0,0] neg_hi:[1,0,0]
    v_pk_fma_f32 v[76:77], v[144:145], v[124:125], v[76:77] neg_lo:[1,0,0] neg_hi:[1,0,0]
    v_pk_fma_f32 v[78:79], v[144:145], v[126:127], v[78:79] neg_lo:[1,0,0] neg_hi:[1,0,0]
    v_pk_mul_f32 v[64:65], v[64:65], v[146:147]
    v_pk_mul_f32 v[66:67], v[66:67], v[146:147]
    v_pk_mul_f32 v[68:69], v[68:69], v[146:147]
    v_pk_mul_f32 v[70:71], v[70:71], v[146:147]
    v_pk_mul_f32 v[72:73], v[72:73], v[146:147]
    v_pk_mul_f32 v[74:75], v[74:75], v[146:147]
    v_pk_mul_f32 v[76:77], v[76:77], v[146:147]
    v_pk_mul_f32 v[78:79], v[78:79], v[146:147]
    v_cvt_pk_bf16_f32 v128, v64, v65
    v_cvt_pk_bf16_f32 v129, v66, v67
    v_cvt_pk_bf16_f32 v130, v68, v69
    v_cvt_pk_bf16_f32 v131, v70, v71
    v_cvt_pk_bf16_f32 v132, v72, v73
    v_cvt_pk_bf16_f32 v133, v74, v75
    v_cvt_pk_bf16_f32 v134, v76, v77
    v_cvt_pk_bf16_f32 v135, v78, v79
    v_pk_max_i16 v128, v128, v29
    v_pk_max_i16 v129, v129, v29
    v_pk_max_i16 v130, v130, v29
    v_pk_max_i16 v131, v131, v29
    v_pk_max_i16 v132, v132, v29
    v_pk_max_i16 v133, v133, v29
    v_pk_max_i16 v134, v134, v29
    v_pk_max_i16 v135, v135, v29
    ds_write_b64 v26, v[128:129] offset:64
    ds_write_b64 v26, v[130:131] offset:80
    ds_write_b64 v26, v[132:133] offset:96
    ds_write_b64 v26, v[134:135] offset:112
    v_pk_fma_f32 v[80:81], v[148:149], v[112:113], v[80:81] neg_lo:[1,0,0] neg_hi:[1,0,0]
    v_pk_fma_f32 v[82:83], v[148:149], v[114:115], v[82:83] neg_lo:[1,0,0] neg_hi:[1,0,0]
    v_pk_fma_f32 v[84:85], v[148:149], v[116:117], v[84:85] neg_lo:[1,0,0] neg_hi:[1,0,0]
    v_pk_fma_f32 v[86:87], v[148:149], v[118:119], v[86:87] neg_lo:[1,0,0] neg_hi:[1,0,0]
    v_pk_fma_f32 v[88:89], v[148:149], v[120:121], v[88:89] neg_lo:[1,0,0] neg_hi:[1,0,0]
    v_pk_fma_f32 v[90:91], v[148:149], v[122:123], v[90:91] neg_lo:[1,0,0] neg_hi:[1,0,0]
    v_pk_fma_f32 v[92:93], v[148:149], v[124:125], v[92:93] neg_lo:[1,0,0] neg_hi:[1,0,0]
    v_pk_fma_f32 v[94:95], v[148:149], v[126:127], v[94:95] neg_lo:[1,0,0] neg_hi:[1,0,0]
    v_pk_mul_f32 v[80:81], v[80:81], v[150:151]
    v_pk_mul_f32 v[82:83], v[82:83], v[150:151]
    v_pk_mul_f32 v[84:85], v[84:85], v[150:151]
    v_pk_mul_f32 v[86:87], v[86:87], v[150:151]
    v_pk_mul_f32 v[88:89], v[88:89], v[150:151]
    v_pk_mul_f32 v[90:91], v[90:91], v[150:151]
    v_pk_mul_f32 v[92:93], v[92:93], v[150:151]
    v_pk_mul_f32 v[94:95], v[94:95], v[150:151]
    v_cvt_pk_bf16_f32 v136, v80, v81
    v_cvt_pk_bf16_f32 v137, v82, v83
    v_cvt_pk_bf16_f32 v138, v84, v85
    v_cvt_pk_bf16_f32 v139, v86, v87
    v_cvt_pk_bf16_f32 v140, v88, v89
    v_cvt_pk_bf16_f32 v141, v90, v91
    v_cvt_pk_bf16_f32 v142, v92, v93
    v_cvt_pk_bf16_f32 v143, v94, v95
    v_pk_max_i16 v136, v136, v29
    v_pk_max_i16 v137, v137, v29
    v_pk_max_i16 v138, v138, v29
    v_pk_max_i16 v139, v139, v29
    v_pk_max_i16 v140, v140, v29
    v_pk_max_i16 v141, v141, v29
    v_pk_max_i16 v142, v142, v29
    v_pk_max_i16 v143, v143, v29
    ds_write_b64 v26, v[136:137] offset:8768
    ds_write_b64 v26, v[138:139] offset:8784
    ds_write_b64 v26, v[140:141] offset:8800
    ds_write_b64 v26, v[142:143] offset:8816
    s_waitcnt lgkmcnt(0)
    s_barrier
    ds_read_b128 v[32:35], v31 offset:0
    ds_read_b128 v[36:39], v31 offset:4352
    ds_read_b128 v[40:43], v31 offset:8704
    ds_read_b128 v[44:47], v31 offset:13056
    ds_read_b128 v[48:51], v31 offset:17408
    ds_read_b128 v[52:55], v31 offset:21760
    ds_read_b128 v[56:59], v31 offset:26112
    ds_read_b128 v[60:63], v31 offset:30464
    s_waitcnt lgkmcnt(7)
    buffer_store_dwordx4 v[32:35], v27, s[32:35], s48 offen sc0 sc1
    s_add_u32 s48, s48, 57344
    s_waitcnt lgkmcnt(6)
    buffer_store_dwordx4 v[36:39], v27, s[32:35], s48 offen sc0 sc1
    s_add_u32 s48, s48, 57344
    s_waitcnt lgkmcnt(5)
    buffer_store_dwordx4 v[40:43], v27, s[32:35], s48 offen sc0 sc1
    s_add_u32 s48, s48, 57344
    s_waitcnt lgkmcnt(4)
    buffer_store_dwordx4 v[44:47], v27, s[32:35], s48 offen sc0 sc1
    s_add_u32 s48, s48, 57344
    s_waitcnt lgkmcnt(3)
    buffer_store_dwordx4 v[48:51], v27, s[32:35], s48 offen sc0 sc1
    s_add_u32 s48, s48, 57344
    s_waitcnt lgkmcnt(2)
    buffer_store_dwordx4 v[52:55], v27, s[32:35], s48 offen sc0 sc1
    s_add_u32 s48, s48, 57344
    s_waitcnt lgkmcnt(1)
    buffer_store_dwordx4 v[56:59], v27, s[32:35], s48 offen sc0 sc1
    s_add_u32 s48, s48, 57344
    s_waitcnt lgkmcnt(0)
    buffer_store_dwordx4 v[60:63], v27, s[32:35], s48 offen sc0 sc1
gemm1b_kernel_end:
    s_endpgm
.text
.globl gemm2b_kernel
.p2align 8
.type gemm2b_kernel,@function
gemm2b_kernel:
    s_load_dwordx16 s[4:19], s[0:1], 0
    s_load_dwordx8 s[20:27], s[0:1], 64
    s_load_dwordx2 s[28:29], s[0:1], 96
    s_cmp_ge_u32 s2, 256
    s_cbranch_scc1 gemm2b_kernel_end
    v_and_b32 v1, 63, v0
    v_lshrrev_b32 v2, 6, v0
    v_lshrrev_b32 v3, 4, v1
    v_lshrrev_b32 v4, 3, v1
    v_readfirstlane_b32 s42, v2
    v_and_b32 v2, 3, v2
    s_and_b32 s3, s2, 7
    s_lshl_b32 s3, s3, 2
    s_lshr_b32 s40, s2, 3
    s_and_b32 s41, s40, 3
    s_add_u32 s40, s3, s41
    s_lshr_b32 s41, s2, 5
    s_lshl_b32 s47, s41, 18
    s_lshl_b32 s48, s40, 7
    s_add_u32 s47, s47, s48
    s_waitcnt lgkmcnt(0)
    s_mov_b32 s32, s28
    s_mov_b32 s33, s29
    s_mov_b32 s34, 268435456
    s_mov_b32 s35, 0x00020000
    s_cmp_lt_u32 s42, 4
    s_cbranch_scc1 gemm2b_kernel_compute
    s_mov_b32 s36, s22
    s_mov_b32 s37, s23
    s_mov_b32 s38, 1835008
    s_mov_b32 s39, 0x00020000
    s_and_b32 s42, s42, 3
    v_and_b32 v5, 7, v1
    v_lshrrev_b32 v6, 1, v4
    v_and_b32 v6, 1, v6
    v_lshlrev_b32 v6, 2, v6
    v_xor_b32 v5, v5, v6
    v_lshl_add_u32 v6, v2, 5, v4
    v_lshlrev_b32 v6, 10, v6
    v_lshl_add_u32 v6, v5, 4, v6
    v_lshl_add_u32 v7, v2, 2, v3
    v_and_b32 v5, 15, v1
    v_xor_b32 v5, v5, v7
    v_mul_u32_u24 v7, 3584, v7
    v_lshl_add_u32 v7, v5, 4, v7
    s_lshl_b32 s43, s41, 7
    s_mul_i32 s44, s40, 229376
    s_add_u32 s44, s44, 8388608
    s_lshl_b32 s45, s42, 12
    s_lshl_b32 s46, s42, 10
    s_add_u32 s50, s44, 0
    s_add_u32 m0, s46, 16384
    s_nop 0
    buffer_load_dwordx4 v7, s[32:35], s50 offen lds
    s_add_u32 s50, s44, 57344
    s_add_u32 m0, s46, 20480
    s_nop 0
    buffer_load_dwordx4 v7, s[32:35], s50 offen lds
    s_add_u32 s50, s44, 114688
    s_add_u32 m0, s46, 24576
    s_nop 0
    buffer_load_dwordx4 v7, s[32:35], s50 offen lds
    s_add_u32 s50, s44, 172032
    s_add_u32 m0, s46, 28672
    s_nop 0
    buffer_load_dwordx4 v7, s[32:35], s50 offen lds
    s_add_u32 s50, s43, 0
    s_add_u32 m0, s45, 0
    s_nop 0
    buffer_load_dwordx4 v6, s[36:39], s50 offen lds
    s_add_u32 s50, s43, 8192
    s_add_u32 m0, s45, 1024
    s_nop 0
    buffer_load_dwordx4 v6, s[36:39], s50 offen lds
    s_add_u32 s50, s43, 16384
    s_add_u32 m0, s45, 2048
    s_nop 0
    buffer_load_dwordx4 v6, s[36:39], s50 offen lds
    s_add_u32 s50, s43, 24576
    s_add_u32 m0, s45, 3072
    s_nop 0
    buffer_load_dwordx4 v6, s[36:39], s50 offen lds
    s_add_u32 s50, s44, 256
    s_add_u32 m0, s46, 49152
    s_nop 0
    buffer_load_dwordx4 v7, s[32:35], s50 offen lds
    s_add_u32 s50, s44, 57600
    s_add_u32 m0, s46, 53248
    s_nop 0
    buffer_load_dwordx4 v7, s[32:35], s50 offen lds
    s_add_u32 s50, s44, 114944
    s_add_u32 m0, s46, 57344
    s_nop 0
    buffer_load_dwordx4 v7, s[32:35], s50 offen lds
    s_add_u32 s50, s44, 172288
    s_add_u32 m0, s46, 61440
    s_nop 0
    buffer_load_dwordx4 v7, s[32:35], s50 offen lds
    s_add_u32 s50, s43, 131072
    s_add_u32 m0, s45, 32768
    s_nop 0
    buffer_load_dwordx4 v6, s[36:39], s50 offen lds
    s_add_u32 s50, s43, 139264
    s_add_u32 m0, s45, 33792
    s_nop 0
    buffer_load_dwordx4 v6, s[36:39], s50 offen lds
    s_add_u32 s50, s43, 147456
    s_add_u32 m0, s45, 34816
    s_nop 0
    buffer_load_dwordx4 v6, s[36:39], s50 offen lds
    s_add_u32 s50, s43, 155648
    s_add_u32 m0, s45, 35840
    s_nop 0
    buffer_load_dwordx4 v6, s[36:39], s50 offen lds
    s_add_u32 s50, s44, 512
    s_add_u32 m0, s46, 81920
    s_nop 0
    buffer_load_dwordx4 v7, s[32:35], s50 offen lds
    s_add_u32 s50, s44, 57856
    s_add_u32 m0, s46, 86016
    s_nop 0
    buffer_load_dwordx4 v7, s[32:35], s50 offen lds
    s_add_u32 s50, s44, 115200
    s_add_u32 m0, s46, 90112
    s_nop 0
    buffer_load_dwordx4 v7, s[32:35], s50 offen lds
    s_add_u32 s50, s44, 172544
    s_add_u32 m0, s46, 94208
    s_nop 0
    buffer_load_dwordx4 v7, s[32:35], s50 offen lds
    s_add_u32 s50, s43, 262144
    s_add_u32 m0, s45, 65536
    s_nop 0
    buffer_load_dwordx4 v6, s[36:39], s50 offen lds
    s_add_u32 s50, s43, 270336
    s_add_u32 m0, s45, 66560
    s_nop 0
    buffer_load_dwordx4 v6, s[36:39], s50 offen lds
    s_add_u32 s50, s43, 278528
    s_add_u32 m0, s45, 67584
    s_nop 0
    buffer_load_dwordx4 v6, s[36:39], s50 offen lds
    s_add_u32 s50, s43, 286720
    s_add_u32 m0, s45, 68608
    s_nop 0
    buffer_load_dwordx4 v6, s[36:39], s50 offen lds
    v_lshl_add_u32 v8, v2, 4, v4
    v_lshlrev_b32 v8, 12, v8
    v_and_b32 v5, 7, v1
    v_lshl_add_u32 v8, v5, 4, v8
    s_add_u32 s48, s47, 6291456
    s_lshl_b32 s49, s42, 11
    s_add_u32 m0, s49, 131072
    s_nop 0
    buffer_load_dwordx4 v8, s[32:35], s48 offen lds
    s_add_u32 s48, s48, 32768
    s_add_u32 m0, s49, 132096
    s_nop 0
    buffer_load_dwordx4 v8, s[32:35], s48 offen lds
    s_waitcnt vmcnt(18)
    s_barrier
    s_add_u32 s50, s44, 768
    s_add_u32 m0, s46, 114688
    s_nop 0
    buffer_load_dwordx4 v7, s[32:35], s50 offen lds
    s_add_u32 s50, s44, 58112
    s_add_u32 m0, s46, 118784
    s_nop 0
    buffer_load_dwordx4 v7, s[32:35], s50 offen lds
    s_add_u32 s50, s44, 115456
    s_add_u32 m0, s46, 122880
    s_nop 0
    buffer_load_dwordx4 v7, s[32:35], s50 offen lds
    s_add_u32 s50, s44, 172800
    s_add_u32 m0, s46, 126976
    s_nop 0
    buffer_load_dwordx4 v7, s[32:35], s50 offen lds
    s_add_u32 s50, s43, 393216
    s_add_u32 m0, s45, 98304
    s_nop 0
    buffer_load_dwordx4 v6, s[36:39], s50 offen lds
    s_add_u32 s50, s43, 401408
    s_add_u32 m0, s45, 99328
    s_nop 0
    buffer_load_dwordx4 v6, s[36:39], s50 offen lds
    s_add_u32 s50, s43, 409600
    s_add_u32 m0, s45, 100352
    s_nop 0
    buffer_load_dwordx4 v6, s[36:39], s50 offen lds
    s_add_u32 s50, s43, 417792
    s_add_u32 m0, s45, 101376
    s_nop 0
    buffer_load_dwordx4 v6, s[36:39], s50 offen lds
    s_waitcnt vmcnt(18)
    s_barrier
    s_add_u32 s50, s44, 1024
    s_add_u32 m0, s46, 16384
    s_nop 0
    buffer_load_dwordx4 v7, s[32:35], s50 offen lds
    s_add_u32 s50, s44, 58368
    s_add_u32 m0, s46, 20480
    s_nop 0
    buffer_load_dwordx4 v7, s[32:35], s50 offen lds
    s_add_u32 s50, s44, 115712
    s_add_u32 m0, s46, 24576
    s_nop 0
    buffer_load_dwordx4 v7, s[32:35], s50 offen lds
    s_add_u32 s50, s44, 173056
    s_add_u32 m0, s46, 28672
    s_nop 0
    buffer_load_dwordx4 v7, s[32:35], s50 offen lds
    s_add_u32 s50, s43, 524288
    s_add_u32 m0, s45, 0
    s_nop 0
    buffer_load_dwordx4 v6, s[36:39], s50 offen lds
    s_add_u32 s50, s43, 532480
    s_add_u32 m0, s45, 1024
    s_nop 0
    buffer_load_dwordx4 v6, s[36:39], s50 offen lds
    s_add_u32 s50, s43, 540672
    s_add_u32 m0, s45, 2048
    s_nop 0
    buffer_load_dwordx4 v6, s[36:39], s50 offen lds
    s_add_u32 s50, s43, 548864
    s_add_u32 m0, s45, 3072
    s_nop 0
    buffer_load_dwordx4 v6, s[36:39], s50 offen lds
    s_waitcnt vmcnt(18)
    s_barrier
    s_add_u32 s50, s44, 1280
    s_add_u32 m0, s46, 49152
    s_nop 0
    buffer_load_dwordx4 v7, s[32:35], s50 offen lds
    s_add_u32 s50, s44, 58624
    s_add_u32 m0, s46, 53248
    s_nop 0
    buffer_load_dwordx4 v7, s[32:35], s50 offen lds
    s_add_u32 s50, s44, 115968
    s_add_u32 m0, s46, 57344
    s_nop 0
    buffer_load_dwordx4 v7, s[32:35], s50 offen lds
    s_add_u32 s50, s44, 173312
    s_add_u32 m0, s46, 61440
    s_nop 0
    buffer_load_dwordx4 v7, s[32:35], s50 offen lds
    s_add_u32 s50, s43, 655360
    s_add_u32 m0, s45, 32768
    s_nop 0
    buffer_load_dwordx4 v6, s[36:39], s50 offen lds
    s_add_u32 s50, s43, 663552
    s_add_u32 m0, s45, 33792
    s_nop 0
    buffer_load_dwordx4 v6, s[36:39], s50 offen lds
    s_add_u32 s50, s43, 671744
    s_add_u32 m0, s45, 34816
    s_nop 0
    buffer_load_dwordx4 v6, s[36:39], s50 offen lds
    s_add_u32 s50, s43, 679936
    s_add_u32 m0, s45, 35840
    s_nop 0
    buffer_load_dwordx4 v6, s[36:39], s50 offen lds
    s_waitcnt vmcnt(16)
    s_barrier
    s_add_u32 s50, s44, 1536
    s_add_u32 m0, s46, 81920
    s_nop 0
    buffer_load_dwordx4 v7, s[32:35], s50 offen lds
    s_add_u32 s50, s44, 58880
    s_add_u32 m0, s46, 86016
    s_nop 0
    buffer_load_dwordx4 v7, s[32:35], s50 offen lds
    s_add_u32 s50, s44, 116224
    s_add_u32 m0, s46, 90112
    s_nop 0
    buffer_load_dwordx4 v7, s[32:35], s50 offen lds
    s_add_u32 s50, s44, 173568
    s_add_u32 m0, s46, 94208
    s_nop 0
    buffer_load_dwordx4 v7, s[32:35], s50 offen lds
    s_add_u32 s50, s43, 786432
    s_add_u32 m0, s45, 65536
    s_nop 0
    buffer_load_dwordx4 v6, s[36:39], s50 offen lds
    s_add_u32 s50, s43, 794624
    s_add_u32 m0, s45, 66560
    s_nop 0
    buffer_load_dwordx4 v6, s[36:39], s50 offen lds
    s_add_u32 s50, s43, 802816
    s_add_u32 m0, s45, 67584
    s_nop 0
    buffer_load_dwordx4 v6, s[36:39], s50 offen lds
    s_add_u32 s50, s43, 811008
    s_add_u32 m0, s45, 68608
    s_nop 0
    buffer_load_dwordx4 v6, s[36:39], s50 offen lds
    s_waitcnt vmcnt(16)
    s_barrier
    s_add_u32 s50, s44, 1792
    s_add_u32 m0, s46, 114688
    s_nop 0
    buffer_load_dwordx4 v7, s[32:35], s50 offen lds
    s_add_u32 s50, s44, 59136
    s_add_u32 m0, s46, 118784
    s_nop 0
    buffer_load_dwordx4 v7, s[32:35], s50 offen lds
    s_add_u32 s50, s44, 116480
    s_add_u32 m0, s46, 122880
    s_nop 0
    buffer_load_dwordx4 v7, s[32:35], s50 offen lds
    s_add_u32 s50, s44, 173824
    s_add_u32 m0, s46, 126976
    s_nop 0
    buffer_load_dwordx4 v7, s[32:35], s50 offen lds
    s_add_u32 s50, s43, 917504
    s_add_u32 m0, s45, 98304
    s_nop 0
    buffer_load_dwordx4 v6, s[36:39], s50 offen lds
    s_add_u32 s50, s43, 925696
    s_add_u32 m0, s45, 99328
    s_nop 0
    buffer_load_dwordx4 v6, s[36:39], s50 offen lds
    s_add_u32 s50, s43, 933888
    s_add_u32 m0, s45, 100352
    s_nop 0
    buffer_load_dwordx4 v6, s[36:39], s50 offen lds
    s_add_u32 s50, s43, 942080
    s_add_u32 m0, s45, 101376
    s_nop 0
    buffer_load_dwordx4 v6, s[36:39], s50 offen lds
    s_waitcnt vmcnt(16)
    s_barrier
    s_add_u32 s50, s44, 2048
    s_add_u32 m0, s46, 16384
    s_nop 0
    buffer_load_dwordx4 v7, s[32:35], s50 offen lds
    s_add_u32 s50, s44, 59392
    s_add_u32 m0, s46, 20480
    s_nop 0
    buffer_load_dwordx4 v7, s[32:35], s50 offen lds
    s_add_u32 s50, s44, 116736
    s_add_u32 m0, s46, 24576
    s_nop 0
    buffer_load_dwordx4 v7, s[32:35], s50 offen lds
    s_add_u32 s50, s44, 174080
    s_add_u32 m0, s46, 28672
    s_nop 0
    buffer_load_dwordx4 v7, s[32:35], s50 offen lds
    s_add_u32 s50, s43, 1048576
    s_add_u32 m0, s45, 0
    s_nop 0
    buffer_load_dwordx4 v6, s[36:39], s50 offen lds
    s_add_u32 s50, s43, 1056768
    s_add_u32 m0, s45, 1024
    s_nop 0
    buffer_load_dwordx4 v6, s[36:39], s50 offen lds
    s_add_u32 s50, s43, 1064960
    s_add_u32 m0, s45, 2048
    s_nop 0
    buffer_load_dwordx4 v6, s[36:39], s50 offen lds
    s_add_u32 s50, s43, 1073152
    s_add_u32 m0, s45, 3072
    s_nop 0
    buffer_load_dwordx4 v6, s[36:39], s50 offen lds
    s_waitcnt vmcnt(16)
    s_barrier
    s_add_u32 s50, s44, 2304
    s_add_u32 m0, s46, 49152
    s_nop 0
    buffer_load_dwordx4 v7, s[32:35], s50 offen lds
    s_add_u32 s50, s44, 59648
    s_add_u32 m0, s46, 53248
    s_nop 0
    buffer_load_dwordx4 v7, s[32:35], s50 offen lds
    s_add_u32 s50, s44, 116992
    s_add_u32 m0, s46, 57344
    s_nop 0
    buffer_load_dwordx4 v7, s[32:35], s50 offen lds
    s_add_u32 s50, s44, 174336
    s_add_u32 m0, s46, 61440
    s_nop 0
    buffer_load_dwordx4 v7, s[32:35], s50 offen lds
    s_add_u32 s50, s43, 1179648
    s_add_u32 m0, s45, 32768
    s_nop 0
    buffer_load_dwordx4 v6, s[36:39], s50 offen lds
    s_add_u32 s50, s43, 1187840
    s_add_u32 m0, s45, 33792
    s_nop 0
    buffer_load_dwordx4 v6, s[36:39], s50 offen lds
    s_add_u32 s50, s43, 1196032
    s_add_u32 m0, s45, 34816
    s_nop 0
    buffer_load_dwordx4 v6, s[36:39], s50 offen lds
    s_add_u32 s50, s43, 1204224
    s_add_u32 m0, s45, 35840
    s_nop 0
    buffer_load_dwordx4 v6, s[36:39], s50 offen lds
    s_waitcnt vmcnt(16)
    s_barrier
    s_add_u32 s50, s44, 2560
    s_add_u32 m0, s46, 81920
    s_nop 0
    buffer_load_dwordx4 v7, s[32:35], s50 offen lds
    s_add_u32 s50, s44, 59904
    s_add_u32 m0, s46, 86016
    s_nop 0
    buffer_load_dwordx4 v7, s[32:35], s50 offen lds
    s_add_u32 s50, s44, 117248
    s_add_u32 m0, s46, 90112
    s_nop 0
    buffer_load_dwordx4 v7, s[32:35], s50 offen lds
    s_add_u32 s50, s44, 174592
    s_add_u32 m0, s46, 94208
    s_nop 0
    buffer_load_dwordx4 v7, s[32:35], s50 offen lds
    s_add_u32 s50, s43, 1310720
    s_add_u32 m0, s45, 65536
    s_nop 0
    buffer_load_dwordx4 v6, s[36:39], s50 offen lds
    s_add_u32 s50, s43, 1318912
    s_add_u32 m0, s45, 66560
    s_nop 0
    buffer_load_dwordx4 v6, s[36:39], s50 offen lds
    s_add_u32 s50, s43, 1327104
    s_add_u32 m0, s45, 67584
    s_nop 0
    buffer_load_dwordx4 v6, s[36:39], s50 offen lds
    s_add_u32 s50, s43, 1335296
    s_add_u32 m0, s45, 68608
    s_nop 0
    buffer_load_dwordx4 v6, s[36:39], s50 offen lds
    s_waitcnt vmcnt(16)
    s_barrier
    s_add_u32 s50, s44, 2816
    s_add_u32 m0, s46, 114688
    s_nop 0
    buffer_load_dwordx4 v7, s[32:35], s50 offen lds
    s_add_u32 s50, s44, 60160
    s_add_u32 m0, s46, 118784
    s_nop 0
    buffer_load_dwordx4 v7, s[32:35], s50 offen lds
    s_add_u32 s50, s44, 117504
    s_add_u32 m0, s46, 122880
    s_nop 0
    buffer_load_dwordx4 v7, s[32:35], s50 offen lds
    s_add_u32 s50, s44, 174848
    s_add_u32 m0, s46, 126976
    s_nop 0
    buffer_load_dwordx4 v7, s[32:35], s50 offen lds
    s_add_u32 s50, s43, 1441792
    s_add_u32 m0, s45, 98304
    s_nop 0
    buffer_load_dwordx4 v6, s[36:39], s50 offen lds
    s_add_u32 s50, s43, 1449984
    s_add_u32 m0, s45, 99328
    s_nop 0
    buffer_load_dwordx4 v6, s[36:39], s50 offen lds
    s_add_u32 s50, s43, 1458176
    s_add_u32 m0, s45, 100352
    s_nop 0
    buffer_load_dwordx4 v6, s[36:39], s50 offen lds
    s_add_u32 s50, s43, 1466368
    s_add_u32 m0, s45, 101376
    s_nop 0
    buffer_load_dwordx4 v6, s[36:39], s50 offen lds
    s_waitcnt vmcnt(16)
    s_barrier
    s_add_u32 s50, s44, 3072
    s_add_u32 m0, s46, 16384
    s_nop 0
    buffer_load_dwordx4 v7, s[32:35], s50 offen lds
    s_add_u32 s50, s44, 60416
    s_add_u32 m0, s46, 20480
    s_nop 0
    buffer_load_dwordx4 v7, s[32:35], s50 offen lds
    s_add_u32 s50, s44, 117760
    s_add_u32 m0, s46, 24576
    s_nop 0
    buffer_load_dwordx4 v7, s[32:35], s50 offen lds
    s_add_u32 s50, s44, 175104
    s_add_u32 m0, s46, 28672
    s_nop 0
    buffer_load_dwordx4 v7, s[32:35], s50 offen lds
    s_add_u32 s50, s43, 1572864
    s_add_u32 m0, s45, 0
    s_nop 0
    buffer_load_dwordx4 v6, s[36:39], s50 offen lds
    s_add_u32 s50, s43, 1581056
    s_add_u32 m0, s45, 1024
    s_nop 0
    buffer_load_dwordx4 v6, s[36:39], s50 offen lds
    s_add_u32 s50, s43, 1589248
    s_add_u32 m0, s45, 2048
    s_nop 0
    buffer_load_dwordx4 v6, s[36:39], s50 offen lds
    s_add_u32 s50, s43, 1597440
    s_add_u32 m0, s45, 3072
    s_nop 0
    buffer_load_dwordx4 v6, s[36:39], s50 offen lds
    s_waitcnt vmcnt(16)
    s_barrier
    s_add_u32 s50, s44, 3328
    s_add_u32 m0, s46, 49152
    s_nop 0
    buffer_load_dwordx4 v7, s[32:35], s50 offen lds
    s_add_u32 s50, s44, 60672
    s_add_u32 m0, s46, 53248
    s_nop 0
    buffer_load_dwordx4 v7, s[32:35], s50 offen lds
    s_add_u32 s50, s44, 118016
    s_add_u32 m0, s46, 57344
    s_nop 0
    buffer_load_dwordx4 v7, s[32:35], s50 offen lds
    s_add_u32 s50, s44, 175360
    s_add_u32 m0, s46, 61440
    s_nop 0
    buffer_load_dwordx4 v7, s[32:35], s50 offen lds
    s_add_u32 s50, s43, 1703936
    s_add_u32 m0, s45, 32768
    s_nop 0
    buffer_load_dwordx4 v6, s[36:39], s50 offen lds
    s_add_u32 s50, s43, 1712128
    s_add_u32 m0, s45, 33792
    s_nop 0
    buffer_load_dwordx4 v6, s[36:39], s50 offen lds
    s_add_u32 s50, s43, 1720320
    s_add_u32 m0, s45, 34816
    s_nop 0
    buffer_load_dwordx4 v6, s[36:39], s50 offen lds
    s_add_u32 s50, s43, 1728512
    s_add_u32 m0, s45, 35840
    s_nop 0
    buffer_load_dwordx4 v6, s[36:39], s50 offen lds
    s_waitcnt vmcnt(16)
    s_barrier
    s_waitcnt vmcnt(8)
    s_barrier
    s_waitcnt vmcnt(0)
    s_barrier
    s_endpgm
gemm2b_kernel_compute:
    s_mov_b32 s56, s24
    s_mov_b32 s57, s25
    s_mov_b32 s58, 2097152
    s_mov_b32 s59, 0x00020000
    v_and_b32 v9, 1, v2
    v_lshrrev_b32 v10, 1, v2
    v_lshrrev_b32 v11, 5, v1
    v_lshrrev_b32 v12, 2, v1
    v_and_b32 v12, 3, v12
    v_and_b32 v13, 3, v1
    v_lshrrev_b32 v14, 1, v3
    v_lshl_add_u32 v14, v14, 3, v12
    v_lshlrev_b32 v14, 7, v14
    v_lshrrev_b32 v15, 1, v12
    v_xor_b32 v15, v15, v9
    v_lshl_add_u32 v14, v15, 6, v14
    v_and_b32 v15, 1, v3
    v_lshl_add_u32 v14, v15, 5, v14
    v_lshrrev_b32 v15, 1, v13
    v_lshl_add_u32 v14, v15, 4, v14
    v_and_b32 v15, 1, v13
    v_lshl_add_u32 v16, v15, 3, v14
    v_add_u32 v17, 0x10000, v16
    v_and_b32 v18, 31, v1
    v_lshl_add_u32 v14, v10, 5, v18
    v_lshlrev_b32 v14, 8, v14
    v_and_b32 v15, 15, v18
    v_xor_b32 v15, v15, v11
    v_lshl_add_u32 v14, v15, 4, v14
    v_add_u32 v14, 0x4000, v14
    v_xor_b32 v20, 0, v14
    v_add_u32 v28, 0x10000, v20
    v_xor_b32 v21, 32, v14
    v_add_u32 v29, 0x10000, v21
    v_xor_b32 v22, 64, v14
    v_add_u32 v30, 0x10000, v22
    v_xor_b32 v23, 96, v14
    v_add_u32 v31, 0x10000, v23
    v_xor_b32 v24, 128, v14
    v_add_u32 v32, 0x10000, v24
    v_xor_b32 v25, 160, v14
    v_add_u32 v33, 0x10000, v25
    v_xor_b32 v26, 192, v14
    v_add_u32 v34, 0x10000, v26
    v_xor_b32 v27, 224, v14
    v_add_u32 v35, 0x10000, v27
    v_mov_b32 v64, 0
    v_mov_b32 v65, 0
    v_mov_b32 v66, 0
    v_mov_b32 v67, 0
    v_mov_b32 v68, 0
    v_mov_b32 v69, 0
    v_mov_b32 v70, 0
    v_mov_b32 v71, 0
    v_mov_b32 v72, 0
    v_mov_b32 v73, 0
    v_mov_b32 v74, 0
    v_mov_b32 v75, 0
    v_mov_b32 v76, 0
    v_mov_b32 v77, 0
    v_mov_b32 v78, 0
    v_mov_b32 v79, 0
    s_barrier
    ds_read_b64_tr_b16 v[96:97], v16 offset:0
    ds_read_b64_tr_b16 v[98:99], v16 offset:512
    ds_read_b128 v[100:103], v20 offset:0
    ds_read_b64_tr_b16 v[104:105], v16 offset:2048
    ds_read_b64_tr_b16 v[106:107], v16 offset:2560
    ds_read_b128 v[108:111], v21 offset:0
    ds_read_b64_tr_b16 v[112:113], v16 offset:4096
    ds_read_b64_tr_b16 v[114:115], v16 offset:4608
    ds_read_b128 v[116:119], v22 offset:0
    s_waitcnt lgkmcnt(6)
    v_mfma_f32_32x32x16_bf16 v[64:79], v[96:99], v[100:103], v[64:79]
    ds_read_b64_tr_b16 v[120:121], v16 offset:6144
    ds_read_b64_tr_b16 v[122:123], v16 offset:6656
    ds_read_b128 v[124:127], v23 offset:0
    s_waitcnt lgkmcnt(6)
    v_mfma_f32_32x32x16_bf16 v[64:79], v[104:107], v[108:111], v[64:79]
    ds_read_b64_tr_b16 v[96:97], v16 offset:8192
    ds_read_b64_tr_b16 v[98:99], v16 offset:8704
    ds_read_b128 v[100:103], v24 offset:0
    s_waitcnt lgkmcnt(6)
    v_mfma_f32_32x32x16_bf16 v[64:79], v[112:115], v[116:119], v[64:79]
    ds_read_b64_tr_b16 v[104:105], v16 offset:10240
    ds_read_b64_tr_b16 v[106:107], v16 offset:10752
    ds_read_b128 v[108:111], v25 offset:0
    s_waitcnt lgkmcnt(6)
    v_mfma_f32_32x32x16_bf16 v[64:79], v[120:123], v[124:127], v[64:79]
    ds_read_b64_tr_b16 v[112:113], v16 offset:12288
    ds_read_b64_tr_b16 v[114:115], v16 offset:12800
    ds_read_b128 v[116:119], v26 offset:0
    s_waitcnt lgkmcnt(6)
    v_mfma_f32_32x32x16_bf16 v[64:79], v[96:99], v[100:103], v[64:79]
    ds_read_b64_tr_b16 v[120:121], v16 offset:14336
    ds_read_b64_tr_b16 v[122:123], v16 offset:14848
    ds_read_b128 v[124:127], v27 offset:0
    s_waitcnt lgkmcnt(6)
    v_mfma_f32_32x32x16_bf16 v[64:79], v[104:107], v[108:111], v[64:79]
    s_waitcnt lgkmcnt(3)
    v_mfma_f32_32x32x16_bf16 v[64:79], v[112:115], v[116:119], v[64:79]
    s_waitcnt lgkmcnt(0)
    v_mfma_f32_32x32x16_bf16 v[64:79], v[120:123], v[124:127], v[64:79]
    s_barrier
    ds_read_b64_tr_b16 v[96:97], v16 offset:32768
    ds_read_b64_tr_b16 v[98:99], v16 offset:33280
    ds_read_b128 v[100:103], v20 offset:32768
    ds_read_b64_tr_b16 v[104:105], v16 offset:34816
    ds_read_b64_tr_b16 v[106:107], v16 offset:35328
    ds_read_b128 v[108:111], v21 offset:32768
    ds_read_b64_tr_b16 v[112:113], v16 offset:36864
    ds_read_b64_tr_b16 v[114:115], v16 offset:37376
    ds_read_b128 v[116:119], v22 offset:32768
    s_waitcnt lgkmcnt(6)
    v_mfma_f32_32x32x16_bf16 v[64:79], v[96:99], v[100:103], v[64:79]
    ds_read_b64_tr_b16 v[120:121], v16 offset:38912
    ds_read_b64_tr_b16 v[122:123], v16 offset:39424
    ds_read_b128 v[124:127], v23 offset:32768
    s_waitcnt lgkmcnt(6)
    v_mfma_f32_32x32x16_bf16 v[64:79], v[104:107], v[108:111], v[64:79]
    ds_read_b64_tr_b16 v[96:97], v16 offset:40960
    ds_read_b64_tr_b16 v[98:99], v16 offset:41472
    ds_read_b128 v[100:103], v24 offset:32768
    s_waitcnt lgkmcnt(6)
    v_mfma_f32_32x32x16_bf16 v[64:79], v[112:115], v[116:119], v[64:79]
    ds_read_b64_tr_b16 v[104:105], v16 offset:43008
    ds_read_b64_tr_b16 v[106:107], v16 offset:43520
    ds_read_b128 v[108:111], v25 offset:32768
    s_waitcnt lgkmcnt(6)
    v_mfma_f32_32x32x16_bf16 v[64:79], v[120:123], v[124:127], v[64:79]
    ds_read_b64_tr_b16 v[112:113], v16 offset:45056
    ds_read_b64_tr_b16 v[114:115], v16 offset:45568
    ds_read_b128 v[116:119], v26 offset:32768
    s_waitcnt lgkmcnt(6)
    v_mfma_f32_32x32x16_bf16 v[64:79], v[96:99], v[100:103], v[64:79]
    ds_read_b64_tr_b16 v[120:121], v16 offset:47104
    ds_read_b64_tr_b16 v[122:123], v16 offset:47616
    ds_read_b128 v[124:127], v27 offset:32768
    s_waitcnt lgkmcnt(6)
    v_mfma_f32_32x32x16_bf16 v[64:79], v[104:107], v[108:111], v[64:79]
    s_waitcnt lgkmcnt(3)
    v_mfma_f32_32x32x16_bf16 v[64:79], v[112:115], v[116:119], v[64:79]
    s_waitcnt lgkmcnt(0)
    v_mfma_f32_32x32x16_bf16 v[64:79], v[120:123], v[124:127], v[64:79]
    s_barrier
    ds_read_b64_tr_b16 v[96:97], v17 offset:0
    ds_read_b64_tr_b16 v[98:99], v17 offset:512
    ds_read_b128 v[100:103], v28 offset:0
    ds_read_b64_tr_b16 v[104:105], v17 offset:2048
    ds_read_b64_tr_b16 v[106:107], v17 offset:2560
    ds_read_b128 v[108:111], v29 offset:0
    ds_read_b64_tr_b16 v[112:113], v17 offset:4096
    ds_read_b64_tr_b16 v[114:115], v17 offset:4608
    ds_read_b128 v[116:119], v30 offset:0
    s_waitcnt lgkmcnt(6)
    v_mfma_f32_32x32x16_bf16 v[64:79], v[96:99], v[100:103], v[64:79]
    ds_read_b64_tr_b16 v[120:121], v17 offset:6144
    ds_read_b64_tr_b16 v[122:123], v17 offset:6656
    ds_read_b128 v[124:127], v31 offset:0
    s_waitcnt lgkmcnt(6)
    v_mfma_f32_32x32x16_bf16 v[64:79], v[104:107], v[108:111], v[64:79]
    ds_read_b64_tr_b16 v[96:97], v17 offset:8192
    ds_read_b64_tr_b16 v[98:99], v17 offset:8704
    ds_read_b128 v[100:103], v32 offset:0
    s_waitcnt lgkmcnt(6)
    v_mfma_f32_32x32x16_bf16 v[64:79], v[112:115], v[116:119], v[64:79]
    ds_read_b64_tr_b16 v[104:105], v17 offset:10240
    ds_read_b64_tr_b16 v[106:107], v17 offset:10752
    ds_read_b128 v[108:111], v33 offset:0
    s_waitcnt lgkmcnt(6)
    v_mfma_f32_32x32x16_bf16 v[64:79], v[120:123], v[124:127], v[64:79]
    ds_read_b64_tr_b16 v[112:113], v17 offset:12288
    ds_read_b64_tr_b16 v[114:115], v17 offset:12800
    ds_read_b128 v[116:119], v34 offset:0
    s_waitcnt lgkmcnt(6)
    v_mfma_f32_32x32x16_bf16 v[64:79], v[96:99], v[100:103], v[64:79]
    ds_read_b64_tr_b16 v[120:121], v17 offset:14336
    ds_read_b64_tr_b16 v[122:123], v17 offset:14848
    ds_read_b128 v[124:127], v35 offset:0
    s_waitcnt lgkmcnt(6)
    v_mfma_f32_32x32x16_bf16 v[64:79], v[104:107], v[108:111], v[64:79]
    s_waitcnt lgkmcnt(3)
    v_mfma_f32_32x32x16_bf16 v[64:79], v[112:115], v[116:119], v[64:79]
    s_waitcnt lgkmcnt(0)
    v_mfma_f32_32x32x16_bf16 v[64:79], v[120:123], v[124:127], v[64:79]
    s_barrier
    ds_read_b64_tr_b16 v[96:97], v17 offset:32768
    ds_read_b64_tr_b16 v[98:99], v17 offset:33280
    ds_read_b128 v[100:103], v28 offset:32768
    ds_read_b64_tr_b16 v[104:105], v17 offset:34816
    ds_read_b64_tr_b16 v[106:107], v17 offset:35328
    ds_read_b128 v[108:111], v29 offset:32768
    ds_read_b64_tr_b16 v[112:113], v17 offset:36864
    ds_read_b64_tr_b16 v[114:115], v17 offset:37376
    ds_read_b128 v[116:119], v30 offset:32768
    s_waitcnt lgkmcnt(6)
    v_mfma_f32_32x32x16_bf16 v[64:79], v[96:99], v[100:103], v[64:79]
    ds_read_b64_tr_b16 v[120:121], v17 offset:38912
    ds_read_b64_tr_b16 v[122:123], v17 offset:39424
    ds_read_b128 v[124:127], v31 offset:32768
    s_waitcnt lgkmcnt(6)
    v_mfma_f32_32x32x16_bf16 v[64:79], v[104:107], v[108:111], v[64:79]
    ds_read_b64_tr_b16 v[96:97], v17 offset:40960
    ds_read_b64_tr_b16 v[98:99], v17 offset:41472
    ds_read_b128 v[100:103], v32 offset:32768
    s_waitcnt lgkmcnt(6)
    v_mfma_f32_32x32x16_bf16 v[64:79], v[112:115], v[116:119], v[64:79]
    ds_read_b64_tr_b16 v[104:105], v17 offset:43008
    ds_read_b64_tr_b16 v[106:107], v17 offset:43520
    ds_read_b128 v[108:111], v33 offset:32768
    s_waitcnt lgkmcnt(6)
    v_mfma_f32_32x32x16_bf16 v[64:79], v[120:123], v[124:127], v[64:79]
    ds_read_b64_tr_b16 v[112:113], v17 offset:45056
    ds_read_b64_tr_b16 v[114:115], v17 offset:45568
    ds_read_b128 v[116:119], v34 offset:32768
    s_waitcnt lgkmcnt(6)
    v_mfma_f32_32x32x16_bf16 v[64:79], v[96:99], v[100:103], v[64:79]
    ds_read_b64_tr_b16 v[120:121], v17 offset:47104
    ds_read_b64_tr_b16 v[122:123], v17 offset:47616
    ds_read_b128 v[124:127], v35 offset:32768
    s_waitcnt lgkmcnt(6)
    v_mfma_f32_32x32x16_bf16 v[64:79], v[104:107], v[108:111], v[64:79]
    s_waitcnt lgkmcnt(3)
    v_mfma_f32_32x32x16_bf16 v[64:79], v[112:115], v[116:119], v[64:79]
    s_waitcnt lgkmcnt(0)
    v_mfma_f32_32x32x16_bf16 v[64:79], v[120:123], v[124:127], v[64:79]
    s_barrier
    ds_read_b64_tr_b16 v[96:97], v16 offset:0
    ds_read_b64_tr_b16 v[98:99], v16 offset:512
    ds_read_b128 v[100:103], v20 offset:0
    ds_read_b64_tr_b16 v[104:105], v16 offset:2048
    ds_read_b64_tr_b16 v[106:107], v16 offset:2560
    ds_read_b128 v[108:111], v21 offset:0
    ds_read_b64_tr_b16 v[112:113], v16 offset:4096
    ds_read_b64_tr_b16 v[114:115], v16 offset:4608
    ds_read_b128 v[116:119], v22 offset:0
    s_waitcnt lgkmcnt(6)
    v_mfma_f32_32x32x16_bf16 v[64:79], v[96:99], v[100:103], v[64:79]
    ds_read_b64_tr_b16 v[120:121], v16 offset:6144
    ds_read_b64_tr_b16 v[122:123], v16 offset:6656
    ds_read_b128 v[124:127], v23 offset:0
    s_waitcnt lgkmcnt(6)
    v_mfma_f32_32x32x16_bf16 v[64:79], v[104:107], v[108:111], v[64:79]
    ds_read_b64_tr_b16 v[96:97], v16 offset:8192
    ds_read_b64_tr_b16 v[98:99], v16 offset:8704
    ds_read_b128 v[100:103], v24 offset:0
    s_waitcnt lgkmcnt(6)
    v_mfma_f32_32x32x16_bf16 v[64:79], v[112:115], v[116:119], v[64:79]
    ds_read_b64_tr_b16 v[104:105], v16 offset:10240
    ds_read_b64_tr_b16 v[106:107], v16 offset:10752
    ds_read_b128 v[108:111], v25 offset:0
    s_waitcnt lgkmcnt(6)
    v_mfma_f32_32x32x16_bf16 v[64:79], v[120:123], v[124:127], v[64:79]
    ds_read_b64_tr_b16 v[112:113], v16 offset:12288
    ds_read_b64_tr_b16 v[114:115], v16 offset:12800
    ds_read_b128 v[116:119], v26 offset:0
    s_waitcnt lgkmcnt(6)
    v_mfma_f32_32x32x16_bf16 v[64:79], v[96:99], v[100:103], v[64:79]
    ds_read_b64_tr_b16 v[120:121], v16 offset:14336
    ds_read_b64_tr_b16 v[122:123], v16 offset:14848
    ds_read_b128 v[124:127], v27 offset:0
    s_waitcnt lgkmcnt(6)
    v_mfma_f32_32x32x16_bf16 v[64:79], v[104:107], v[108:111], v[64:79]
    s_waitcnt lgkmcnt(3)
    v_mfma_f32_32x32x16_bf16 v[64:79], v[112:115], v[116:119], v[64:79]
    s_waitcnt lgkmcnt(0)
    v_mfma_f32_32x32x16_bf16 v[64:79], v[120:123], v[124:127], v[64:79]
    s_barrier
    ds_read_b64_tr_b16 v[96:97], v16 offset:32768
    ds_read_b64_tr_b16 v[98:99], v16 offset:33280
    ds_read_b128 v[100:103], v20 offset:32768
    ds_read_b64_tr_b16 v[104:105], v16 offset:34816
    ds_read_b64_tr_b16 v[106:107], v16 offset:35328
    ds_read_b128 v[108:111], v21 offset:32768
    ds_read_b64_tr_b16 v[112:113], v16 offset:36864
    ds_read_b64_tr_b16 v[114:115], v16 offset:37376
    ds_read_b128 v[116:119], v22 offset:32768
    s_waitcnt lgkmcnt(6)
    v_mfma_f32_32x32x16_bf16 v[64:79], v[96:99], v[100:103], v[64:79]
    ds_read_b64_tr_b16 v[120:121], v16 offset:38912
    ds_read_b64_tr_b16 v[122:123], v16 offset:39424
    ds_read_b128 v[124:127], v23 offset:32768
    s_waitcnt lgkmcnt(6)
    v_mfma_f32_32x32x16_bf16 v[64:79], v[104:107], v[108:111], v[64:79]
    ds_read_b64_tr_b16 v[96:97], v16 offset:40960
    ds_read_b64_tr_b16 v[98:99], v16 offset:41472
    ds_read_b128 v[100:103], v24 offset:32768
    s_waitcnt lgkmcnt(6)
    v_mfma_f32_32x32x16_bf16 v[64:79], v[112:115], v[116:119], v[64:79]
    ds_read_b64_tr_b16 v[104:105], v16 offset:43008
    ds_read_b64_tr_b16 v[106:107], v16 offset:43520
    ds_read_b128 v[108:111], v25 offset:32768
    s_waitcnt lgkmcnt(6)
    v_mfma_f32_32x32x16_bf16 v[64:79], v[120:123], v[124:127], v[64:79]
    ds_read_b64_tr_b16 v[112:113], v16 offset:45056
    ds_read_b64_tr_b16 v[114:115], v16 offset:45568
    ds_read_b128 v[116:119], v26 offset:32768
    s_waitcnt lgkmcnt(6)
    v_mfma_f32_32x32x16_bf16 v[64:79], v[96:99], v[100:103], v[64:79]
    ds_read_b64_tr_b16 v[120:121], v16 offset:47104
    ds_read_b64_tr_b16 v[122:123], v16 offset:47616
    ds_read_b128 v[124:127], v27 offset:32768
    s_waitcnt lgkmcnt(6)
    v_mfma_f32_32x32x16_bf16 v[64:79], v[104:107], v[108:111], v[64:79]
    s_waitcnt lgkmcnt(3)
    v_mfma_f32_32x32x16_bf16 v[64:79], v[112:115], v[116:119], v[64:79]
    s_waitcnt lgkmcnt(0)
    v_mfma_f32_32x32x16_bf16 v[64:79], v[120:123], v[124:127], v[64:79]
    s_barrier
    ds_read_b64_tr_b16 v[96:97], v17 offset:0
    ds_read_b64_tr_b16 v[98:99], v17 offset:512
    ds_read_b128 v[100:103], v28 offset:0
    ds_read_b64_tr_b16 v[104:105], v17 offset:2048
    ds_read_b64_tr_b16 v[106:107], v17 offset:2560
    ds_read_b128 v[108:111], v29 offset:0
    ds_read_b64_tr_b16 v[112:113], v17 offset:4096
    ds_read_b64_tr_b16 v[114:115], v17 offset:4608
    ds_read_b128 v[116:119], v30 offset:0
    s_waitcnt lgkmcnt(6)
    v_mfma_f32_32x32x16_bf16 v[64:79], v[96:99], v[100:103], v[64:79]
    ds_read_b64_tr_b16 v[120:121], v17 offset:6144
    ds_read_b64_tr_b16 v[122:123], v17 offset:6656
    ds_read_b128 v[124:127], v31 offset:0
    s_waitcnt lgkmcnt(6)
    v_mfma_f32_32x32x16_bf16 v[64:79], v[104:107], v[108:111], v[64:79]
    ds_read_b64_tr_b16 v[96:97], v17 offset:8192
    ds_read_b64_tr_b16 v[98:99], v17 offset:8704
    ds_read_b128 v[100:103], v32 offset:0
    s_waitcnt lgkmcnt(6)
    v_mfma_f32_32x32x16_bf16 v[64:79], v[112:115], v[116:119], v[64:79]
    ds_read_b64_tr_b16 v[104:105], v17 offset:10240
    ds_read_b64_tr_b16 v[106:107], v17 offset:10752
    ds_read_b128 v[108:111], v33 offset:0
    s_waitcnt lgkmcnt(6)
    v_mfma_f32_32x32x16_bf16 v[64:79], v[120:123], v[124:127], v[64:79]
    ds_read_b64_tr_b16 v[112:113], v17 offset:12288
    ds_read_b64_tr_b16 v[114:115], v17 offset:12800
    ds_read_b128 v[116:119], v34 offset:0
    s_waitcnt lgkmcnt(6)
    v_mfma_f32_32x32x16_bf16 v[64:79], v[96:99], v[100:103], v[64:79]
    ds_read_b64_tr_b16 v[120:121], v17 offset:14336
    ds_read_b64_tr_b16 v[122:123], v17 offset:14848
    ds_read_b128 v[124:127], v35 offset:0
    s_waitcnt lgkmcnt(6)
    v_mfma_f32_32x32x16_bf16 v[64:79], v[104:107], v[108:111], v[64:79]
    s_waitcnt lgkmcnt(3)
    v_mfma_f32_32x32x16_bf16 v[64:79], v[112:115], v[116:119], v[64:79]
    s_waitcnt lgkmcnt(0)
    v_mfma_f32_32x32x16_bf16 v[64:79], v[120:123], v[124:127], v[64:79]
    s_barrier
    ds_read_b64_tr_b16 v[96:97], v17 offset:32768
    ds_read_b64_tr_b16 v[98:99], v17 offset:33280
    ds_read_b128 v[100:103], v28 offset:32768
    ds_read_b64_tr_b16 v[104:105], v17 offset:34816
    ds_read_b64_tr_b16 v[106:107], v17 offset:35328
    ds_read_b128 v[108:111], v29 offset:32768
    ds_read_b64_tr_b16 v[112:113], v17 offset:36864
    ds_read_b64_tr_b16 v[114:115], v17 offset:37376
    ds_read_b128 v[116:119], v30 offset:32768
    s_waitcnt lgkmcnt(6)
    v_mfma_f32_32x32x16_bf16 v[64:79], v[96:99], v[100:103], v[64:79]
    ds_read_b64_tr_b16 v[120:121], v17 offset:38912
    ds_read_b64_tr_b16 v[122:123], v17 offset:39424
    ds_read_b128 v[124:127], v31 offset:32768
    s_waitcnt lgkmcnt(6)
    v_mfma_f32_32x32x16_bf16 v[64:79], v[104:107], v[108:111], v[64:79]
    ds_read_b64_tr_b16 v[96:97], v17 offset:40960
    ds_read_b64_tr_b16 v[98:99], v17 offset:41472
    ds_read_b128 v[100:103], v32 offset:32768
    s_waitcnt lgkmcnt(6)
    v_mfma_f32_32x32x16_bf16 v[64:79], v[112:115], v[116:119], v[64:79]
    ds_read_b64_tr_b16 v[104:105], v17 offset:43008
    ds_read_b64_tr_b16 v[106:107], v17 offset:43520
    ds_read_b128 v[108:111], v33 offset:32768
    s_waitcnt lgkmcnt(6)
    v_mfma_f32_32x32x16_bf16 v[64:79], v[120:123], v[124:127], v[64:79]
    ds_read_b64_tr_b16 v[112:113], v17 offset:45056
    ds_read_b64_tr_b16 v[114:115], v17 offset:45568
    ds_read_b128 v[116:119], v34 offset:32768
    s_waitcnt lgkmcnt(6)
    v_mfma_f32_32x32x16_bf16 v[64:79], v[96:99], v[100:103], v[64:79]
    ds_read_b64_tr_b16 v[120:121], v17 offset:47104
    ds_read_b64_tr_b16 v[122:123], v17 offset:47616
    ds_read_b128 v[124:127], v35 offset:32768
    s_waitcnt lgkmcnt(6)
    v_mfma_f32_32x32x16_bf16 v[64:79], v[104:107], v[108:111], v[64:79]
    s_waitcnt lgkmcnt(3)
    v_mfma_f32_32x32x16_bf16 v[64:79], v[112:115], v[116:119], v[64:79]
    s_waitcnt lgkmcnt(0)
    v_mfma_f32_32x32x16_bf16 v[64:79], v[120:123], v[124:127], v[64:79]
    s_barrier
    ds_read_b64_tr_b16 v[96:97], v16 offset:0
    ds_read_b64_tr_b16 v[98:99], v16 offset:512
    ds_read_b128 v[100:103], v20 offset:0
    ds_read_b64_tr_b16 v[104:105], v16 offset:2048
    ds_read_b64_tr_b16 v[106:107], v16 offset:2560
    ds_read_b128 v[108:111], v21 offset:0
    ds_read_b64_tr_b16 v[112:113], v16 offset:4096
    ds_read_b64_tr_b16 v[114:115], v16 offset:4608
    ds_read_b128 v[116:119], v22 offset:0
    s_waitcnt lgkmcnt(6)
    v_mfma_f32_32x32x16_bf16 v[64:79], v[96:99], v[100:103], v[64:79]
    ds_read_b64_tr_b16 v[120:121], v16 offset:6144
    ds_read_b64_tr_b16 v[122:123], v16 offset:6656
    ds_read_b128 v[124:127], v23 offset:0
    s_waitcnt lgkmcnt(6)
    v_mfma_f32_32x32x16_bf16 v[64:79], v[104:107], v[108:111], v[64:79]
    ds_read_b64_tr_b16 v[96:97], v16 offset:8192
    ds_read_b64_tr_b16 v[98:99], v16 offset:8704
    ds_read_b128 v[100:103], v24 offset:0
    s_waitcnt lgkmcnt(6)
    v_mfma_f32_32x32x16_bf16 v[64:79], v[112:115], v[116:119], v[64:79]
    ds_read_b64_tr_b16 v[104:105], v16 offset:10240
    ds_read_b64_tr_b16 v[106:107], v16 offset:10752
    ds_read_b128 v[108:111], v25 offset:0
    s_waitcnt lgkmcnt(6)
    v_mfma_f32_32x32x16_bf16 v[64:79], v[120:123], v[124:127], v[64:79]
    ds_read_b64_tr_b16 v[112:113], v16 offset:12288
    ds_read_b64_tr_b16 v[114:115], v16 offset:12800
    ds_read_b128 v[116:119], v26 offset:0
    s_waitcnt lgkmcnt(6)
    v_mfma_f32_32x32x16_bf16 v[64:79], v[96:99], v[100:103], v[64:79]
    ds_read_b64_tr_b16 v[120:121], v16 offset:14336
    ds_read_b64_tr_b16 v[122:123], v16 offset:14848
    ds_read_b128 v[124:127], v27 offset:0
    s_waitcnt lgkmcnt(6)
    v_mfma_f32_32x32x16_bf16 v[64:79], v[104:107], v[108:111], v[64:79]
    s_waitcnt lgkmcnt(3)
    v_mfma_f32_32x32x16_bf16 v[64:79], v[112:115], v[116:119], v[64:79]
    s_waitcnt lgkmcnt(0)
    v_mfma_f32_32x32x16_bf16 v[64:79], v[120:123], v[124:127], v[64:79]
    s_barrier
    ds_read_b64_tr_b16 v[96:97], v16 offset:32768
    ds_read_b64_tr_b16 v[98:99], v16 offset:33280
    ds_read_b128 v[100:103], v20 offset:32768
    ds_read_b64_tr_b16 v[104:105], v16 offset:34816
    ds_read_b64_tr_b16 v[106:107], v16 offset:35328
    ds_read_b128 v[108:111], v21 offset:32768
    ds_read_b64_tr_b16 v[112:113], v16 offset:36864
    ds_read_b64_tr_b16 v[114:115], v16 offset:37376
    ds_read_b128 v[116:119], v22 offset:32768
    s_waitcnt lgkmcnt(6)
    v_mfma_f32_32x32x16_bf16 v[64:79], v[96:99], v[100:103], v[64:79]
    ds_read_b64_tr_b16 v[120:121], v16 offset:38912
    ds_read_b64_tr_b16 v[122:123], v16 offset:39424
    ds_read_b128 v[124:127], v23 offset:32768
    s_waitcnt lgkmcnt(6)
    v_mfma_f32_32x32x16_bf16 v[64:79], v[104:107], v[108:111], v[64:79]
    ds_read_b64_tr_b16 v[96:97], v16 offset:40960
    ds_read_b64_tr_b16 v[98:99], v16 offset:41472
    ds_read_b128 v[100:103], v24 offset:32768
    s_waitcnt lgkmcnt(6)
    v_mfma_f32_32x32x16_bf16 v[64:79], v[112:115], v[116:119], v[64:79]
    ds_read_b64_tr_b16 v[104:105], v16 offset:43008
    ds_read_b64_tr_b16 v[106:107], v16 offset:43520
    ds_read_b128 v[108:111], v25 offset:32768
    s_waitcnt lgkmcnt(6)
    v_mfma_f32_32x32x16_bf16 v[64:79], v[120:123], v[124:127], v[64:79]
    ds_read_b64_tr_b16 v[112:113], v16 offset:45056
    ds_read_b64_tr_b16 v[114:115], v16 offset:45568
    ds_read_b128 v[116:119], v26 offset:32768
    s_waitcnt lgkmcnt(6)
    v_mfma_f32_32x32x16_bf16 v[64:79], v[96:99], v[100:103], v[64:79]
    ds_read_b64_tr_b16 v[120:121], v16 offset:47104
    ds_read_b64_tr_b16 v[122:123], v16 offset:47616
    ds_read_b128 v[124:127], v27 offset:32768
    s_waitcnt lgkmcnt(6)
    v_mfma_f32_32x32x16_bf16 v[64:79], v[104:107], v[108:111], v[64:79]
    s_waitcnt lgkmcnt(3)
    v_mfma_f32_32x32x16_bf16 v[64:79], v[112:115], v[116:119], v[64:79]
    s_waitcnt lgkmcnt(0)
    v_mfma_f32_32x32x16_bf16 v[64:79], v[120:123], v[124:127], v[64:79]
    s_barrier
    ds_read_b64_tr_b16 v[96:97], v17 offset:0
    ds_read_b64_tr_b16 v[98:99], v17 offset:512
    ds_read_b128 v[100:103], v28 offset:0
    ds_read_b64_tr_b16 v[104:105], v17 offset:2048
    ds_read_b64_tr_b16 v[106:107], v17 offset:2560
    ds_read_b128 v[108:111], v29 offset:0
    ds_read_b64_tr_b16 v[112:113], v17 offset:4096
    ds_read_b64_tr_b16 v[114:115], v17 offset:4608
    ds_read_b128 v[116:119], v30 offset:0
    s_waitcnt lgkmcnt(6)
    v_mfma_f32_32x32x16_bf16 v[64:79], v[96:99], v[100:103], v[64:79]
    ds_read_b64_tr_b16 v[120:121], v17 offset:6144
    ds_read_b64_tr_b16 v[122:123], v17 offset:6656
    ds_read_b128 v[124:127], v31 offset:0
    s_waitcnt lgkmcnt(6)
    v_mfma_f32_32x32x16_bf16 v[64:79], v[104:107], v[108:111], v[64:79]
    ds_read_b64_tr_b16 v[96:97], v17 offset:8192
    ds_read_b64_tr_b16 v[98:99], v17 offset:8704
    ds_read_b128 v[100:103], v32 offset:0
    s_waitcnt lgkmcnt(6)
    v_mfma_f32_32x32x16_bf16 v[64:79], v[112:115], v[116:119], v[64:79]
    ds_read_b64_tr_b16 v[104:105], v17 offset:10240
    ds_read_b64_tr_b16 v[106:107], v17 offset:10752
    ds_read_b128 v[108:111], v33 offset:0
    s_waitcnt lgkmcnt(6)
    v_mfma_f32_32x32x16_bf16 v[64:79], v[120:123], v[124:127], v[64:79]
    ds_read_b64_tr_b16 v[112:113], v17 offset:12288
    ds_read_b64_tr_b16 v[114:115], v17 offset:12800
    ds_read_b128 v[116:119], v34 offset:0
    s_waitcnt lgkmcnt(6)
    v_mfma_f32_32x32x16_bf16 v[64:79], v[96:99], v[100:103], v[64:79]
    ds_read_b64_tr_b16 v[120:121], v17 offset:14336
    ds_read_b64_tr_b16 v[122:123], v17 offset:14848
    ds_read_b128 v[124:127], v35 offset:0
    s_waitcnt lgkmcnt(6)
    v_mfma_f32_32x32x16_bf16 v[64:79], v[104:107], v[108:111], v[64:79]
    s_waitcnt lgkmcnt(3)
    v_mfma_f32_32x32x16_bf16 v[64:79], v[112:115], v[116:119], v[64:79]
    s_waitcnt lgkmcnt(0)
    v_mfma_f32_32x32x16_bf16 v[64:79], v[120:123], v[124:127], v[64:79]
    s_barrier
    ds_read_b64_tr_b16 v[96:97], v17 offset:32768
    ds_read_b64_tr_b16 v[98:99], v17 offset:33280
    ds_read_b128 v[100:103], v28 offset:32768
    ds_read_b64_tr_b16 v[104:105], v17 offset:34816
    ds_read_b64_tr_b16 v[106:107], v17 offset:35328
    ds_read_b128 v[108:111], v29 offset:32768
    ds_read_b64_tr_b16 v[112:113], v17 offset:36864
    ds_read_b64_tr_b16 v[114:115], v17 offset:37376
    ds_read_b128 v[116:119], v30 offset:32768
    s_waitcnt lgkmcnt(6)
    v_mfma_f32_32x32x16_bf16 v[64:79], v[96:99], v[100:103], v[64:79]
    ds_read_b64_tr_b16 v[120:121], v17 offset:38912
    ds_read_b64_tr_b16 v[122:123], v17 offset:39424
    ds_read_b128 v[124:127], v31 offset:32768
    s_waitcnt lgkmcnt(6)
    v_mfma_f32_32x32x16_bf16 v[64:79], v[104:107], v[108:111], v[64:79]
    ds_read_b64_tr_b16 v[96:97], v17 offset:40960
    ds_read_b64_tr_b16 v[98:99], v17 offset:41472
    ds_read_b128 v[100:103], v32 offset:32768
    s_waitcnt lgkmcnt(6)
    v_mfma_f32_32x32x16_bf16 v[64:79], v[112:115], v[116:119], v[64:79]
    ds_read_b64_tr_b16 v[104:105], v17 offset:43008
    ds_read_b64_tr_b16 v[106:107], v17 offset:43520
    ds_read_b128 v[108:111], v33 offset:32768
    s_waitcnt lgkmcnt(6)
    v_mfma_f32_32x32x16_bf16 v[64:79], v[120:123], v[124:127], v[64:79]
    ds_read_b64_tr_b16 v[112:113], v17 offset:45056
    ds_read_b64_tr_b16 v[114:115], v17 offset:45568
    ds_read_b128 v[116:119], v34 offset:32768
    s_waitcnt lgkmcnt(6)
    v_mfma_f32_32x32x16_bf16 v[64:79], v[96:99], v[100:103], v[64:79]
    ds_read_b64_tr_b16 v[120:121], v17 offset:47104
    ds_read_b64_tr_b16 v[122:123], v17 offset:47616
    ds_read_b128 v[124:127], v35 offset:32768
    s_waitcnt lgkmcnt(6)
    v_mfma_f32_32x32x16_bf16 v[64:79], v[104:107], v[108:111], v[64:79]
    s_waitcnt lgkmcnt(3)
    v_mfma_f32_32x32x16_bf16 v[64:79], v[112:115], v[116:119], v[64:79]
    s_waitcnt lgkmcnt(0)
    v_mfma_f32_32x32x16_bf16 v[64:79], v[120:123], v[124:127], v[64:79]
    s_barrier
    ds_read_b64_tr_b16 v[96:97], v16 offset:0
    ds_read_b64_tr_b16 v[98:99], v16 offset:512
    ds_read_b128 v[100:103], v20 offset:0
    ds_read_b64_tr_b16 v[104:105], v16 offset:2048
    ds_read_b64_tr_b16 v[106:107], v16 offset:2560
    ds_read_b128 v[108:111], v21 offset:0
    ds_read_b64_tr_b16 v[112:113], v16 offset:4096
    ds_read_b64_tr_b16 v[114:115], v16 offset:4608
    ds_read_b128 v[116:119], v22 offset:0
    s_waitcnt lgkmcnt(6)
    v_mfma_f32_32x32x16_bf16 v[64:79], v[96:99], v[100:103], v[64:79]
    ds_read_b64_tr_b16 v[120:121], v16 offset:6144
    ds_read_b64_tr_b16 v[122:123], v16 offset:6656
    ds_read_b128 v[124:127], v23 offset:0
    s_waitcnt lgkmcnt(6)
    v_mfma_f32_32x32x16_bf16 v[64:79], v[104:107], v[108:111], v[64:79]
    ds_read_b64_tr_b16 v[96:97], v16 offset:8192
    ds_read_b64_tr_b16 v[98:99], v16 offset:8704
    ds_read_b128 v[100:103], v24 offset:0
    s_waitcnt lgkmcnt(6)
    v_mfma_f32_32x32x16_bf16 v[64:79], v[112:115], v[116:119], v[64:79]
    ds_read_b64_tr_b16 v[104:105], v16 offset:10240
    ds_read_b64_tr_b16 v[106:107], v16 offset:10752
    ds_read_b128 v[108:111], v25 offset:0
    s_waitcnt lgkmcnt(6)
    v_mfma_f32_32x32x16_bf16 v[64:79], v[120:123], v[124:127], v[64:79]
    ds_read_b64_tr_b16 v[112:113], v16 offset:12288
    ds_read_b64_tr_b16 v[114:115], v16 offset:12800
    ds_read_b128 v[116:119], v26 offset:0
    s_waitcnt lgkmcnt(6)
    v_mfma_f32_32x32x16_bf16 v[64:79], v[96:99], v[100:103], v[64:79]
    ds_read_b64_tr_b16 v[120:121], v16 offset:14336
    ds_read_b64_tr_b16 v[122:123], v16 offset:14848
    ds_read_b128 v[124:127], v27 offset:0
    s_waitcnt lgkmcnt(6)
    v_mfma_f32_32x32x16_bf16 v[64:79], v[104:107], v[108:111], v[64:79]
    s_waitcnt lgkmcnt(3)
    v_mfma_f32_32x32x16_bf16 v[64:79], v[112:115], v[116:119], v[64:79]
    s_waitcnt lgkmcnt(0)
    v_mfma_f32_32x32x16_bf16 v[64:79], v[120:123], v[124:127], v[64:79]
    s_barrier
    ds_read_b64_tr_b16 v[96:97], v16 offset:32768
    ds_read_b64_tr_b16 v[98:99], v16 offset:33280
    ds_read_b128 v[100:103], v20 offset:32768
    ds_read_b64_tr_b16 v[104:105], v16 offset:34816
    ds_read_b64_tr_b16 v[106:107], v16 offset:35328
    ds_read_b128 v[108:111], v21 offset:32768
    ds_read_b64_tr_b16 v[112:113], v16 offset:36864
    ds_read_b64_tr_b16 v[114:115], v16 offset:37376
    ds_read_b128 v[116:119], v22 offset:32768
    s_waitcnt lgkmcnt(6)
    v_mfma_f32_32x32x16_bf16 v[64:79], v[96:99], v[100:103], v[64:79]
    ds_read_b64_tr_b16 v[120:121], v16 offset:38912
    ds_read_b64_tr_b16 v[122:123], v16 offset:39424
    ds_read_b128 v[124:127], v23 offset:32768
    s_waitcnt lgkmcnt(6)
    v_mfma_f32_32x32x16_bf16 v[64:79], v[104:107], v[108:111], v[64:79]
    ds_read_b64_tr_b16 v[96:97], v16 offset:40960
    ds_read_b64_tr_b16 v[98:99], v16 offset:41472
    ds_read_b128 v[100:103], v24 offset:32768
    s_waitcnt lgkmcnt(6)
    v_mfma_f32_32x32x16_bf16 v[64:79], v[112:115], v[116:119], v[64:79]
    ds_read_b64_tr_b16 v[104:105], v16 offset:43008
    ds_read_b64_tr_b16 v[106:107], v16 offset:43520
    ds_read_b128 v[108:111], v25 offset:32768
    s_waitcnt lgkmcnt(6)
    v_mfma_f32_32x32x16_bf16 v[64:79], v[120:123], v[124:127], v[64:79]
    ds_read_b64_tr_b16 v[112:113], v16 offset:45056
    ds_read_b64_tr_b16 v[114:115], v16 offset:45568
    ds_read_b128 v[116:119], v26 offset:32768
    s_waitcnt lgkmcnt(6)
    v_mfma_f32_32x32x16_bf16 v[64:79], v[96:99], v[100:103], v[64:79]
    ds_read_b64_tr_b16 v[120:121], v16 offset:47104
    ds_read_b64_tr_b16 v[122:123], v16 offset:47616
    ds_read_b128 v[124:127], v27 offset:32768
    s_waitcnt lgkmcnt(6)
    v_mfma_f32_32x32x16_bf16 v[64:79], v[104:107], v[108:111], v[64:79]
    s_waitcnt lgkmcnt(3)
    v_mfma_f32_32x32x16_bf16 v[64:79], v[112:115], v[116:119], v[64:79]
    s_waitcnt lgkmcnt(0)
    v_mfma_f32_32x32x16_bf16 v[64:79], v[120:123], v[124:127], v[64:79]
    v_lshrrev_b32 v14, 1, v3
    v_lshl_add_u32 v14, v14, 2, v12
    v_lshl_add_u32 v14, v9, 5, v14
    v_lshlrev_b32 v14, 7, v14
    v_lshl_add_u32 v14, v10, 6, v14
    v_and_b32 v15, 1, v3
    v_lshl_add_u32 v14, v15, 5, v14
    v_lshl_add_u32 v14, v13, 3, v14
    v_add_u32 v14, 131072, v14
    ds_read_b64_tr_b16 v[80:81], v14 offset:0
    ds_read_b64_tr_b16 v[82:83], v14 offset:1024
    ds_read_b64_tr_b16 v[84:85], v14 offset:2048
    ds_read_b64_tr_b16 v[86:87], v14 offset:3072
    s_nop 7
    v_cvt_pk_bf16_f32 v41, v64, v65
    v_lshlrev_b32 v64, 16, v41
    v_and_b32 v65, 0xffff0000, v41
    v_cvt_pk_bf16_f32 v41, v66, v67
    v_lshlrev_b32 v66, 16, v41
    v_and_b32 v67, 0xffff0000, v41
    v_cvt_pk_bf16_f32 v41, v68, v69
    v_lshlrev_b32 v68, 16, v41
    v_and_b32 v69, 0xffff0000, v41
    v_cvt_pk_bf16_f32 v41, v70, v71
    v_lshlrev_b32 v70, 16, v41
    v_and_b32 v71, 0xffff0000, v41
    v_cvt_pk_bf16_f32 v41, v72, v73
    v_lshlrev_b32 v72, 16, v41
    v_and_b32 v73, 0xffff0000, v41
    v_cvt_pk_bf16_f32 v41, v74, v75
    v_lshlrev_b32 v74, 16, v41
    v_and_b32 v75, 0xffff0000, v41
    v_cvt_pk_bf16_f32 v41, v76, v77
    v_lshlrev_b32 v76, 16, v41
    v_and_b32 v77, 0xffff0000, v41
    v_cvt_pk_bf16_f32 v41, v78, v79
    v_lshlrev_b32 v78, 16, v41
    v_and_b32 v79, 0xffff0000, v41
    s_waitcnt vmcnt(0) lgkmcnt(0)
    v_lshlrev_b32 v41, 16, v80
    v_add_f32 v64, v64, v41
    v_and_b32 v41, 0xffff0000, v80
    v_add_f32 v65, v65, v41
    v_lshlrev_b32 v41, 16, v81
    v_add_f32 v66, v66, v41
    v_and_b32 v41, 0xffff0000, v81
    v_add_f32 v67, v67, v41
    v_lshlrev_b32 v41, 16, v82
    v_add_f32 v68, v68, v41
    v_and_b32 v41, 0xffff0000, v82
    v_add_f32 v69, v69, v41
    v_lshlrev_b32 v41, 16, v83
    v_add_f32 v70, v70, v41
    v_and_b32 v41, 0xffff0000, v83
    v_add_f32 v71, v71, v41
    v_lshlrev_b32 v41, 16, v84
    v_add_f32 v72, v72, v41
    v_and_b32 v41, 0xffff0000, v84
    v_add_f32 v73, v73, v41
    v_lshlrev_b32 v41, 16, v85
    v_add_f32 v74, v74, v41
    v_and_b32 v41, 0xffff0000, v85
    v_add_f32 v75, v75, v41
    v_lshlrev_b32 v41, 16, v86
    v_add_f32 v76, v76, v41
    v_and_b32 v41, 0xffff0000, v86
    v_add_f32 v77, v77, v41
    v_lshlrev_b32 v41, 16, v87
    v_add_f32 v78, v78, v41
    v_and_b32 v41, 0xffff0000, v87
    v_add_f32 v79, v79, v41
    v_cvt_pk_bf16_f32 v88, v64, v65
    v_cvt_pk_bf16_f32 v89, v66, v67
    v_cvt_pk_bf16_f32 v90, v68, v69
    v_cvt_pk_bf16_f32 v91, v70, v71
    v_cvt_pk_bf16_f32 v92, v72, v73
    v_cvt_pk_bf16_f32 v93, v74, v75
    v_cvt_pk_bf16_f32 v94, v76, v77
    v_cvt_pk_bf16_f32 v95, v78, v79
    s_nop 1
    v_permlane32_swap_b32 v88, v90
    v_permlane32_swap_b32 v89, v91
    v_permlane32_swap_b32 v92, v94
    v_permlane32_swap_b32 v93, v95
    v_lshl_add_u32 v14, v10, 5, v18
    v_lshlrev_b32 v14, 10, v14
    v_lshl_add_u32 v14, v9, 6, v14
    v_lshl_add_u32 v14, v11, 4, v14
    s_lshl_b32 s50, s40, 16
    s_lshl_b32 s51, s41, 7
    s_add_u32 s50, s50, s51
    buffer_store_dwordx4 v[88:91], v14, s[56:59], s50 offen
    buffer_store_dwordx4 v[92:95], v14, s[56:59], s50 offen offset:32
gemm2b_kernel_end:
    s_endpgm
.section .rodata,"a"
.p2align 6
.amdhsa_kernel prep_kernel
  .amdhsa_next_free_vgpr 128
  .amdhsa_next_free_sgpr 96
  .amdhsa_accum_offset 128
  .amdhsa_group_segment_fixed_size 0
  .amdhsa_kernarg_size 104
  .amdhsa_user_sgpr_count 2
  .amdhsa_user_sgpr_kernarg_segment_ptr 1
  .amdhsa_system_sgpr_workgroup_id_x 1
  .amdhsa_float_denorm_mode_32 3
.end_amdhsa_kernel
.section .rodata,"a"
.p2align 6
.amdhsa_kernel conv1_kernel
  .amdhsa_next_free_vgpr 128
  .amdhsa_next_free_sgpr 96
  .amdhsa_accum_offset 128
  .amdhsa_group_segment_fixed_size 0
  .amdhsa_kernarg_size 104
  .amdhsa_user_sgpr_count 2
  .amdhsa_user_sgpr_kernarg_segment_ptr 1
  .amdhsa_system_sgpr_workgroup_id_x 1
  .amdhsa_float_denorm_mode_32 3
.end_amdhsa_kernel
.section .rodata,"a"
.p2align 6
.amdhsa_kernel gemm1a_kernel
  .amdhsa_next_free_vgpr 168
  .amdhsa_next_free_sgpr 96
  .amdhsa_accum_offset 168
  .amdhsa_group_segment_fixed_size 0
  .amdhsa_kernarg_size 104
  .amdhsa_user_sgpr_count 2
  .amdhsa_user_sgpr_kernarg_segment_ptr 1
  .amdhsa_system_sgpr_workgroup_id_x 1
  .amdhsa_float_denorm_mode_32 3
.end_amdhsa_kernel
.section .rodata,"a"
.p2align 6
.amdhsa_kernel gemm2a_kernel
  .amdhsa_next_free_vgpr 136
  .amdhsa_next_free_sgpr 96
  .amdhsa_accum_offset 136
  .amdhsa_group_segment_fixed_size 0
  .amdhsa_kernarg_size 104
  .amdhsa_user_sgpr_count 2
  .amdhsa_user_sgpr_kernarg_segment_ptr 1
  .amdhsa_system_sgpr_workgroup_id_x 1
  .amdhsa_float_denorm_mode_32 3
.end_amdhsa_kernel
.section .rodata,"a"
.p2align 6
.amdhsa_kernel conv2_kernel
  .amdhsa_next_free_vgpr 128
  .amdhsa_next_free_sgpr 96
  .amdhsa_accum_offset 128
  .amdhsa_group_segment_fixed_size 0
  .amdhsa_kernarg_size 104
  .amdhsa_user_sgpr_count 2
  .amdhsa_user_sgpr_kernarg_segment_ptr 1
  .amdhsa_system_sgpr_workgroup_id_x 1
  .amdhsa_float_denorm_mode_32 3
.end_amdhsa_kernel
.section .rodata,"a"
.p2align 6
.amdhsa_kernel gemm1b_kernel
  .amdhsa_next_free_vgpr 168
  .amdhsa_next_free_sgpr 96
  .amdhsa_accum_offset 168
  .amdhsa_group_segment_fixed_size 0
  .amdhsa_kernarg_size 104
  .amdhsa_user_sgpr_count 2
  .amdhsa_user_sgpr_kernarg_segment_ptr 1
  .amdhsa_system_sgpr_workgroup_id_x 1
  .amdhsa_float_denorm_mode_32 3
.end_amdhsa_kernel
.section .rodata,"a"
.p2align 6
.amdhsa_kernel gemm2b_kernel
  .amdhsa_next_free_vgpr 136
  .amdhsa_next_free_sgpr 96
  .amdhsa_accum_offset 136
  .amdhsa_group_segment_fixed_size 0
  .amdhsa_kernarg_size 104
  .amdhsa_user_sgpr_count 2
  .amdhsa_user_sgpr_kernarg_segment_ptr 1
  .amdhsa_system_sgpr_workgroup_id_x 1
  .amdhsa_float_denorm_mode_32 3
.end_amdhsa_kernel
```
